```python
import torch

def _softmax(x, axis=-1):
    return torch.softmax(x, dim=axis)
def _gelu(x):
    return torch.nn.functional.gelu(x, approximate="tanh")
def _silu(x):
    return torch.nn.functional.silu(x)
def _sigmoid(x):
    return torch.sigmoid(x)
def _layernorm(x, axis=-1, eps=1e-5):
    m = x.mean(dim=axis, keepdim=True)
    v = x.var(dim=axis, keepdim=True, unbiased=False)
    return (x - m) / torch.sqrt(v + eps)
def _scatter_add(tgt, idx, src, axis=0):
    return tgt.clone().index_add_(axis, idx, src)
def _segment_sum(src, seg, n):
    out = torch.zeros((n,) + src.shape[1:], dtype=src.dtype)
    return out.index_add_(0, seg, src)
def _pad(x, pw):
    flat = tuple(v for pair in reversed(pw) for v in pair)
    return torch.nn.functional.pad(x, flat)

kernel_name = 'interleave_layers__mha_block__mixer_channel_mlp__prompt'

def setup_inputs():

    _w = (lambda a: (lambda t: t.to(torch.bfloat16) if t.is_floating_point() else t)(torch.as_tensor(a)))
    def _A_setup():
        B, S, D, H = 1, 2048, 1024, 32
        return {
            "x": _w((lambda *s: torch.randn(*s, dtype=torch.bfloat16) * 0.05)(B, S, D)),
            "wqkv": _w((lambda *s: torch.randn(*s, dtype=torch.bfloat16) * 0.05)(D, 3 * D)),
            "wo": _w((lambda *s: torch.randn(*s, dtype=torch.bfloat16) * 0.05)(D, D)),
        }
    _A_in = _A_setup()

    def _B_setup():
        B, S, D, F = 1, 2048, 1024, 3584
        return {
            "x": _w((lambda *s: torch.randn(*s, dtype=torch.bfloat16) * 0.05)(B, S, D)),
            "w1": _w((lambda *s: torch.randn(*s, dtype=torch.bfloat16) * 3.2)(D, F) * (D ** -0.5)),
            "b1": _w((lambda *s: torch.randn(*s, dtype=torch.bfloat16) * 0.8)(F)),
            "w2": _w((lambda *s: torch.randn(*s, dtype=torch.bfloat16) * 0.4)(F, D) * (F ** -0.5)),
            "b2": _w((lambda *s: torch.randn(*s, dtype=torch.bfloat16) * 0.4)(D)),
        }
    _B_in = _B_setup()

    return {
        "A_x": _A_in["x"],
        "A_wqkv": _A_in["wqkv"],
        "A_wo": _A_in["wo"],
        "B_x": _B_in["x"],
        "B_w1": _B_in["w1"],
        "B_b1": _B_in["b1"],
        "B_w2": _B_in["w2"],
        "B_b2": _B_in["b2"],
    }

def reference(A_x, A_wqkv, A_wo, B_x, B_w1, B_b1, B_w2, B_b2):
    def _A_ref(x, wqkv, wo):
        B, S, D = x.shape
        H = 32
        Dh = D // H
        qkv = (lambda x, *d: x.permute(*d))((x @ wqkv).reshape(B, S, 3, H, Dh), 2, 0, 3, 1, 4)
        q, k, v = qkv[0], qkv[1], qkv[2]
        scores = torch.einsum("bhqd,bhkd->bhqk", q, k) * (Dh ** -0.5)
        p = _softmax(scores, axis=-1)
        o = torch.einsum("bhqk,bhkd->bhqd", p, v)
        return (lambda x, *d: x.permute(*d))(o, 0, 2, 1, 3).reshape(B, S, D) @ wo

    def _B_ref(x, w1, b1, w2, b2):
        y = _layernorm(x, axis=-1)
        h = _gelu(torch.einsum("bsd,df->bsf", y, w1) + b1)
        return torch.einsum("bsf,fd->bsd", h, w2) + b2

    x = A_x
    x = x + _A_ref(_layernorm(x, axis=-1), A_wqkv, A_wo)
    x = x + _B_ref(_layernorm(x, axis=-1), B_w1, B_b1, B_w2, B_b2)
    x = x + _A_ref(_layernorm(x, axis=-1), A_wqkv, A_wo)
    x = x + _B_ref(_layernorm(x, axis=-1), B_w1, B_b1, B_w2, B_b2)
    return x
```

```asm
; @launch kernel=g0_kernel grid=(256,1,1) block=(512,1,1) lds=163840
; @launch kernel=rest_kernel grid=(256,1,1) block=(512,1,1) lds=163840
.amdgcn_target "amdgcn-amd-amdhsa--gfx950"
.text
.p2align 8
L_text_start:
.globl g0_kernel
.p2align 8
.type g0_kernel,@function
g0_kernel:
    s_load_dwordx16 s[16:31], s[0:1], 0
    s_load_dwordx4 s[32:35], s[0:1], 64
    s_load_dwordx2 s[36:37], s[0:1], 80
    s_cmp_ge_u32 s2, 256
    s_cbranch_scc1 L_g0_kernel_end
    v_lshrrev_b32 v1, 6, v0
    v_and_b32 v0, 63, v0
    v_readfirstlane_b32 s10, v1
    s_cmp_ge_u32 s2, 8
    s_cbranch_scc1 L_g0_kernel_cpf_skip
    s_getpc_b64 s[60:61]
L_g0_kernel_cpf_pc:
    s_add_u32 s60, s60, L_text_start-L_g0_kernel_cpf_pc
    s_addc_u32 s61, s61, -1
    v_and_b32 v2, 63, v0
    v_lshlrev_b32 v2, 7, v2
    s_mul_i32 s62, s10, 8192
    v_add_u32 v2, s62, v2
    v_min_u32 v3, L_text_end-L_text_start-4, v2
    global_load_dword v250, v3, s[60:61]
L_g0_kernel_cpf_skip:
    s_cmp_lt_u32 s10, 4
    s_cbranch_scc1 L_g0_kernel_compute
    s_sub_u32 s10, s10, 4
    s_setprio 0
    s_and_b32 s4, s2, 7
    s_lshr_b32 s5, s2, 3
    s_and_b32 s6, s4, 3
    s_lshr_b32 s7, s4, 2
    s_mul_i32 s9, s6, 4
    s_and_b32 s6, s5, 3
    s_add_u32 s9, s9, s6
    s_mul_i32 s8, s7, 8
    s_lshr_b32 s6, s5, 2
    s_add_u32 s8, s8, s6
    s_lshl_b32 s4, s8, 7
    s_lshl_b32 s5, s10, 5
    s_add_u32 s4, s4, s5
    s_mul_i32 s48, s4, 2048
    v_lshrrev_b32 v2, 3, v0
    v_mul_u32_u24 v2, 2048, v2
    v_and_b32 v3, 7, v0
    v_lshrrev_b32 v4, 4, v0
    v_xor_b32 v3, v3, v4
    v_lshl_add_u32 v8, v3, 4, v2
    v_xor_b32 v3, 4, v3
    v_lshl_add_u32 v9, v3, 4, v2
    v_add_u32 v9, 16384, v9
    v_add_u32 v10, 32768, v8
    v_add_u32 v11, 32768, v9
    s_mul_i32 s49, s10, 98304
    v_lshrrev_b32 v2, 2, v0
    v_mul_u32_u24 v2, 6144, v2
    v_and_b32 v3, 3, v0
    v_lshl_add_u32 v2, v3, 4, v2
    s_add_u32 s4, s9, 0
    s_and_b32 s4, s4, 15
    s_lshl_b32 s4, s4, 7
    s_add_u32 s4, s4, 0
    v_add_u32 v12, s4, v2
    v_add_u32 v13, 64, v12
    s_add_u32 s4, s9, 1
    s_and_b32 s4, s4, 15
    s_lshl_b32 s4, s4, 7
    s_add_u32 s4, s4, 2048
    v_add_u32 v14, s4, v2
    v_add_u32 v15, 64, v14
    s_add_u32 s4, s9, 2
    s_and_b32 s4, s4, 15
    s_lshl_b32 s4, s4, 7
    s_add_u32 s4, s4, 4096
    v_add_u32 v16, s4, v2
    v_add_u32 v17, 64, v16
    s_lshl_b32 s6, s10, 10
    s_lshl_b32 s5, s10, 12
    s_add_u32 s6, s6, 16384
    s_mov_b32 s50, 0
    s_waitcnt lgkmcnt(0)
    s_mov_b32 s40, s16
    s_mov_b32 s41, s17
    s_mov_b32 s42, 4194304
    s_mov_b32 s43, 0x20000
    s_mov_b32 s44, s18
    s_mov_b32 s45, s19
    s_mov_b32 s46, 6291456
    s_mov_b32 s47, 0x20000
    s_add_u32 s7, s50, s5
    s_add_u32 m0, s7, 0
    s_nop 0
    buffer_load_dwordx4 v8, s[40:43], s48 offen lds
    s_add_u32 m0, s7, 1024
    s_nop 0
    buffer_load_dwordx4 v9, s[40:43], s48 offen lds
    s_add_u32 m0, s7, 2048
    s_nop 0
    buffer_load_dwordx4 v10, s[40:43], s48 offen lds
    s_add_u32 m0, s7, 3072
    s_nop 0
    buffer_load_dwordx4 v11, s[40:43], s48 offen lds
    s_add_u32 s7, s50, s6
    s_add_u32 m0, s7, 0
    s_nop 0
    buffer_load_dwordx4 v12, s[44:47], s49 offen lds
    s_add_u32 m0, s7, 4096
    s_nop 0
    buffer_load_dwordx4 v13, s[44:47], s49 offen lds
    s_add_u32 m0, s7, 8192
    s_nop 0
    buffer_load_dwordx4 v14, s[44:47], s49 offen lds
    s_add_u32 m0, s7, 12288
    s_nop 0
    buffer_load_dwordx4 v15, s[44:47], s49 offen lds
    s_add_u32 m0, s7, 16384
    s_nop 0
    buffer_load_dwordx4 v16, s[44:47], s49 offen lds
    s_add_u32 m0, s7, 20480
    s_nop 0
    buffer_load_dwordx4 v17, s[44:47], s49 offen lds
    s_add_u32 s48, s48, 128
    s_add_u32 s49, s49, 393216
    s_add_u32 s50, s50, 40960
    s_cmp_eq_u32 s50, 163840
    s_cselect_b32 s50, 0, s50
    s_add_u32 s7, s50, s5
    s_add_u32 m0, s7, 0
    s_nop 0
    buffer_load_dwordx4 v8, s[40:43], s48 offen lds
    s_add_u32 m0, s7, 1024
    s_nop 0
    buffer_load_dwordx4 v9, s[40:43], s48 offen lds
    s_add_u32 m0, s7, 2048
    s_nop 0
    buffer_load_dwordx4 v10, s[40:43], s48 offen lds
    s_add_u32 m0, s7, 3072
    s_nop 0
    buffer_load_dwordx4 v11, s[40:43], s48 offen lds
    s_add_u32 s7, s50, s6
    s_add_u32 m0, s7, 0
    s_nop 0
    buffer_load_dwordx4 v12, s[44:47], s49 offen lds
    s_add_u32 m0, s7, 4096
    s_nop 0
    buffer_load_dwordx4 v13, s[44:47], s49 offen lds
    s_add_u32 m0, s7, 8192
    s_nop 0
    buffer_load_dwordx4 v14, s[44:47], s49 offen lds
    s_add_u32 m0, s7, 12288
    s_nop 0
    buffer_load_dwordx4 v15, s[44:47], s49 offen lds
    s_add_u32 m0, s7, 16384
    s_nop 0
    buffer_load_dwordx4 v16, s[44:47], s49 offen lds
    s_add_u32 m0, s7, 20480
    s_nop 0
    buffer_load_dwordx4 v17, s[44:47], s49 offen lds
    s_add_u32 s48, s48, 128
    s_add_u32 s49, s49, 393216
    s_add_u32 s50, s50, 40960
    s_cmp_eq_u32 s50, 163840
    s_cselect_b32 s50, 0, s50
    v_mov_b32 v24, 0
    v_mov_b32 v28, 0
    v_mov_b32 v25, 0
    v_mov_b32 v29, 0
    v_mov_b32 v26, 0
    v_mov_b32 v30, 0
    v_mov_b32 v27, 0
    v_mov_b32 v31, 0
    v_lshlrev_b32 v2, 4, v0
    v_add_u32 v2, s5, v2
    s_mov_b32 s52, 0
    s_waitcnt vmcnt(10)
    s_barrier
    v_add_u32 v48, s52, v2
    ds_read_b128 v[32:35], v48 offset:0
    ds_read_b128 v[36:39], v48 offset:1024
    ds_read_b128 v[40:43], v48 offset:2048
    ds_read_b128 v[44:47], v48 offset:3072
    s_add_u32 s52, s52, 40960
    s_cmp_eq_u32 s52, 163840
    s_cselect_b32 s52, 0, s52
    s_add_u32 s7, s50, s5
    s_add_u32 m0, s7, 0
    s_nop 0
    buffer_load_dwordx4 v8, s[40:43], s48 offen lds
    s_waitcnt lgkmcnt(3)
    v_lshlrev_b32 v50, 16, v32
    v_and_b32 v51, 0xffff0000, v32
    v_add_f32 v24, v24, v50
    v_fmac_f32 v28, v50, v50
    v_add_f32 v24, v24, v51
    v_fmac_f32 v28, v51, v51
    v_lshlrev_b32 v52, 16, v33
    v_and_b32 v53, 0xffff0000, v33
    v_add_f32 v24, v24, v52
    s_add_u32 m0, s7, 1024
    s_nop 0
    buffer_load_dwordx4 v9, s[40:43], s48 offen lds
    v_fmac_f32 v28, v52, v52
    v_add_f32 v24, v24, v53
    v_fmac_f32 v28, v53, v53
    v_lshlrev_b32 v50, 16, v34
    v_and_b32 v51, 0xffff0000, v34
    v_add_f32 v24, v24, v50
    v_fmac_f32 v28, v50, v50
    v_add_f32 v24, v24, v51
    v_fmac_f32 v28, v51, v51
    v_lshlrev_b32 v52, 16, v35
    s_add_u32 m0, s7, 2048
    s_nop 0
    buffer_load_dwordx4 v10, s[40:43], s48 offen lds
    v_and_b32 v53, 0xffff0000, v35
    v_add_f32 v24, v24, v52
    v_fmac_f32 v28, v52, v52
    v_add_f32 v24, v24, v53
    v_fmac_f32 v28, v53, v53
    s_waitcnt lgkmcnt(2)
    v_lshlrev_b32 v50, 16, v36
    v_and_b32 v51, 0xffff0000, v36
    v_add_f32 v25, v25, v50
    v_fmac_f32 v29, v50, v50
    s_add_u32 m0, s7, 3072
    s_nop 0
    buffer_load_dwordx4 v11, s[40:43], s48 offen lds
    v_add_f32 v25, v25, v51
    v_fmac_f32 v29, v51, v51
    v_lshlrev_b32 v52, 16, v37
    v_and_b32 v53, 0xffff0000, v37
    v_add_f32 v25, v25, v52
    v_fmac_f32 v29, v52, v52
    v_add_f32 v25, v25, v53
    v_fmac_f32 v29, v53, v53
    v_lshlrev_b32 v50, 16, v38
    v_and_b32 v51, 0xffff0000, v38
    s_add_u32 s7, s50, s6
    s_add_u32 m0, s7, 0
    s_nop 0
    buffer_load_dwordx4 v12, s[44:47], s49 offen lds
    v_add_f32 v25, v25, v50
    v_fmac_f32 v29, v50, v50
    v_add_f32 v25, v25, v51
    v_fmac_f32 v29, v51, v51
    v_lshlrev_b32 v52, 16, v39
    v_and_b32 v53, 0xffff0000, v39
    v_add_f32 v25, v25, v52
    v_fmac_f32 v29, v52, v52
    v_add_f32 v25, v25, v53
    v_fmac_f32 v29, v53, v53
    s_add_u32 m0, s7, 4096
    s_nop 0
    buffer_load_dwordx4 v13, s[44:47], s49 offen lds
    s_waitcnt lgkmcnt(1)
    v_lshlrev_b32 v50, 16, v40
    v_and_b32 v51, 0xffff0000, v40
    v_add_f32 v26, v26, v50
    v_fmac_f32 v30, v50, v50
    v_add_f32 v26, v26, v51
    v_fmac_f32 v30, v51, v51
    v_lshlrev_b32 v52, 16, v41
    v_and_b32 v53, 0xffff0000, v41
    v_add_f32 v26, v26, v52
    s_add_u32 m0, s7, 8192
    s_nop 0
    buffer_load_dwordx4 v14, s[44:47], s49 offen lds
    v_fmac_f32 v30, v52, v52
    v_add_f32 v26, v26, v53
    v_fmac_f32 v30, v53, v53
    v_lshlrev_b32 v50, 16, v42
    v_and_b32 v51, 0xffff0000, v42
    v_add_f32 v26, v26, v50
    v_fmac_f32 v30, v50, v50
    v_add_f32 v26, v26, v51
    v_fmac_f32 v30, v51, v51
    v_lshlrev_b32 v52, 16, v43
    s_add_u32 m0, s7, 12288
    s_nop 0
    buffer_load_dwordx4 v15, s[44:47], s49 offen lds
    v_and_b32 v53, 0xffff0000, v43
    v_add_f32 v26, v26, v52
    v_fmac_f32 v30, v52, v52
    v_add_f32 v26, v26, v53
    v_fmac_f32 v30, v53, v53
    s_waitcnt lgkmcnt(0)
    v_lshlrev_b32 v50, 16, v44
    v_and_b32 v51, 0xffff0000, v44
    v_add_f32 v27, v27, v50
    v_fmac_f32 v31, v50, v50
    s_add_u32 m0, s7, 16384
    s_nop 0
    buffer_load_dwordx4 v16, s[44:47], s49 offen lds
    v_add_f32 v27, v27, v51
    v_fmac_f32 v31, v51, v51
    v_lshlrev_b32 v52, 16, v45
    v_and_b32 v53, 0xffff0000, v45
    v_add_f32 v27, v27, v52
    v_fmac_f32 v31, v52, v52
    v_add_f32 v27, v27, v53
    v_fmac_f32 v31, v53, v53
    v_lshlrev_b32 v50, 16, v46
    v_and_b32 v51, 0xffff0000, v46
    s_add_u32 m0, s7, 20480
    s_nop 0
    buffer_load_dwordx4 v17, s[44:47], s49 offen lds
    v_add_f32 v27, v27, v50
    v_fmac_f32 v31, v50, v50
    v_add_f32 v27, v27, v51
    v_fmac_f32 v31, v51, v51
    v_lshlrev_b32 v52, 16, v47
    v_and_b32 v53, 0xffff0000, v47
    v_add_f32 v27, v27, v52
    v_fmac_f32 v31, v52, v52
    v_add_f32 v27, v27, v53
    v_fmac_f32 v31, v53, v53
    s_add_u32 s48, s48, 128
    s_add_u32 s49, s49, 393216
    s_add_u32 s50, s50, 40960
    s_cmp_eq_u32 s50, 163840
    s_cselect_b32 s50, 0, s50
    s_add_u32 s7, s50, s5
    s_add_u32 m0, s7, 0
    s_nop 0
    buffer_load_dwordx4 v8, s[40:43], s48 offen lds
    s_add_u32 m0, s7, 1024
    s_nop 0
    buffer_load_dwordx4 v9, s[40:43], s48 offen lds
    s_add_u32 m0, s7, 2048
    s_nop 0
    buffer_load_dwordx4 v10, s[40:43], s48 offen lds
    s_add_u32 m0, s7, 3072
    s_nop 0
    buffer_load_dwordx4 v11, s[40:43], s48 offen lds
    s_add_u32 s7, s50, s6
    s_add_u32 m0, s7, 0
    s_nop 0
    buffer_load_dwordx4 v12, s[44:47], s49 offen lds
    s_add_u32 m0, s7, 4096
    s_nop 0
    buffer_load_dwordx4 v13, s[44:47], s49 offen lds
    s_add_u32 m0, s7, 8192
    s_nop 0
    buffer_load_dwordx4 v14, s[44:47], s49 offen lds
    s_add_u32 m0, s7, 12288
    s_nop 0
    buffer_load_dwordx4 v15, s[44:47], s49 offen lds
    s_add_u32 m0, s7, 16384
    s_nop 0
    buffer_load_dwordx4 v16, s[44:47], s49 offen lds
    s_add_u32 m0, s7, 20480
    s_nop 0
    buffer_load_dwordx4 v17, s[44:47], s49 offen lds
    s_add_u32 s48, s48, 128
    s_add_u32 s49, s49, 393216
    s_add_u32 s50, s50, 40960
    s_cmp_eq_u32 s50, 163840
    s_cselect_b32 s50, 0, s50
    s_mov_b32 s51, 12
L_qkv1_ld_loop:
    s_waitcnt vmcnt(20)
    s_barrier
    v_add_u32 v48, s52, v2
    ds_read_b128 v[32:35], v48 offset:0
    ds_read_b128 v[36:39], v48 offset:1024
    ds_read_b128 v[40:43], v48 offset:2048
    ds_read_b128 v[44:47], v48 offset:3072
    s_add_u32 s52, s52, 40960
    s_cmp_eq_u32 s52, 163840
    s_cselect_b32 s52, 0, s52
    s_add_u32 s7, s50, s5
    s_add_u32 m0, s7, 0
    s_nop 0
    buffer_load_dwordx4 v8, s[40:43], s48 offen lds
    s_waitcnt lgkmcnt(3)
    v_lshlrev_b32 v50, 16, v32
    v_and_b32 v51, 0xffff0000, v32
    v_add_f32 v24, v24, v50
    v_fmac_f32 v28, v50, v50
    v_add_f32 v24, v24, v51
    v_fmac_f32 v28, v51, v51
    v_lshlrev_b32 v52, 16, v33
    v_and_b32 v53, 0xffff0000, v33
    v_add_f32 v24, v24, v52
    s_add_u32 m0, s7, 1024
    s_nop 0
    buffer_load_dwordx4 v9, s[40:43], s48 offen lds
    v_fmac_f32 v28, v52, v52
    v_add_f32 v24, v24, v53
    v_fmac_f32 v28, v53, v53
    v_lshlrev_b32 v50, 16, v34
    v_and_b32 v51, 0xffff0000, v34
    v_add_f32 v24, v24, v50
    v_fmac_f32 v28, v50, v50
    v_add_f32 v24, v24, v51
    v_fmac_f32 v28, v51, v51
    v_lshlrev_b32 v52, 16, v35
    s_add_u32 m0, s7, 2048
    s_nop 0
    buffer_load_dwordx4 v10, s[40:43], s48 offen lds
    v_and_b32 v53, 0xffff0000, v35
    v_add_f32 v24, v24, v52
    v_fmac_f32 v28, v52, v52
    v_add_f32 v24, v24, v53
    v_fmac_f32 v28, v53, v53
    s_waitcnt lgkmcnt(2)
    v_lshlrev_b32 v50, 16, v36
    v_and_b32 v51, 0xffff0000, v36
    v_add_f32 v25, v25, v50
    v_fmac_f32 v29, v50, v50
    s_add_u32 m0, s7, 3072
    s_nop 0
    buffer_load_dwordx4 v11, s[40:43], s48 offen lds
    v_add_f32 v25, v25, v51
    v_fmac_f32 v29, v51, v51
    v_lshlrev_b32 v52, 16, v37
    v_and_b32 v53, 0xffff0000, v37
    v_add_f32 v25, v25, v52
    v_fmac_f32 v29, v52, v52
    v_add_f32 v25, v25, v53
    v_fmac_f32 v29, v53, v53
    v_lshlrev_b32 v50, 16, v38
    v_and_b32 v51, 0xffff0000, v38
    s_add_u32 s7, s50, s6
    s_add_u32 m0, s7, 0
    s_nop 0
    buffer_load_dwordx4 v12, s[44:47], s49 offen lds
    v_add_f32 v25, v25, v50
    v_fmac_f32 v29, v50, v50
    v_add_f32 v25, v25, v51
    v_fmac_f32 v29, v51, v51
    v_lshlrev_b32 v52, 16, v39
    v_and_b32 v53, 0xffff0000, v39
    v_add_f32 v25, v25, v52
    v_fmac_f32 v29, v52, v52
    v_add_f32 v25, v25, v53
    v_fmac_f32 v29, v53, v53
    s_add_u32 m0, s7, 4096
    s_nop 0
    buffer_load_dwordx4 v13, s[44:47], s49 offen lds
    s_waitcnt lgkmcnt(1)
    v_lshlrev_b32 v50, 16, v40
    v_and_b32 v51, 0xffff0000, v40
    v_add_f32 v26, v26, v50
    v_fmac_f32 v30, v50, v50
    v_add_f32 v26, v26, v51
    v_fmac_f32 v30, v51, v51
    v_lshlrev_b32 v52, 16, v41
    v_and_b32 v53, 0xffff0000, v41
    v_add_f32 v26, v26, v52
    s_add_u32 m0, s7, 8192
    s_nop 0
    buffer_load_dwordx4 v14, s[44:47], s49 offen lds
    v_fmac_f32 v30, v52, v52
    v_add_f32 v26, v26, v53
    v_fmac_f32 v30, v53, v53
    v_lshlrev_b32 v50, 16, v42
    v_and_b32 v51, 0xffff0000, v42
    v_add_f32 v26, v26, v50
    v_fmac_f32 v30, v50, v50
    v_add_f32 v26, v26, v51
    v_fmac_f32 v30, v51, v51
    v_lshlrev_b32 v52, 16, v43
    s_add_u32 m0, s7, 12288
    s_nop 0
    buffer_load_dwordx4 v15, s[44:47], s49 offen lds
    v_and_b32 v53, 0xffff0000, v43
    v_add_f32 v26, v26, v52
    v_fmac_f32 v30, v52, v52
    v_add_f32 v26, v26, v53
    v_fmac_f32 v30, v53, v53
    s_waitcnt lgkmcnt(0)
    v_lshlrev_b32 v50, 16, v44
    v_and_b32 v51, 0xffff0000, v44
    v_add_f32 v27, v27, v50
    v_fmac_f32 v31, v50, v50
    s_add_u32 m0, s7, 16384
    s_nop 0
    buffer_load_dwordx4 v16, s[44:47], s49 offen lds
    v_add_f32 v27, v27, v51
    v_fmac_f32 v31, v51, v51
    v_lshlrev_b32 v52, 16, v45
    v_and_b32 v53, 0xffff0000, v45
    v_add_f32 v27, v27, v52
    v_fmac_f32 v31, v52, v52
    v_add_f32 v27, v27, v53
    v_fmac_f32 v31, v53, v53
    v_lshlrev_b32 v50, 16, v46
    v_and_b32 v51, 0xffff0000, v46
    s_add_u32 m0, s7, 20480
    s_nop 0
    buffer_load_dwordx4 v17, s[44:47], s49 offen lds
    v_add_f32 v27, v27, v50
    v_fmac_f32 v31, v50, v50
    v_add_f32 v27, v27, v51
    v_fmac_f32 v31, v51, v51
    v_lshlrev_b32 v52, 16, v47
    v_and_b32 v53, 0xffff0000, v47
    v_add_f32 v27, v27, v52
    v_fmac_f32 v31, v52, v52
    v_add_f32 v27, v27, v53
    v_fmac_f32 v31, v53, v53
    s_add_u32 s48, s48, 128
    s_add_u32 s49, s49, 393216
    s_add_u32 s50, s50, 40960
    s_cmp_eq_u32 s50, 163840
    s_cselect_b32 s50, 0, s50
    s_sub_u32 s51, s51, 1
    s_cmp_lg_u32 s51, 0
    s_cbranch_scc1 L_qkv1_ld_loop
    s_waitcnt vmcnt(20)
    s_barrier
    v_add_u32 v48, s52, v2
    ds_read_b128 v[32:35], v48 offset:0
    ds_read_b128 v[36:39], v48 offset:1024
    ds_read_b128 v[40:43], v48 offset:2048
    ds_read_b128 v[44:47], v48 offset:3072
    s_add_u32 s52, s52, 40960
    s_cmp_eq_u32 s52, 163840
    s_cselect_b32 s52, 0, s52
    s_waitcnt lgkmcnt(3)
    v_lshlrev_b32 v50, 16, v32
    v_and_b32 v51, 0xffff0000, v32
    v_add_f32 v24, v24, v50
    v_fmac_f32 v28, v50, v50
    v_add_f32 v24, v24, v51
    v_fmac_f32 v28, v51, v51
    v_lshlrev_b32 v52, 16, v33
    v_and_b32 v53, 0xffff0000, v33
    v_add_f32 v24, v24, v52
    v_fmac_f32 v28, v52, v52
    v_add_f32 v24, v24, v53
    v_fmac_f32 v28, v53, v53
    v_lshlrev_b32 v50, 16, v34
    v_and_b32 v51, 0xffff0000, v34
    v_add_f32 v24, v24, v50
    v_fmac_f32 v28, v50, v50
    v_add_f32 v24, v24, v51
    v_fmac_f32 v28, v51, v51
    v_lshlrev_b32 v52, 16, v35
    v_and_b32 v53, 0xffff0000, v35
    v_add_f32 v24, v24, v52
    v_fmac_f32 v28, v52, v52
    v_add_f32 v24, v24, v53
    v_fmac_f32 v28, v53, v53
    s_waitcnt lgkmcnt(2)
    v_lshlrev_b32 v50, 16, v36
    v_and_b32 v51, 0xffff0000, v36
    v_add_f32 v25, v25, v50
    v_fmac_f32 v29, v50, v50
    v_add_f32 v25, v25, v51
    v_fmac_f32 v29, v51, v51
    v_lshlrev_b32 v52, 16, v37
    v_and_b32 v53, 0xffff0000, v37
    v_add_f32 v25, v25, v52
    v_fmac_f32 v29, v52, v52
    v_add_f32 v25, v25, v53
    v_fmac_f32 v29, v53, v53
    v_lshlrev_b32 v50, 16, v38
    v_and_b32 v51, 0xffff0000, v38
    v_add_f32 v25, v25, v50
    v_fmac_f32 v29, v50, v50
    v_add_f32 v25, v25, v51
    v_fmac_f32 v29, v51, v51
    v_lshlrev_b32 v52, 16, v39
    v_and_b32 v53, 0xffff0000, v39
    v_add_f32 v25, v25, v52
    v_fmac_f32 v29, v52, v52
    v_add_f32 v25, v25, v53
    v_fmac_f32 v29, v53, v53
    s_waitcnt lgkmcnt(1)
    v_lshlrev_b32 v50, 16, v40
    v_and_b32 v51, 0xffff0000, v40
    v_add_f32 v26, v26, v50
    v_fmac_f32 v30, v50, v50
    v_add_f32 v26, v26, v51
    v_fmac_f32 v30, v51, v51
    v_lshlrev_b32 v52, 16, v41
    v_and_b32 v53, 0xffff0000, v41
    v_add_f32 v26, v26, v52
    v_fmac_f32 v30, v52, v52
    v_add_f32 v26, v26, v53
    v_fmac_f32 v30, v53, v53
    v_lshlrev_b32 v50, 16, v42
    v_and_b32 v51, 0xffff0000, v42
    v_add_f32 v26, v26, v50
    v_fmac_f32 v30, v50, v50
    v_add_f32 v26, v26, v51
    v_fmac_f32 v30, v51, v51
    v_lshlrev_b32 v52, 16, v43
    v_and_b32 v53, 0xffff0000, v43
    v_add_f32 v26, v26, v52
    v_fmac_f32 v30, v52, v52
    v_add_f32 v26, v26, v53
    v_fmac_f32 v30, v53, v53
    s_waitcnt lgkmcnt(0)
    v_lshlrev_b32 v50, 16, v44
    v_and_b32 v51, 0xffff0000, v44
    v_add_f32 v27, v27, v50
    v_fmac_f32 v31, v50, v50
    v_add_f32 v27, v27, v51
    v_fmac_f32 v31, v51, v51
    v_lshlrev_b32 v52, 16, v45
    v_and_b32 v53, 0xffff0000, v45
    v_add_f32 v27, v27, v52
    v_fmac_f32 v31, v52, v52
    v_add_f32 v27, v27, v53
    v_fmac_f32 v31, v53, v53
    v_lshlrev_b32 v50, 16, v46
    v_and_b32 v51, 0xffff0000, v46
    v_add_f32 v27, v27, v50
    v_fmac_f32 v31, v50, v50
    v_add_f32 v27, v27, v51
    v_fmac_f32 v31, v51, v51
    v_lshlrev_b32 v52, 16, v47
    v_and_b32 v53, 0xffff0000, v47
    v_add_f32 v27, v27, v52
    v_fmac_f32 v31, v52, v52
    v_add_f32 v27, v27, v53
    v_fmac_f32 v31, v53, v53
    s_waitcnt vmcnt(10)
    s_barrier
    v_add_u32 v48, s52, v2
    ds_read_b128 v[32:35], v48 offset:0
    ds_read_b128 v[36:39], v48 offset:1024
    ds_read_b128 v[40:43], v48 offset:2048
    ds_read_b128 v[44:47], v48 offset:3072
    s_add_u32 s52, s52, 40960
    s_cmp_eq_u32 s52, 163840
    s_cselect_b32 s52, 0, s52
    s_waitcnt lgkmcnt(3)
    v_lshlrev_b32 v50, 16, v32
    v_and_b32 v51, 0xffff0000, v32
    v_add_f32 v24, v24, v50
    v_fmac_f32 v28, v50, v50
    v_add_f32 v24, v24, v51
    v_fmac_f32 v28, v51, v51
    v_lshlrev_b32 v52, 16, v33
    v_and_b32 v53, 0xffff0000, v33
    v_add_f32 v24, v24, v52
    v_fmac_f32 v28, v52, v52
    v_add_f32 v24, v24, v53
    v_fmac_f32 v28, v53, v53
    v_lshlrev_b32 v50, 16, v34
    v_and_b32 v51, 0xffff0000, v34
    v_add_f32 v24, v24, v50
    v_fmac_f32 v28, v50, v50
    v_add_f32 v24, v24, v51
    v_fmac_f32 v28, v51, v51
    v_lshlrev_b32 v52, 16, v35
    v_and_b32 v53, 0xffff0000, v35
    v_add_f32 v24, v24, v52
    v_fmac_f32 v28, v52, v52
    v_add_f32 v24, v24, v53
    v_fmac_f32 v28, v53, v53
    s_waitcnt lgkmcnt(2)
    v_lshlrev_b32 v50, 16, v36
    v_and_b32 v51, 0xffff0000, v36
    v_add_f32 v25, v25, v50
    v_fmac_f32 v29, v50, v50
    v_add_f32 v25, v25, v51
    v_fmac_f32 v29, v51, v51
    v_lshlrev_b32 v52, 16, v37
    v_and_b32 v53, 0xffff0000, v37
    v_add_f32 v25, v25, v52
    v_fmac_f32 v29, v52, v52
    v_add_f32 v25, v25, v53
    v_fmac_f32 v29, v53, v53
    v_lshlrev_b32 v50, 16, v38
    v_and_b32 v51, 0xffff0000, v38
    v_add_f32 v25, v25, v50
    v_fmac_f32 v29, v50, v50
    v_add_f32 v25, v25, v51
    v_fmac_f32 v29, v51, v51
    v_lshlrev_b32 v52, 16, v39
    v_and_b32 v53, 0xffff0000, v39
    v_add_f32 v25, v25, v52
    v_fmac_f32 v29, v52, v52
    v_add_f32 v25, v25, v53
    v_fmac_f32 v29, v53, v53
    s_waitcnt lgkmcnt(1)
    v_lshlrev_b32 v50, 16, v40
    v_and_b32 v51, 0xffff0000, v40
    v_add_f32 v26, v26, v50
    v_fmac_f32 v30, v50, v50
    v_add_f32 v26, v26, v51
    v_fmac_f32 v30, v51, v51
    v_lshlrev_b32 v52, 16, v41
    v_and_b32 v53, 0xffff0000, v41
    v_add_f32 v26, v26, v52
    v_fmac_f32 v30, v52, v52
    v_add_f32 v26, v26, v53
    v_fmac_f32 v30, v53, v53
    v_lshlrev_b32 v50, 16, v42
    v_and_b32 v51, 0xffff0000, v42
    v_add_f32 v26, v26, v50
    v_fmac_f32 v30, v50, v50
    v_add_f32 v26, v26, v51
    v_fmac_f32 v30, v51, v51
    v_lshlrev_b32 v52, 16, v43
    v_and_b32 v53, 0xffff0000, v43
    v_add_f32 v26, v26, v52
    v_fmac_f32 v30, v52, v52
    v_add_f32 v26, v26, v53
    v_fmac_f32 v30, v53, v53
    s_waitcnt lgkmcnt(0)
    v_lshlrev_b32 v50, 16, v44
    v_and_b32 v51, 0xffff0000, v44
    v_add_f32 v27, v27, v50
    v_fmac_f32 v31, v50, v50
    v_add_f32 v27, v27, v51
    v_fmac_f32 v31, v51, v51
    v_lshlrev_b32 v52, 16, v45
    v_and_b32 v53, 0xffff0000, v45
    v_add_f32 v27, v27, v52
    v_fmac_f32 v31, v52, v52
    v_add_f32 v27, v27, v53
    v_fmac_f32 v31, v53, v53
    v_lshlrev_b32 v50, 16, v46
    v_and_b32 v51, 0xffff0000, v46
    v_add_f32 v27, v27, v50
    v_fmac_f32 v31, v50, v50
    v_add_f32 v27, v27, v51
    v_fmac_f32 v31, v51, v51
    v_lshlrev_b32 v52, 16, v47
    v_and_b32 v53, 0xffff0000, v47
    v_add_f32 v27, v27, v52
    v_fmac_f32 v31, v52, v52
    v_add_f32 v27, v27, v53
    v_fmac_f32 v31, v53, v53
    s_waitcnt vmcnt(0)
    s_barrier
    v_add_u32 v48, s52, v2
    ds_read_b128 v[32:35], v48 offset:0
    ds_read_b128 v[36:39], v48 offset:1024
    ds_read_b128 v[40:43], v48 offset:2048
    ds_read_b128 v[44:47], v48 offset:3072
    s_add_u32 s52, s52, 40960
    s_cmp_eq_u32 s52, 163840
    s_cselect_b32 s52, 0, s52
    s_waitcnt lgkmcnt(3)
    v_lshlrev_b32 v50, 16, v32
    v_and_b32 v51, 0xffff0000, v32
    v_add_f32 v24, v24, v50
    v_fmac_f32 v28, v50, v50
    v_add_f32 v24, v24, v51
    v_fmac_f32 v28, v51, v51
    v_lshlrev_b32 v52, 16, v33
    v_and_b32 v53, 0xffff0000, v33
    v_add_f32 v24, v24, v52
    v_fmac_f32 v28, v52, v52
    v_add_f32 v24, v24, v53
    v_fmac_f32 v28, v53, v53
    v_lshlrev_b32 v50, 16, v34
    v_and_b32 v51, 0xffff0000, v34
    v_add_f32 v24, v24, v50
    v_fmac_f32 v28, v50, v50
    v_add_f32 v24, v24, v51
    v_fmac_f32 v28, v51, v51
    v_lshlrev_b32 v52, 16, v35
    v_and_b32 v53, 0xffff0000, v35
    v_add_f32 v24, v24, v52
    v_fmac_f32 v28, v52, v52
    v_add_f32 v24, v24, v53
    v_fmac_f32 v28, v53, v53
    s_waitcnt lgkmcnt(2)
    v_lshlrev_b32 v50, 16, v36
    v_and_b32 v51, 0xffff0000, v36
    v_add_f32 v25, v25, v50
    v_fmac_f32 v29, v50, v50
    v_add_f32 v25, v25, v51
    v_fmac_f32 v29, v51, v51
    v_lshlrev_b32 v52, 16, v37
    v_and_b32 v53, 0xffff0000, v37
    v_add_f32 v25, v25, v52
    v_fmac_f32 v29, v52, v52
    v_add_f32 v25, v25, v53
    v_fmac_f32 v29, v53, v53
    v_lshlrev_b32 v50, 16, v38
    v_and_b32 v51, 0xffff0000, v38
    v_add_f32 v25, v25, v50
    v_fmac_f32 v29, v50, v50
    v_add_f32 v25, v25, v51
    v_fmac_f32 v29, v51, v51
    v_lshlrev_b32 v52, 16, v39
    v_and_b32 v53, 0xffff0000, v39
    v_add_f32 v25, v25, v52
    v_fmac_f32 v29, v52, v52
    v_add_f32 v25, v25, v53
    v_fmac_f32 v29, v53, v53
    s_waitcnt lgkmcnt(1)
    v_lshlrev_b32 v50, 16, v40
    v_and_b32 v51, 0xffff0000, v40
    v_add_f32 v26, v26, v50
    v_fmac_f32 v30, v50, v50
    v_add_f32 v26, v26, v51
    v_fmac_f32 v30, v51, v51
    v_lshlrev_b32 v52, 16, v41
    v_and_b32 v53, 0xffff0000, v41
    v_add_f32 v26, v26, v52
    v_fmac_f32 v30, v52, v52
    v_add_f32 v26, v26, v53
    v_fmac_f32 v30, v53, v53
    v_lshlrev_b32 v50, 16, v42
    v_and_b32 v51, 0xffff0000, v42
    v_add_f32 v26, v26, v50
    v_fmac_f32 v30, v50, v50
    v_add_f32 v26, v26, v51
    v_fmac_f32 v30, v51, v51
    v_lshlrev_b32 v52, 16, v43
    v_and_b32 v53, 0xffff0000, v43
    v_add_f32 v26, v26, v52
    v_fmac_f32 v30, v52, v52
    v_add_f32 v26, v26, v53
    v_fmac_f32 v30, v53, v53
    s_waitcnt lgkmcnt(0)
    v_lshlrev_b32 v50, 16, v44
    v_and_b32 v51, 0xffff0000, v44
    v_add_f32 v27, v27, v50
    v_fmac_f32 v31, v50, v50
    v_add_f32 v27, v27, v51
    v_fmac_f32 v31, v51, v51
    v_lshlrev_b32 v52, 16, v45
    v_and_b32 v53, 0xffff0000, v45
    v_add_f32 v27, v27, v52
    v_fmac_f32 v31, v52, v52
    v_add_f32 v27, v27, v53
    v_fmac_f32 v31, v53, v53
    v_lshlrev_b32 v50, 16, v46
    v_and_b32 v51, 0xffff0000, v46
    v_add_f32 v27, v27, v50
    v_fmac_f32 v31, v50, v50
    v_add_f32 v27, v27, v51
    v_fmac_f32 v31, v51, v51
    v_lshlrev_b32 v52, 16, v47
    v_and_b32 v53, 0xffff0000, v47
    v_add_f32 v27, v27, v52
    v_fmac_f32 v31, v52, v52
    v_add_f32 v27, v27, v53
    v_fmac_f32 v31, v53, v53
    v_add_f32_dpp v24, v24, v24 quad_perm:[1,0,3,2] row_mask:0xf bank_mask:0xf
    v_add_f32_dpp v25, v25, v25 quad_perm:[1,0,3,2] row_mask:0xf bank_mask:0xf
    v_add_f32_dpp v26, v26, v26 quad_perm:[1,0,3,2] row_mask:0xf bank_mask:0xf
    v_add_f32_dpp v27, v27, v27 quad_perm:[1,0,3,2] row_mask:0xf bank_mask:0xf
    v_add_f32_dpp v28, v28, v28 quad_perm:[1,0,3,2] row_mask:0xf bank_mask:0xf
    v_add_f32_dpp v29, v29, v29 quad_perm:[1,0,3,2] row_mask:0xf bank_mask:0xf
    v_add_f32_dpp v30, v30, v30 quad_perm:[1,0,3,2] row_mask:0xf bank_mask:0xf
    v_add_f32_dpp v31, v31, v31 quad_perm:[1,0,3,2] row_mask:0xf bank_mask:0xf
    v_add_f32_dpp v24, v24, v24 quad_perm:[2,3,0,1] row_mask:0xf bank_mask:0xf
    v_add_f32_dpp v25, v25, v25 quad_perm:[2,3,0,1] row_mask:0xf bank_mask:0xf
    v_add_f32_dpp v26, v26, v26 quad_perm:[2,3,0,1] row_mask:0xf bank_mask:0xf
    v_add_f32_dpp v27, v27, v27 quad_perm:[2,3,0,1] row_mask:0xf bank_mask:0xf
    v_add_f32_dpp v28, v28, v28 quad_perm:[2,3,0,1] row_mask:0xf bank_mask:0xf
    v_add_f32_dpp v29, v29, v29 quad_perm:[2,3,0,1] row_mask:0xf bank_mask:0xf
    v_add_f32_dpp v30, v30, v30 quad_perm:[2,3,0,1] row_mask:0xf bank_mask:0xf
    v_add_f32_dpp v31, v31, v31 quad_perm:[2,3,0,1] row_mask:0xf bank_mask:0xf
    v_add_f32_dpp v24, v24, v24 row_half_mirror row_mask:0xf bank_mask:0xf
    v_add_f32_dpp v25, v25, v25 row_half_mirror row_mask:0xf bank_mask:0xf
    v_add_f32_dpp v26, v26, v26 row_half_mirror row_mask:0xf bank_mask:0xf
    v_add_f32_dpp v27, v27, v27 row_half_mirror row_mask:0xf bank_mask:0xf
    v_add_f32_dpp v28, v28, v28 row_half_mirror row_mask:0xf bank_mask:0xf
    v_add_f32_dpp v29, v29, v29 row_half_mirror row_mask:0xf bank_mask:0xf
    v_add_f32_dpp v30, v30, v30 row_half_mirror row_mask:0xf bank_mask:0xf
    v_add_f32_dpp v31, v31, v31 row_half_mirror row_mask:0xf bank_mask:0xf
    v_lshrrev_b32 v3, 3, v0
    v_lshlrev_b32 v3, 2, v3
    s_lshl_b32 s4, s10, 7
    s_add_u32 s4, s4, 98304
    v_add_u32 v3, s4, v3
    v_mul_f32 v24, 0x3a800000, v24
    v_mul_f32 v28, 0x3a800000, v28
    v_fma_f32 v28, -v24, v24, v28
    v_max_f32 v28, 0, v28
    v_add_f32 v36, 0x3727c5ac, v28
    v_rsq_f32 v32, v36
    s_nop 0
    v_mul_f32 v24, v24, v32
    v_sub_f32 v24, 0, v24
    ds_write_b32 v3, v32 offset:0
    ds_write_b32 v3, v24 offset:512
    v_mul_f32 v25, 0x3a800000, v25
    v_mul_f32 v29, 0x3a800000, v29
    v_fma_f32 v29, -v25, v25, v29
    v_max_f32 v29, 0, v29
    v_add_f32 v37, 0x3727c5ac, v29
    v_rsq_f32 v33, v37
    s_nop 0
    v_mul_f32 v25, v25, v33
    v_sub_f32 v25, 0, v25
    ds_write_b32 v3, v33 offset:32
    ds_write_b32 v3, v25 offset:544
    v_mul_f32 v26, 0x3a800000, v26
    v_mul_f32 v30, 0x3a800000, v30
    v_fma_f32 v30, -v26, v26, v30
    v_max_f32 v30, 0, v30
    v_add_f32 v38, 0x3727c5ac, v30
    v_rsq_f32 v34, v38
    s_nop 0
    v_mul_f32 v26, v26, v34
    v_sub_f32 v26, 0, v26
    ds_write_b32 v3, v34 offset:64
    ds_write_b32 v3, v26 offset:576
    v_mul_f32 v27, 0x3a800000, v27
    v_mul_f32 v31, 0x3a800000, v31
    v_fma_f32 v31, -v27, v27, v31
    v_max_f32 v31, 0, v31
    v_add_f32 v39, 0x3727c5ac, v31
    v_rsq_f32 v35, v39
    s_nop 0
    v_mul_f32 v27, v27, v35
    v_sub_f32 v27, 0, v27
    ds_write_b32 v3, v35 offset:96
    ds_write_b32 v3, v27 offset:608
    s_waitcnt lgkmcnt(0)
    s_barrier
    s_cmp_lg_u32 s10, 0
    s_cbranch_scc1 L_g0_kernel_end
    s_cmp_ge_u32 s2, 16
    s_cbranch_scc1 L_g0_kernel_npf_skip
    s_getpc_b64 s[60:61]
L_g0_kernel_npf_pc:
    s_add_u32 s60, s60, rest_kernel-L_g0_kernel_npf_pc
    s_addc_u32 s61, s61, 0
    v_and_b32 v4, 63, v0
    v_lshlrev_b32 v4, 7, v4
    v_min_u32 v5, L_text_end-rest_kernel-4, v4
    global_load_dword v6, v5, s[60:61]
    v_add_u32 v4, 8192, v4
    v_min_u32 v5, L_text_end-rest_kernel-4, v4
    global_load_dword v6, v5, s[60:61]
    v_add_u32 v4, 8192, v4
    v_min_u32 v5, L_text_end-rest_kernel-4, v4
    global_load_dword v6, v5, s[60:61]
    v_add_u32 v4, 8192, v4
    v_min_u32 v5, L_text_end-rest_kernel-4, v4
    global_load_dword v6, v5, s[60:61]
L_g0_kernel_npf_skip:
    s_branch L_g0_kernel_end
L_g0_kernel_compute:
    s_and_b32 s4, s2, 7
    s_lshr_b32 s5, s2, 3
    s_and_b32 s6, s4, 3
    s_lshr_b32 s7, s4, 2
    s_mul_i32 s9, s6, 4
    s_and_b32 s6, s5, 3
    s_add_u32 s9, s9, s6
    s_mul_i32 s8, s7, 8
    s_lshr_b32 s6, s5, 2
    s_add_u32 s8, s8, s6
    s_and_b32 s11, s10, 1
    s_lshr_b32 s12, s10, 1
    s_lshl_b32 s14, s11, 1
    s_add_u32 s14, s14, s12
    s_xor_b32 s15, s14, 1
    v_and_b32 v2, 31, v0
    v_lshrrev_b32 v3, 5, v0
    s_lshl_b32 s6, s14, 12
    s_lshl_b32 s7, s15, 12
    v_lshrrev_b32 v4, 1, v2
    v_and_b32 v4, 7, v4
    v_xor_b32 v4, v4, v3
    v_lshlrev_b32 v4, 4, v4
    v_lshl_add_u32 v4, v2, 7, v4
    v_xor_b32 v5, 0, v4
    v_add_u32 v8, s6, v5
    v_add_u32 v12, s7, v5
    v_xor_b32 v5, 32, v4
    v_add_u32 v9, s6, v5
    v_add_u32 v13, s7, v5
    v_xor_b32 v5, 64, v4
    v_add_u32 v10, s6, v5
    v_add_u32 v14, s7, v5
    v_xor_b32 v5, 96, v4
    v_add_u32 v11, s6, v5
    v_add_u32 v15, s7, v5
    v_lshlrev_b32 v4, 9, v3
    v_bfe_u32 v5, v0, 2, 2
    v_lshl_add_u32 v4, v5, 6, v4
    v_bfe_u32 v5, v0, 4, 1
    v_lshl_add_u32 v4, v5, 5, v4
    v_and_b32 v5, 3, v0
    v_lshl_add_u32 v4, v5, 3, v4
    s_mul_i32 s4, s12, 4096
    s_add_u32 s4, s4, 16384
    v_add_u32 v24, s4, v4
    v_mov_b32 v92, 0
    v_mov_b32 v93, 0
    v_mov_b32 v94, 0
    v_mov_b32 v95, 0
    v_mov_b32 v96, 0
    v_mov_b32 v97, 0
    v_mov_b32 v98, 0
    v_mov_b32 v99, 0
    v_mov_b32 v100, 0
    v_mov_b32 v101, 0
    v_mov_b32 v102, 0
    v_mov_b32 v103, 0
    v_mov_b32 v104, 0
    v_mov_b32 v105, 0
    v_mov_b32 v106, 0
    v_mov_b32 v107, 0
    v_mov_b32 v108, 0
    v_mov_b32 v109, 0
    v_mov_b32 v110, 0
    v_mov_b32 v111, 0
    v_mov_b32 v112, 0
    v_mov_b32 v113, 0
    v_mov_b32 v114, 0
    v_mov_b32 v115, 0
    v_mov_b32 v116, 0
    v_mov_b32 v117, 0
    v_mov_b32 v118, 0
    v_mov_b32 v119, 0
    v_mov_b32 v120, 0
    v_mov_b32 v121, 0
    v_mov_b32 v122, 0
    v_mov_b32 v123, 0
    v_mov_b32 v124, 0
    v_mov_b32 v125, 0
    v_mov_b32 v126, 0
    v_mov_b32 v127, 0
    v_mov_b32 v128, 0
    v_mov_b32 v129, 0
    v_mov_b32 v130, 0
    v_mov_b32 v131, 0
    v_mov_b32 v132, 0
    v_mov_b32 v133, 0
    v_mov_b32 v134, 0
    v_mov_b32 v135, 0
    v_mov_b32 v136, 0
    v_mov_b32 v137, 0
    v_mov_b32 v138, 0
    v_mov_b32 v139, 0
    v_mov_b32 v140, 0
    v_mov_b32 v141, 0
    v_mov_b32 v142, 0
    v_mov_b32 v143, 0
    v_mov_b32 v144, 0
    v_mov_b32 v145, 0
    v_mov_b32 v146, 0
    v_mov_b32 v147, 0
    v_mov_b32 v148, 0
    v_mov_b32 v149, 0
    v_mov_b32 v150, 0
    v_mov_b32 v151, 0
    v_mov_b32 v152, 0
    v_mov_b32 v153, 0
    v_mov_b32 v154, 0
    v_mov_b32 v155, 0
    v_mov_b32 v156, 0
    v_mov_b32 v157, 0
    v_mov_b32 v158, 0
    v_mov_b32 v159, 0
    v_mov_b32 v160, 0
    v_mov_b32 v161, 0
    v_mov_b32 v162, 0
    v_mov_b32 v163, 0
    v_mov_b32 v164, 0
    v_mov_b32 v165, 0
    v_mov_b32 v166, 0
    v_mov_b32 v167, 0
    v_mov_b32 v168, 0
    v_mov_b32 v169, 0
    v_mov_b32 v170, 0
    v_mov_b32 v171, 0
    v_mov_b32 v172, 0
    v_mov_b32 v173, 0
    v_mov_b32 v174, 0
    v_mov_b32 v175, 0
    v_mov_b32 v176, 0
    v_mov_b32 v177, 0
    v_mov_b32 v178, 0
    v_mov_b32 v179, 0
    v_mov_b32 v180, 0
    v_mov_b32 v181, 0
    v_mov_b32 v182, 0
    v_mov_b32 v183, 0
    v_mov_b32 v184, 0
    v_mov_b32 v185, 0
    v_mov_b32 v186, 0
    v_mov_b32 v187, 0
    v_mov_b32 v40, 0
    v_mov_b32 v41, 0
    v_mov_b32 v42, 0
    v_mov_b32 v43, 0
    v_mov_b32 v44, 0
    v_mov_b32 v45, 0
    v_mov_b32 v46, 0
    v_mov_b32 v47, 0
    v_mov_b32 v48, 0
    v_mov_b32 v49, 0
    v_mov_b32 v50, 0
    v_mov_b32 v51, 0
    v_lshrrev_b32 v4, 4, v0
    v_xor_b32 v4, v4, v0
    v_and_b32 v4, 1, v4
    v_cmp_eq_u32 vcc, 0, v4
    v_mov_b32 v5, 0x3f803f80
    s_nop 0
    v_cndmask_b32 v36, 0, v5, vcc
    v_mov_b32 v37, v36
    v_mov_b32 v38, v36
    v_mov_b32 v39, v36
    s_mov_b32 s4, s11
    s_mov_b32 s5, 0
    s_mov_b64 vcc, s[4:5]
    s_waitcnt lgkmcnt(0)
    s_add_u32 s52, s36, 48234496
    s_addc_u32 s53, s37, 0
    s_mov_b32 s54, 2097152
    s_mov_b32 s55, 0x20000
    s_lshl_b32 s4, s2, 13
    s_lshl_b32 s5, s10, 11
    s_add_u32 s4, s4, s5
    v_lshlrev_b32 v4, 4, v0
    buffer_store_dwordx4 v[92:95], v4, s[52:55], s4 offen sc1
    buffer_store_dwordx4 v[92:95], v4, s[52:55], s4 offen offset:1024 sc1
    s_add_u32 s4, s9, 0
    s_and_b32 s4, s4, 15
    s_lshl_b32 s4, s4, 1
    s_add_u32 s60, s4, s12
    s_lshl_b32 s4, s60, 7
    s_add_u32 s56, s4, 0
    s_add_u32 s4, s9, 1
    s_and_b32 s4, s4, 15
    s_lshl_b32 s4, s4, 1
    s_add_u32 s61, s4, s12
    s_lshl_b32 s4, s61, 7
    s_add_u32 s57, s4, 4096
    s_add_u32 s4, s9, 2
    s_and_b32 s4, s4, 15
    s_lshl_b32 s4, s4, 1
    s_add_u32 s62, s4, s12
    s_lshl_b32 s4, s62, 7
    s_add_u32 s58, s4, 8192
    s_add_u32 s44, s36, 46137344
    s_addc_u32 s45, s37, 0
    s_mov_b32 s46, 12288
    s_mov_b32 s47, 0x20000
    s_mov_b32 s13, 0
    s_mov_b32 s51, 15
    v_add_u32 v16, s13, v8
    v_add_u32 v17, s13, v9
    v_add_u32 v18, s13, v10
    v_add_u32 v19, s13, v11
    v_add_u32 v20, s13, v12
    v_add_u32 v21, s13, v13
    v_add_u32 v22, s13, v14
    v_add_u32 v23, s13, v15
    v_add_u32 v26, s13, v24
    s_add_u32 s13, s13, 40960
    s_cmp_eq_u32 s13, 163840
    s_cselect_b32 s13, 0, s13
    s_barrier
    ds_read_b128 v[52:55], v16
    ds_read_b64_tr_b16 v[60:61], v26 offset:0
    ds_read_b64_tr_b16 v[62:63], v26 offset:256
    ds_read_b128 v[56:59], v20
    ds_read_b64_tr_b16 v[64:65], v26 offset:8192
    ds_read_b64_tr_b16 v[66:67], v26 offset:8448
    ds_read_b64_tr_b16 v[68:69], v26 offset:16384
    ds_read_b64_tr_b16 v[70:71], v26 offset:16640
L_qkv1_c_loop:
    s_waitcnt lgkmcnt(5)
    v_mfma_f32_32x32x16_bf16 v[92:107], v[60:63], v[52:55], v[92:107]
    ds_read_b128 v[72:75], v17
    ds_read_b64_tr_b16 v[80:81], v26 offset:1024
    ds_read_b64_tr_b16 v[82:83], v26 offset:1280
    ds_read_b128 v[76:79], v21
    s_waitcnt lgkmcnt(8)
    v_mfma_f32_32x32x16_bf16 v[108:123], v[60:63], v[56:59], v[108:123]
    ds_read_b64_tr_b16 v[84:85], v26 offset:9216
    ds_read_b64_tr_b16 v[86:87], v26 offset:9472
    ds_read_b64_tr_b16 v[88:89], v26 offset:17408
    ds_read_b64_tr_b16 v[90:91], v26 offset:17664
    s_waitcnt lgkmcnt(10)
    v_mfma_f32_32x32x16_bf16 v[124:139], v[64:67], v[52:55], v[124:139]
    v_mfma_f32_32x32x16_bf16 v[140:155], v[64:67], v[56:59], v[140:155]
    s_waitcnt lgkmcnt(8)
    v_mfma_f32_32x32x16_bf16 v[156:171], v[52:55], v[68:71], v[156:171]
    v_mfma_f32_32x32x16_bf16 v[172:187], v[56:59], v[68:71], v[172:187]
    s_cbranch_vccnz L_qkv1_cs1
    v_mfma_f32_16x16x32_bf16 v[40:43], v[60:63], v[36:39], v[40:43]
    v_mfma_f32_16x16x32_bf16 v[44:47], v[64:67], v[36:39], v[44:47]
    v_mfma_f32_16x16x32_bf16 v[48:51], v[68:71], v[36:39], v[48:51]
L_qkv1_cs1:
    s_waitcnt lgkmcnt(5)
    v_mfma_f32_32x32x16_bf16 v[92:107], v[80:83], v[72:75], v[92:107]
    ds_read_b128 v[52:55], v18
    ds_read_b64_tr_b16 v[60:61], v26 offset:2048
    ds_read_b64_tr_b16 v[62:63], v26 offset:2304
    ds_read_b128 v[56:59], v22
    s_waitcnt lgkmcnt(8)
    v_mfma_f32_32x32x16_bf16 v[108:123], v[80:83], v[76:79], v[108:123]
    ds_read_b64_tr_b16 v[64:65], v26 offset:10240
    ds_read_b64_tr_b16 v[66:67], v26 offset:10496
    ds_read_b64_tr_b16 v[68:69], v26 offset:18432
    ds_read_b64_tr_b16 v[70:71], v26 offset:18688
    s_waitcnt lgkmcnt(10)
    v_mfma_f32_32x32x16_bf16 v[124:139], v[84:87], v[72:75], v[124:139]
    v_mfma_f32_32x32x16_bf16 v[140:155], v[84:87], v[76:79], v[140:155]
    s_waitcnt lgkmcnt(8)
    v_mfma_f32_32x32x16_bf16 v[156:171], v[72:75], v[88:91], v[156:171]
    v_mfma_f32_32x32x16_bf16 v[172:187], v[76:79], v[88:91], v[172:187]
    s_cbranch_vccz L_qkv1_cs2
    v_mfma_f32_16x16x32_bf16 v[40:43], v[80:83], v[36:39], v[40:43]
    v_mfma_f32_16x16x32_bf16 v[44:47], v[84:87], v[36:39], v[44:47]
    v_mfma_f32_16x16x32_bf16 v[48:51], v[88:91], v[36:39], v[48:51]
L_qkv1_cs2:
    s_waitcnt lgkmcnt(5)
    v_mfma_f32_32x32x16_bf16 v[92:107], v[60:63], v[52:55], v[92:107]
    ds_read_b128 v[72:75], v19
    ds_read_b64_tr_b16 v[80:81], v26 offset:3072
    ds_read_b64_tr_b16 v[82:83], v26 offset:3328
    ds_read_b128 v[76:79], v23
    s_waitcnt lgkmcnt(8)
    v_mfma_f32_32x32x16_bf16 v[108:123], v[60:63], v[56:59], v[108:123]
    ds_read_b64_tr_b16 v[84:85], v26 offset:11264
    ds_read_b64_tr_b16 v[86:87], v26 offset:11520
    ds_read_b64_tr_b16 v[88:89], v26 offset:19456
    ds_read_b64_tr_b16 v[90:91], v26 offset:19712
    s_waitcnt lgkmcnt(10)
    v_mfma_f32_32x32x16_bf16 v[124:139], v[64:67], v[52:55], v[124:139]
    v_mfma_f32_32x32x16_bf16 v[140:155], v[64:67], v[56:59], v[140:155]
    s_waitcnt lgkmcnt(8)
    v_mfma_f32_32x32x16_bf16 v[156:171], v[52:55], v[68:71], v[156:171]
    v_mfma_f32_32x32x16_bf16 v[172:187], v[56:59], v[68:71], v[172:187]
    s_cbranch_vccnz L_qkv1_cs3
    v_mfma_f32_16x16x32_bf16 v[40:43], v[60:63], v[36:39], v[40:43]
    v_mfma_f32_16x16x32_bf16 v[44:47], v[64:67], v[36:39], v[44:47]
    v_mfma_f32_16x16x32_bf16 v[48:51], v[68:71], v[36:39], v[48:51]
L_qkv1_cs3:
    s_waitcnt lgkmcnt(0)
    v_add_u32 v16, s13, v8
    v_add_u32 v17, s13, v9
    v_add_u32 v18, s13, v10
    v_add_u32 v19, s13, v11
    v_add_u32 v20, s13, v12
    v_add_u32 v21, s13, v13
    v_add_u32 v22, s13, v14
    v_add_u32 v23, s13, v15
    v_add_u32 v26, s13, v24
    s_add_u32 s13, s13, 40960
    s_cmp_eq_u32 s13, 163840
    s_cselect_b32 s13, 0, s13
    s_barrier
    v_mfma_f32_32x32x16_bf16 v[92:107], v[80:83], v[72:75], v[92:107]
    ds_read_b128 v[52:55], v16
    ds_read_b64_tr_b16 v[60:61], v26 offset:0
    ds_read_b64_tr_b16 v[62:63], v26 offset:256
    ds_read_b128 v[56:59], v20
    v_mfma_f32_32x32x16_bf16 v[108:123], v[80:83], v[76:79], v[108:123]
    ds_read_b64_tr_b16 v[64:65], v26 offset:8192
    ds_read_b64_tr_b16 v[66:67], v26 offset:8448
    ds_read_b64_tr_b16 v[68:69], v26 offset:16384
    ds_read_b64_tr_b16 v[70:71], v26 offset:16640
    v_mfma_f32_32x32x16_bf16 v[124:139], v[84:87], v[72:75], v[124:139]
    v_mfma_f32_32x32x16_bf16 v[140:155], v[84:87], v[76:79], v[140:155]
    v_mfma_f32_32x32x16_bf16 v[156:171], v[72:75], v[88:91], v[156:171]
    v_mfma_f32_32x32x16_bf16 v[172:187], v[76:79], v[88:91], v[172:187]
    s_cbranch_vccz L_qkv1_cs4
    v_mfma_f32_16x16x32_bf16 v[40:43], v[80:83], v[36:39], v[40:43]
    v_mfma_f32_16x16x32_bf16 v[44:47], v[84:87], v[36:39], v[44:47]
    v_mfma_f32_16x16x32_bf16 v[48:51], v[88:91], v[36:39], v[48:51]
L_qkv1_cs4:
    s_sub_u32 s51, s51, 1
    s_cmp_lg_u32 s51, 0
    s_cbranch_scc1 L_qkv1_c_loop
    s_waitcnt lgkmcnt(5)
    v_mfma_f32_32x32x16_bf16 v[92:107], v[60:63], v[52:55], v[92:107]
    ds_read_b128 v[72:75], v17
    ds_read_b64_tr_b16 v[80:81], v26 offset:1024
    ds_read_b64_tr_b16 v[82:83], v26 offset:1280
    ds_read_b128 v[76:79], v21
    s_waitcnt lgkmcnt(8)
    v_mfma_f32_32x32x16_bf16 v[108:123], v[60:63], v[56:59], v[108:123]
    ds_read_b64_tr_b16 v[84:85], v26 offset:9216
    ds_read_b64_tr_b16 v[86:87], v26 offset:9472
    ds_read_b64_tr_b16 v[88:89], v26 offset:17408
    ds_read_b64_tr_b16 v[90:91], v26 offset:17664
    s_waitcnt lgkmcnt(10)
    v_mfma_f32_32x32x16_bf16 v[124:139], v[64:67], v[52:55], v[124:139]
    v_mfma_f32_32x32x16_bf16 v[140:155], v[64:67], v[56:59], v[140:155]
    s_waitcnt lgkmcnt(8)
    v_mfma_f32_32x32x16_bf16 v[156:171], v[52:55], v[68:71], v[156:171]
    v_mfma_f32_32x32x16_bf16 v[172:187], v[56:59], v[68:71], v[172:187]
    s_cbranch_vccnz L_qkv1_cs5
    v_mfma_f32_16x16x32_bf16 v[40:43], v[60:63], v[36:39], v[40:43]
    v_mfma_f32_16x16x32_bf16 v[44:47], v[64:67], v[36:39], v[44:47]
    v_mfma_f32_16x16x32_bf16 v[48:51], v[68:71], v[36:39], v[48:51]
L_qkv1_cs5:
    s_waitcnt lgkmcnt(5)
    v_mfma_f32_32x32x16_bf16 v[92:107], v[80:83], v[72:75], v[92:107]
    ds_read_b128 v[52:55], v18
    ds_read_b64_tr_b16 v[60:61], v26 offset:2048
    ds_read_b64_tr_b16 v[62:63], v26 offset:2304
    ds_read_b128 v[56:59], v22
    s_waitcnt lgkmcnt(8)
    v_mfma_f32_32x32x16_bf16 v[108:123], v[80:83], v[76:79], v[108:123]
    ds_read_b64_tr_b16 v[64:65], v26 offset:10240
    ds_read_b64_tr_b16 v[66:67], v26 offset:10496
    ds_read_b64_tr_b16 v[68:69], v26 offset:18432
    ds_read_b64_tr_b16 v[70:71], v26 offset:18688
    s_waitcnt lgkmcnt(10)
    v_mfma_f32_32x32x16_bf16 v[124:139], v[84:87], v[72:75], v[124:139]
    v_mfma_f32_32x32x16_bf16 v[140:155], v[84:87], v[76:79], v[140:155]
    s_waitcnt lgkmcnt(8)
    v_mfma_f32_32x32x16_bf16 v[156:171], v[72:75], v[88:91], v[156:171]
    v_mfma_f32_32x32x16_bf16 v[172:187], v[76:79], v[88:91], v[172:187]
    s_cbranch_vccz L_qkv1_cs6
    v_mfma_f32_16x16x32_bf16 v[40:43], v[80:83], v[36:39], v[40:43]
    v_mfma_f32_16x16x32_bf16 v[44:47], v[84:87], v[36:39], v[44:47]
    v_mfma_f32_16x16x32_bf16 v[48:51], v[88:91], v[36:39], v[48:51]
L_qkv1_cs6:
    s_waitcnt lgkmcnt(5)
    v_mfma_f32_32x32x16_bf16 v[92:107], v[60:63], v[52:55], v[92:107]
    ds_read_b128 v[72:75], v19
    ds_read_b64_tr_b16 v[80:81], v26 offset:3072
    ds_read_b64_tr_b16 v[82:83], v26 offset:3328
    ds_read_b128 v[76:79], v23
    s_waitcnt lgkmcnt(8)
    v_mfma_f32_32x32x16_bf16 v[108:123], v[60:63], v[56:59], v[108:123]
    ds_read_b64_tr_b16 v[84:85], v26 offset:11264
    ds_read_b64_tr_b16 v[86:87], v26 offset:11520
    ds_read_b64_tr_b16 v[88:89], v26 offset:19456
    ds_read_b64_tr_b16 v[90:91], v26 offset:19712
    s_waitcnt lgkmcnt(10)
    v_mfma_f32_32x32x16_bf16 v[124:139], v[64:67], v[52:55], v[124:139]
    v_mfma_f32_32x32x16_bf16 v[140:155], v[64:67], v[56:59], v[140:155]
    s_waitcnt lgkmcnt(8)
    v_mfma_f32_32x32x16_bf16 v[156:171], v[52:55], v[68:71], v[156:171]
    v_mfma_f32_32x32x16_bf16 v[172:187], v[56:59], v[68:71], v[172:187]
    s_cbranch_vccnz L_qkv1_cs7
    v_mfma_f32_16x16x32_bf16 v[40:43], v[60:63], v[36:39], v[40:43]
    v_mfma_f32_16x16x32_bf16 v[44:47], v[64:67], v[36:39], v[44:47]
    v_mfma_f32_16x16x32_bf16 v[48:51], v[68:71], v[36:39], v[48:51]
L_qkv1_cs7:
    s_waitcnt lgkmcnt(5)
    v_mfma_f32_32x32x16_bf16 v[92:107], v[80:83], v[72:75], v[92:107]
    s_waitcnt lgkmcnt(4)
    v_mfma_f32_32x32x16_bf16 v[108:123], v[80:83], v[76:79], v[108:123]
    s_waitcnt lgkmcnt(2)
    v_mfma_f32_32x32x16_bf16 v[124:139], v[84:87], v[72:75], v[124:139]
    v_mfma_f32_32x32x16_bf16 v[140:155], v[84:87], v[76:79], v[140:155]
    s_waitcnt lgkmcnt(0)
    v_mfma_f32_32x32x16_bf16 v[156:171], v[72:75], v[88:91], v[156:171]
    v_mfma_f32_32x32x16_bf16 v[172:187], v[76:79], v[88:91], v[172:187]
    s_cbranch_vccz L_qkv1_cs8
    v_mfma_f32_16x16x32_bf16 v[40:43], v[80:83], v[36:39], v[40:43]
    v_mfma_f32_16x16x32_bf16 v[44:47], v[84:87], v[36:39], v[44:47]
    v_mfma_f32_16x16x32_bf16 v[48:51], v[88:91], v[36:39], v[48:51]
L_qkv1_cs8:
    s_lshl_b32 s4, s10, 11
    s_add_u32 s4, s4, 99328
    v_lshlrev_b32 v4, 2, v2
    v_add_u32 v4, s4, v4
    v_lshlrev_b32 v5, 4, v3
    v_add_u32 v5, s4, v5
    v_and_b32 v6, 1, v0
    v_lshlrev_b32 v6, 6, v6
    v_lshrrev_b32 v7, 4, v0
    v_lshl_add_u32 v6, v7, 4, v6
    v_add_u32 v6, s4, v6
    ds_write_b128 v6, v[40:43] offset:1024
    ds_write_b128 v6, v[44:47] offset:1152
    ds_write_b128 v6, v[48:51] offset:1280
    s_waitcnt vmcnt(0)
    s_waitcnt lgkmcnt(0)
    s_barrier
    s_xor_b32 s5, s10, 1
    s_lshl_b32 s5, s5, 11
    s_add_u32 s5, s5, 99328
    v_lshlrev_b32 v7, 2, v2
    v_add_u32 v6, s5, v7
    ds_read_b32 v28, v4 offset:1024
    ds_read_b32 v40, v6 offset:1024
    ds_read_b32 v29, v4 offset:1152
    ds_read_b32 v41, v6 offset:1152
    ds_read_b32 v30, v4 offset:1280
    ds_read_b32 v42, v6 offset:1280
    s_waitcnt lgkmcnt(0)
    v_add_f32 v28, v28, v40
    v_add_f32 v29, v29, v41
    v_add_f32 v30, v30, v42
    s_or_b32 s5, s8, s11
    s_cmp_lg_u32 s5, 0
    s_cbranch_scc1 L_qkv1_nocs
    buffer_store_dword v28, v7, s[44:47], s56 offen sc1
    buffer_store_dword v29, v7, s[44:47], s57 offen sc1
    buffer_store_dword v30, v7, s[44:47], s58 offen sc1
L_qkv1_nocs:
    ds_write_b32 v4, v28 offset:0
    ds_write_b32 v4, v29 offset:128
    ds_write_b32 v4, v30 offset:256
    s_waitcnt lgkmcnt(0)
    s_add_u32 s40, s36, 0
    s_addc_u32 s41, s37, 0
    s_mov_b32 s42, 12582912
    s_mov_b32 s43, 0x20000
    s_lshl_b32 s7, s14, 7
    s_add_u32 s7, s7, 98304
    s_lshl_b32 s5, s8, 2
    s_add_u32 s5, s5, s14
    s_lshl_b32 s4, s60, 6
    s_add_u32 s4, s4, s5
    s_lshl_b32 s14, s4, 11
    s_lshl_b32 s4, s61, 6
    s_add_u32 s4, s4, s5
    s_lshl_b32 s15, s4, 12
    s_add_u32 s15, s15, 4194304
    s_lshl_b32 s4, s62, 6
    s_add_u32 s4, s4, s5
    s_lshl_b32 s13, s4, 12
    s_add_u32 s13, s13, 4194304
    v_lshlrev_b32 v6, 4, v0
    v_lshlrev_b32 v10, 2, v2
    v_add_u32 v10, s7, v10
    v_xor_b32 v11, 128, v10
    v_lshlrev_b32 v8, 4, v3
    v_add_u32 v8, s7, v8
    v_xor_b32 v9, 128, v8
    ds_read_b128 v[188:191], v5 offset:0
    ds_read_b128 v[204:207], v5 offset:128
    ds_read_b128 v[192:195], v5 offset:32
    ds_read_b128 v[208:211], v5 offset:160
    ds_read_b128 v[196:199], v5 offset:64
    ds_read_b128 v[212:215], v5 offset:192
    ds_read_b128 v[200:203], v5 offset:96
    ds_read_b128 v[216:219], v5 offset:224
    ds_read_b32 v220, v10
    ds_read_b32 v221, v10 offset:512
    ds_read_b32 v222, v11
    ds_read_b32 v223, v11 offset:512
    s_waitcnt lgkmcnt(0)
    v_mul_f32 v224, 0x3e8293ee, v220
    v_mul_f32 v225, 0x3e8293ee, v221
    v_mul_f32 v226, 0x3e8293ee, v222
    v_mul_f32 v227, 0x3e8293ee, v223
    ds_read_b128 v[52:55], v8 offset:0
    ds_read_b128 v[68:71], v8 offset:512
    ds_read_b128 v[56:59], v8 offset:32
    ds_read_b128 v[72:75], v8 offset:544
    ds_read_b128 v[60:63], v8 offset:64
    ds_read_b128 v[76:79], v8 offset:576
    ds_read_b128 v[64:67], v8 offset:96
    ds_read_b128 v[80:83], v8 offset:608
    v_pk_mul_f32 v[228:229], v[188:189], v[224:225] op_sel:[0,1]
    v_pk_mul_f32 v[230:231], v[190:191], v[224:225] op_sel:[0,1]
    v_pk_mul_f32 v[232:233], v[192:193], v[224:225] op_sel:[0,1]
    v_pk_mul_f32 v[234:235], v[194:195], v[224:225] op_sel:[0,1]
    v_pk_mul_f32 v[236:237], v[196:197], v[224:225] op_sel:[0,1]
    v_pk_mul_f32 v[238:239], v[198:199], v[224:225] op_sel:[0,1]
    v_pk_mul_f32 v[240:241], v[200:201], v[224:225] op_sel:[0,1]
    v_pk_mul_f32 v[242:243], v[202:203], v[224:225] op_sel:[0,1]
    v_pk_fma_f32 v[228:229], v[92:93], v[224:225], v[228:229] op_sel_hi:[1,0,1]
    v_pk_fma_f32 v[230:231], v[94:95], v[224:225], v[230:231] op_sel_hi:[1,0,1]
    v_pk_fma_f32 v[232:233], v[96:97], v[224:225], v[232:233] op_sel_hi:[1,0,1]
    v_pk_fma_f32 v[234:235], v[98:99], v[224:225], v[234:235] op_sel_hi:[1,0,1]
    v_pk_fma_f32 v[236:237], v[100:101], v[224:225], v[236:237] op_sel_hi:[1,0,1]
    v_pk_fma_f32 v[238:239], v[102:103], v[224:225], v[238:239] op_sel_hi:[1,0,1]
    v_pk_fma_f32 v[240:241], v[104:105], v[224:225], v[240:241] op_sel_hi:[1,0,1]
    v_pk_fma_f32 v[242:243], v[106:107], v[224:225], v[242:243] op_sel_hi:[1,0,1]
    v_cvt_pk_bf16_f32 v92, v228, v229
    v_cvt_pk_bf16_f32 v93, v230, v231
    v_cvt_pk_bf16_f32 v94, v232, v233
    v_cvt_pk_bf16_f32 v95, v234, v235
    v_cvt_pk_bf16_f32 v96, v236, v237
    v_cvt_pk_bf16_f32 v97, v238, v239
    v_cvt_pk_bf16_f32 v98, v240, v241
    v_cvt_pk_bf16_f32 v99, v242, v243
    buffer_store_dwordx4 v[92:95], v6, s[40:43], s14 offen offset:0 sc1
    buffer_store_dwordx4 v[96:99], v6, s[40:43], s14 offen offset:1024 sc1
    v_pk_mul_f32 v[228:229], v[204:205], v[220:221] op_sel:[0,1]
    v_pk_mul_f32 v[230:231], v[206:207], v[220:221] op_sel:[0,1]
    v_pk_mul_f32 v[232:233], v[208:209], v[220:221] op_sel:[0,1]
    v_pk_mul_f32 v[234:235], v[210:211], v[220:221] op_sel:[0,1]
    v_pk_mul_f32 v[236:237], v[212:213], v[220:221] op_sel:[0,1]
    v_pk_mul_f32 v[238:239], v[214:215], v[220:221] op_sel:[0,1]
    v_pk_mul_f32 v[240:241], v[216:217], v[220:221] op_sel:[0,1]
    v_pk_mul_f32 v[242:243], v[218:219], v[220:221] op_sel:[0,1]
    v_pk_fma_f32 v[228:229], v[124:125], v[220:221], v[228:229] op_sel_hi:[1,0,1]
    v_pk_fma_f32 v[230:231], v[126:127], v[220:221], v[230:231] op_sel_hi:[1,0,1]
    v_pk_fma_f32 v[232:233], v[128:129], v[220:221], v[232:233] op_sel_hi:[1,0,1]
    v_pk_fma_f32 v[234:235], v[130:131], v[220:221], v[234:235] op_sel_hi:[1,0,1]
    v_pk_fma_f32 v[236:237], v[132:133], v[220:221], v[236:237] op_sel_hi:[1,0,1]
    v_pk_fma_f32 v[238:239], v[134:135], v[220:221], v[238:239] op_sel_hi:[1,0,1]
    v_pk_fma_f32 v[240:241], v[136:137], v[220:221], v[240:241] op_sel_hi:[1,0,1]
    v_pk_fma_f32 v[242:243], v[138:139], v[220:221], v[242:243] op_sel_hi:[1,0,1]
    v_cvt_pk_bf16_f32 v124, v228, v229
    v_cvt_pk_bf16_f32 v125, v230, v231
    v_cvt_pk_bf16_f32 v126, v232, v233
    v_cvt_pk_bf16_f32 v127, v234, v235
    v_cvt_pk_bf16_f32 v128, v236, v237
    v_cvt_pk_bf16_f32 v129, v238, v239
    v_cvt_pk_bf16_f32 v130, v240, v241
    v_cvt_pk_bf16_f32 v131, v242, v243
    buffer_store_dwordx4 v[124:127], v6, s[40:43], s15 offen offset:0 sc1
    buffer_store_dwordx4 v[128:131], v6, s[40:43], s15 offen offset:1024 sc1
    s_waitcnt lgkmcnt(0)
    v_pk_mul_f32 v[228:229], v[68:69], v[30:31] op_sel_hi:[1,0]
    v_pk_mul_f32 v[230:231], v[70:71], v[30:31] op_sel_hi:[1,0]
    v_pk_mul_f32 v[232:233], v[72:73], v[30:31] op_sel_hi:[1,0]
    v_pk_mul_f32 v[234:235], v[74:75], v[30:31] op_sel_hi:[1,0]
    v_pk_mul_f32 v[236:237], v[76:77], v[30:31] op_sel_hi:[1,0]
    v_pk_mul_f32 v[238:239], v[78:79], v[30:31] op_sel_hi:[1,0]
    v_pk_mul_f32 v[240:241], v[80:81], v[30:31] op_sel_hi:[1,0]
    v_pk_mul_f32 v[242:243], v[82:83], v[30:31] op_sel_hi:[1,0]
    v_pk_fma_f32 v[228:229], v[156:157], v[52:53], v[228:229]
    v_pk_fma_f32 v[230:231], v[158:159], v[54:55], v[230:231]
    v_pk_fma_f32 v[232:233], v[160:161], v[56:57], v[232:233]
    v_pk_fma_f32 v[234:235], v[162:163], v[58:59], v[234:235]
    v_pk_fma_f32 v[236:237], v[164:165], v[60:61], v[236:237]
    v_pk_fma_f32 v[238:239], v[166:167], v[62:63], v[238:239]
    v_pk_fma_f32 v[240:241], v[168:169], v[64:65], v[240:241]
    v_pk_fma_f32 v[242:243], v[170:171], v[66:67], v[242:243]
    v_cvt_pk_bf16_f32 v156, v228, v229
    v_cvt_pk_bf16_f32 v157, v230, v231
    v_cvt_pk_bf16_f32 v158, v232, v233
    v_cvt_pk_bf16_f32 v159, v234, v235
    v_cvt_pk_bf16_f32 v160, v236, v237
    v_cvt_pk_bf16_f32 v161, v238, v239
    v_cvt_pk_bf16_f32 v162, v240, v241
    v_cvt_pk_bf16_f32 v163, v242, v243
    buffer_store_dwordx4 v[156:159], v6, s[40:43], s13 offen offset:2048 sc1
    buffer_store_dwordx4 v[160:163], v6, s[40:43], s13 offen offset:3072 sc1
    s_xor_b32 s15, s15, 4096
    s_xor_b32 s13, s13, 4096
    s_xor_b32 s14, s14, 2048
    ds_read_b128 v[52:55], v9 offset:0
    ds_read_b128 v[68:71], v9 offset:512
    ds_read_b128 v[56:59], v9 offset:32
    ds_read_b128 v[72:75], v9 offset:544
    ds_read_b128 v[60:63], v9 offset:64
    ds_read_b128 v[76:79], v9 offset:576
    ds_read_b128 v[64:67], v9 offset:96
    ds_read_b128 v[80:83], v9 offset:608
    v_pk_mul_f32 v[228:229], v[188:189], v[226:227] op_sel:[0,1]
    v_pk_mul_f32 v[230:231], v[190:191], v[226:227] op_sel:[0,1]
    v_pk_mul_f32 v[232:233], v[192:193], v[226:227] op_sel:[0,1]
    v_pk_mul_f32 v[234:235], v[194:195], v[226:227] op_sel:[0,1]
    v_pk_mul_f32 v[236:237], v[196:197], v[226:227] op_sel:[0,1]
    v_pk_mul_f32 v[238:239], v[198:199], v[226:227] op_sel:[0,1]
    v_pk_mul_f32 v[240:241], v[200:201], v[226:227] op_sel:[0,1]
    v_pk_mul_f32 v[242:243], v[202:203], v[226:227] op_sel:[0,1]
    v_pk_fma_f32 v[228:229], v[108:109], v[226:227], v[228:229] op_sel_hi:[1,0,1]
    v_pk_fma_f32 v[230:231], v[110:111], v[226:227], v[230:231] op_sel_hi:[1,0,1]
    v_pk_fma_f32 v[232:233], v[112:113], v[226:227], v[232:233] op_sel_hi:[1,0,1]
    v_pk_fma_f32 v[234:235], v[114:115], v[226:227], v[234:235] op_sel_hi:[1,0,1]
    v_pk_fma_f32 v[236:237], v[116:117], v[226:227], v[236:237] op_sel_hi:[1,0,1]
    v_pk_fma_f32 v[238:239], v[118:119], v[226:227], v[238:239] op_sel_hi:[1,0,1]
    v_pk_fma_f32 v[240:241], v[120:121], v[226:227], v[240:241] op_sel_hi:[1,0,1]
    v_pk_fma_f32 v[242:243], v[122:123], v[226:227], v[242:243] op_sel_hi:[1,0,1]
    v_cvt_pk_bf16_f32 v108, v228, v229
    v_cvt_pk_bf16_f32 v109, v230, v231
    v_cvt_pk_bf16_f32 v110, v232, v233
    v_cvt_pk_bf16_f32 v111, v234, v235
    v_cvt_pk_bf16_f32 v112, v236, v237
    v_cvt_pk_bf16_f32 v113, v238, v239
    v_cvt_pk_bf16_f32 v114, v240, v241
    v_cvt_pk_bf16_f32 v115, v242, v243
    buffer_store_dwordx4 v[108:111], v6, s[40:43], s14 offen offset:0 sc1
    buffer_store_dwordx4 v[112:115], v6, s[40:43], s14 offen offset:1024 sc1
    v_pk_mul_f32 v[228:229], v[204:205], v[222:223] op_sel:[0,1]
    v_pk_mul_f32 v[230:231], v[206:207], v[222:223] op_sel:[0,1]
    v_pk_mul_f32 v[232:233], v[208:209], v[222:223] op_sel:[0,1]
    v_pk_mul_f32 v[234:235], v[210:211], v[222:223] op_sel:[0,1]
    v_pk_mul_f32 v[236:237], v[212:213], v[222:223] op_sel:[0,1]
    v_pk_mul_f32 v[238:239], v[214:215], v[222:223] op_sel:[0,1]
    v_pk_mul_f32 v[240:241], v[216:217], v[222:223] op_sel:[0,1]
    v_pk_mul_f32 v[242:243], v[218:219], v[222:223] op_sel:[0,1]
    v_pk_fma_f32 v[228:229], v[140:141], v[222:223], v[228:229] op_sel_hi:[1,0,1]
    v_pk_fma_f32 v[230:231], v[142:143], v[222:223], v[230:231] op_sel_hi:[1,0,1]
    v_pk_fma_f32 v[232:233], v[144:145], v[222:223], v[232:233] op_sel_hi:[1,0,1]
    v_pk_fma_f32 v[234:235], v[146:147], v[222:223], v[234:235] op_sel_hi:[1,0,1]
    v_pk_fma_f32 v[236:237], v[148:149], v[222:223], v[236:237] op_sel_hi:[1,0,1]
    v_pk_fma_f32 v[238:239], v[150:151], v[222:223], v[238:239] op_sel_hi:[1,0,1]
    v_pk_fma_f32 v[240:241], v[152:153], v[222:223], v[240:241] op_sel_hi:[1,0,1]
    v_pk_fma_f32 v[242:243], v[154:155], v[222:223], v[242:243] op_sel_hi:[1,0,1]
    v_cvt_pk_bf16_f32 v140, v228, v229
    v_cvt_pk_bf16_f32 v141, v230, v231
    v_cvt_pk_bf16_f32 v142, v232, v233
    v_cvt_pk_bf16_f32 v143, v234, v235
    v_cvt_pk_bf16_f32 v144, v236, v237
    v_cvt_pk_bf16_f32 v145, v238, v239
    v_cvt_pk_bf16_f32 v146, v240, v241
    v_cvt_pk_bf16_f32 v147, v242, v243
    buffer_store_dwordx4 v[140:143], v6, s[40:43], s15 offen offset:0 sc1
    buffer_store_dwordx4 v[144:147], v6, s[40:43], s15 offen offset:1024 sc1
    s_waitcnt lgkmcnt(0)
    v_pk_mul_f32 v[228:229], v[68:69], v[30:31] op_sel_hi:[1,0]
    v_pk_mul_f32 v[230:231], v[70:71], v[30:31] op_sel_hi:[1,0]
    v_pk_mul_f32 v[232:233], v[72:73], v[30:31] op_sel_hi:[1,0]
    v_pk_mul_f32 v[234:235], v[74:75], v[30:31] op_sel_hi:[1,0]
    v_pk_mul_f32 v[236:237], v[76:77], v[30:31] op_sel_hi:[1,0]
    v_pk_mul_f32 v[238:239], v[78:79], v[30:31] op_sel_hi:[1,0]
    v_pk_mul_f32 v[240:241], v[80:81], v[30:31] op_sel_hi:[1,0]
    v_pk_mul_f32 v[242:243], v[82:83], v[30:31] op_sel_hi:[1,0]
    v_pk_fma_f32 v[228:229], v[172:173], v[52:53], v[228:229]
    v_pk_fma_f32 v[230:231], v[174:175], v[54:55], v[230:231]
    v_pk_fma_f32 v[232:233], v[176:177], v[56:57], v[232:233]
    v_pk_fma_f32 v[234:235], v[178:179], v[58:59], v[234:235]
    v_pk_fma_f32 v[236:237], v[180:181], v[60:61], v[236:237]
    v_pk_fma_f32 v[238:239], v[182:183], v[62:63], v[238:239]
    v_pk_fma_f32 v[240:241], v[184:185], v[64:65], v[240:241]
    v_pk_fma_f32 v[242:243], v[186:187], v[66:67], v[242:243]
    v_cvt_pk_bf16_f32 v172, v228, v229
    v_cvt_pk_bf16_f32 v173, v230, v231
    v_cvt_pk_bf16_f32 v174, v232, v233
    v_cvt_pk_bf16_f32 v175, v234, v235
    v_cvt_pk_bf16_f32 v176, v236, v237
    v_cvt_pk_bf16_f32 v177, v238, v239
    v_cvt_pk_bf16_f32 v178, v240, v241
    v_cvt_pk_bf16_f32 v179, v242, v243
    buffer_store_dwordx4 v[172:175], v6, s[40:43], s13 offen offset:2048 sc1
    buffer_store_dwordx4 v[176:179], v6, s[40:43], s13 offen offset:3072 sc1
L_qkv1_dend:
L_g0_kernel_end:
    s_endpgm
.globl rest_kernel
.p2align 8
.type rest_kernel,@function
rest_kernel:
    s_load_dwordx16 s[16:31], s[0:1], 0
    s_load_dwordx4 s[32:35], s[0:1], 64
    s_load_dwordx2 s[36:37], s[0:1], 80
    s_cmp_ge_u32 s2, 256
    s_cbranch_scc1 L_rest_kernel_end
    v_lshrrev_b32 v1, 6, v0
    v_and_b32 v0, 63, v0
    v_readfirstlane_b32 s94, v1
    s_nop 0
    s_mov_b32 s8, s94
    s_setprio 0
    s_and_b32 s4, s2, 7
    s_lshr_b32 s5, s2, 3
    s_lshr_b32 s6, s5, 3
    s_lshl_b32 s9, s4, 2
    s_add_u32 s9, s9, s6
    s_and_b32 s5, s5, 7
    s_waitcnt lgkmcnt(0)
    s_lshl_b32 s10, s5, 3
    s_and_b32 s4, s8, 3
    s_lshl_b32 s4, s4, 1
    s_add_u32 s10, s10, s4
    s_lshr_b32 s15, s8, 2
    s_add_u32 s44, s36, 4194304
    s_addc_u32 s45, s37, 0
    s_mov_b32 s46, 8388608
    s_mov_b32 s47, 0x20000
    s_add_u32 s46, s9, 1
    s_lshl_b32 s46, s46, 18
    v_lshlrev_b32 v2, 4, v0
    s_lshl_b32 s11, s9, 18
    s_lshl_b32 s5, s8, 12
    s_add_u32 s11, s11, s5
    s_mov_b32 s12, s5
    s_add_u32 s6, s5, 98304
    s_mov_b32 m0, s12
    s_nop 0
    buffer_load_dwordx4 v2, s[44:47], s11 offen offset:0 lds
    buffer_load_dwordx4 v2, s[44:47], s11 offen offset:1024 lds
    buffer_load_dwordx4 v2, s[44:47], s11 offen offset:2048 lds
    buffer_load_dwordx4 v2, s[44:47], s11 offen offset:3072 lds
    s_add_u32 s11, s11, 32768
    s_add_u32 s12, s12, 32768
    s_cmp_eq_u32 s12, s6
    s_cselect_b32 s12, s5, s12
    s_add_u32 s40, s36, 0
    s_addc_u32 s41, s37, 0
    s_mov_b32 s42, 4194304
    s_mov_b32 s43, 0x20000
    s_lshl_b32 s4, s9, 6
    s_add_u32 s4, s4, s10
    s_lshl_b32 s4, s4, 11
    buffer_load_dwordx4 v[8:11], v2, s[40:43], s4 offen
    buffer_load_dwordx4 v[12:15], v2, s[40:43], s4 offen offset:1024
    buffer_load_dwordx4 v[16:19], v2, s[40:43], s4 offen offset:2048
    buffer_load_dwordx4 v[20:23], v2, s[40:43], s4 offen offset:3072
    s_mov_b32 m0, s12
    s_nop 0
    buffer_load_dwordx4 v2, s[44:47], s11 offen offset:0 lds
    buffer_load_dwordx4 v2, s[44:47], s11 offen offset:1024 lds
    buffer_load_dwordx4 v2, s[44:47], s11 offen offset:2048 lds
    buffer_load_dwordx4 v2, s[44:47], s11 offen offset:3072 lds
    s_add_u32 s11, s11, 32768
    s_add_u32 s12, s12, 32768
    s_cmp_eq_u32 s12, s6
    s_cselect_b32 s12, s5, s12
    v_lshrrev_b32 v61, 5, v0
    v_lshlrev_b32 v61, 8, v61
    v_bfe_u32 v62, v0, 2, 2
    v_lshl_add_u32 v61, v62, 6, v61
    v_bfe_u32 v62, v0, 4, 1
    v_lshl_add_u32 v61, v62, 5, v61
    v_and_b32 v62, 3, v0
    v_lshl_add_u32 v61, v62, 3, v61
    s_add_u32 s4, s5, 98304
    v_add_u32 v61, s4, v61
    s_lshl_b32 s4, s2, 3
    s_add_u32 s4, s4, s8
    s_lshr_b32 s7, s4, 7
    s_and_b32 s4, s4, 127
    s_min_u32 s4, s4, 95
    s_and_b32 s57, s4, 31
    s_and_b32 s58, s57, 1
    s_lshr_b32 s57, s57, 1
    s_lshr_b32 s59, s4, 5
    s_lshl_b32 s59, s59, 1
    s_add_u32 s58, s58, s59
    s_mov_b32 s60, s18
    s_mov_b32 s61, s19
    s_mov_b32 s62, 6291456
    s_mov_b32 s63, 0x20000
    s_mul_i32 s52, s7, 393216
    s_lshl_b32 s4, s4, 6
    s_add_u32 s52, s52, s4
    s_mov_b32 s54, 6144
    s_mul_i32 s53, s57, 64
    s_lshl_b32 s7, s7, 2
    s_add_u32 s53, s53, s7
    s_mul_i32 s53, s53, 6
    s_add_u32 s53, s53, s58
    s_lshl_b32 s53, s53, 10
    s_add_u32 s53, s53, 0
    s_mov_b32 s56, 6144
    s_mov_b32 s86, s52
    s_mov_b32 s87, s53
    s_lshl_b32 s4, s2, 3
    s_add_u32 s4, s4, s8
    s_cmp_lt_u32 s4, 1792
    s_cbranch_scc0 L_at1_r1wo
    s_lshr_b32 s7, s4, 5
    s_and_b32 s4, s4, 31
    s_lshr_b32 s57, s4, 2
    s_and_b32 s58, s4, 3
    s_mov_b32 s60, s28
    s_mov_b32 s61, s29
    s_mov_b32 s62, 7340032
    s_mov_b32 s63, 0x20000
    s_mul_i32 s52, s7, 131072
    s_lshl_b32 s4, s4, 6
    s_add_u32 s52, s52, s4
    s_mov_b32 s54, 2048
    s_mul_i32 s53, s57, 224
    s_lshl_b32 s7, s7, 2
    s_add_u32 s53, s53, s7
    s_mul_i32 s53, s53, 4
    s_add_u32 s53, s53, s58
    s_lshl_b32 s53, s53, 10
    s_add_u32 s53, s53, 16777216
    s_mov_b32 s56, 4096
    s_branch L_at1_r1j
L_at1_r1wo:
    s_sub_u32 s4, s4, 1792
    s_lshr_b32 s7, s4, 4
    s_and_b32 s4, s4, 15
    s_add_u32 s4, s4, 16
    s_lshr_b32 s57, s4, 1
    s_and_b32 s58, s4, 1
    s_mov_b32 s60, s20
    s_mov_b32 s61, s21
    s_mov_b32 s62, 2097152
    s_mov_b32 s63, 0x20000
    s_mul_i32 s52, s7, 131072
    s_lshl_b32 s4, s4, 6
    s_add_u32 s52, s52, s4
    s_mov_b32 s54, 2048
    s_mul_i32 s53, s57, 64
    s_lshl_b32 s7, s7, 2
    s_add_u32 s53, s53, s7
    s_mul_i32 s53, s53, 2
    s_add_u32 s53, s53, s58
    s_lshl_b32 s53, s53, 10
    s_add_u32 s53, s53, 6291456
    s_mov_b32 s56, 2048
L_at1_r1j:
    s_mov_b32 s95, s60
    s_mov_b32 s96, s61
    s_mov_b32 s97, s52
    s_mov_b32 s98, s53
    s_mov_b32 s99, s56
    s_mov_b32 s100, s62
    s_lshl_b32 s4, s2, 3
    s_add_u32 s4, s4, s8
    s_lshr_b32 s7, s4, 7
    s_and_b32 s4, s4, 127
    s_cmp_lt_u32 s4, 112
    s_cbranch_scc0 L_at1_r0wo
    s_mul_i32 s57, s4, 147
    s_lshr_b32 s57, s57, 10
    s_mul_i32 s58, s57, 7
    s_sub_u32 s58, s4, s58
    s_mov_b32 s60, s24
    s_mov_b32 s61, s25
    s_mov_b32 s62, 7340032
    s_mov_b32 s63, 0x20000
    s_mul_i32 s52, s7, 458752
    s_lshl_b32 s4, s4, 6
    s_add_u32 s52, s52, s4
    s_mov_b32 s54, 7168
    s_mul_i32 s53, s57, 64
    s_lshl_b32 s7, s7, 2
    s_add_u32 s53, s53, s7
    s_mul_i32 s53, s53, 7
    s_add_u32 s53, s53, s58
    s_lshl_b32 s53, s53, 10
    s_add_u32 s53, s53, 8388608
    s_mov_b32 s56, 7168
    s_branch L_at1_r0j
L_at1_r0wo:
    s_sub_u32 s4, s4, 112
    s_lshr_b32 s57, s4, 1
    s_and_b32 s58, s4, 1
    s_mov_b32 s60, s20
    s_mov_b32 s61, s21
    s_mov_b32 s62, 2097152
    s_mov_b32 s63, 0x20000
    s_mul_i32 s52, s7, 131072
    s_lshl_b32 s4, s4, 6
    s_add_u32 s52, s52, s4
    s_mov_b32 s54, 2048
    s_mul_i32 s53, s57, 64
    s_lshl_b32 s7, s7, 2
    s_add_u32 s53, s53, s7
    s_mul_i32 s53, s53, 2
    s_add_u32 s53, s53, s58
    s_lshl_b32 s53, s53, 10
    s_add_u32 s53, s53, 6291456
    s_mov_b32 s56, 2048
L_at1_r0j:
    s_add_u32 s48, s36, 46137344
    s_addc_u32 s49, s37, 0
    s_mov_b32 s50, 4194304
    s_mov_b32 s51, 0x20000
    s_lshl_b32 s92, s2, 3
    s_add_u32 s92, s92, s8
    s_and_b32 s4, s92, 127
    s_lshr_b32 s93, s92, 7
    s_mul_i32 s58, s93, 14336
    s_lshl_b32 s7, s4, 7
    s_add_u32 s58, s58, s7
    s_add_u32 s58, s58, 262144
    s_cmp_lt_u32 s4, 112
    s_cselect_b32 s58, s58, 0x7ffffff0
    s_sub_u32 s4, s4, 112
    s_lshl_b32 s7, s4, 4
    s_add_u32 s7, s7, s93
    s_lshl_b32 s7, s7, 2
    s_add_u32 s7, s7, 2785280
    s_cmp_lt_u32 s4, 16
    s_cselect_b32 s59, s7, 0x7ffffff0
    s_sub_u32 s4, s92, 1792
    s_and_b32 s7, s4, 15
    s_add_u32 s7, s7, 16
    s_lshl_b32 s7, s7, 4
    s_lshr_b32 s93, s4, 4
    s_add_u32 s7, s7, s93
    s_lshl_b32 s7, s7, 2
    s_add_u32 s7, s7, 2785280
    s_cmp_lt_u32 s4, 256
    s_cselect_b32 s101, s7, 0x7ffffff0
    s_mov_b32 s55, 0
    s_mov_b32 s57, 0
    v_lshrrev_b32 v62, 4, v0
    v_xor_b32 v5, v62, v0
    v_and_b32 v5, 1, v5
    v_cmp_eq_u32 vcc, 0, v5
    v_mov_b32 v6, 0x3f803f80
    s_nop 0
    v_cndmask_b32 v184, 0, v6, vcc
    v_mov_b32 v185, v184
    v_mov_b32 v186, v184
    v_mov_b32 v187, v184
    v_and_b32 v5, 1, v0
    v_lshlrev_b32 v5, 6, v5
    v_lshl_add_u32 v192, v62, 4, v5
    v_and_b32 v5, 15, v0
    v_cmp_gt_u32 vcc, 2, v5
    v_mov_b32 v6, 0x7fff0000
    s_nop 0
    v_cndmask_b32 v192, v6, v192, vcc
    v_mov_b32 v193, 1
    v_mov_b32 v194, 0
    v_lshrrev_b32 v60, 2, v0
    v_mul_lo_u32 v60, v60, s54
    v_and_b32 v62, 3, v0
    v_lshl_add_u32 v60, v62, 4, v60
    s_lshl_b32 s54, s54, 4
    v_lshrrev_b32 v5, 2, v0
    v_lshrrev_b32 v6, 4, v0
    v_xor_b32 v5, v5, v6
    v_and_b32 v5, 1, v5
    v_cmp_eq_u32 vcc, 0, v5
    v_mov_b32 v6, 0x3f803f80
    s_nop 0
    v_cndmask_b32 v40, 0, v6, vcc
    v_mov_b32 v41, v40
    v_mov_b32 v42, v40
    v_mov_b32 v43, v40
    s_lshl_b32 s4, s15, 14
    v_add_u32 v63, s4, v2
    v_mov_b32 v3, v63
    v_add_u32 v4, 32768, v63
    s_mov_b32 s14, 65536
    s_mov_b32 s13, 0
    v_mov_b32 v44, 0
    v_mov_b32 v45, 0
    v_mov_b32 v46, 0
    v_mov_b32 v47, 0
    v_mov_b32 v128, 0
    v_mov_b32 v129, 0
    v_mov_b32 v130, 0
    v_mov_b32 v131, 0
    v_mov_b32 v132, 0
    v_mov_b32 v133, 0
    v_mov_b32 v134, 0
    v_mov_b32 v135, 0
    v_mov_b32 v136, 0
    v_mov_b32 v137, 0
    v_mov_b32 v138, 0
    v_mov_b32 v139, 0
    v_mov_b32 v140, 0
    v_mov_b32 v141, 0
    v_mov_b32 v142, 0
    v_mov_b32 v143, 0
    v_mov_b32 v48, 0
    v_mov_b32 v49, 0
    v_mov_b32 v50, 0
    v_mov_b32 v51, 0
    v_mov_b32 v144, 0
    v_mov_b32 v145, 0
    v_mov_b32 v146, 0
    v_mov_b32 v147, 0
    v_mov_b32 v148, 0
    v_mov_b32 v149, 0
    v_mov_b32 v150, 0
    v_mov_b32 v151, 0
    v_mov_b32 v152, 0
    v_mov_b32 v153, 0
    v_mov_b32 v154, 0
    v_mov_b32 v155, 0
    v_mov_b32 v156, 0
    v_mov_b32 v157, 0
    v_mov_b32 v158, 0
    v_mov_b32 v159, 0
    v_mov_b32 v36, 0
    v_mov_b32 v56, 0
    v_mov_b32 v37, 0
    v_mov_b32 v57, 0
    v_mov_b32 v38, 0
    v_mov_b32 v58, 0
    v_mov_b32 v39, 0
    v_mov_b32 v59, 0
    s_waitcnt vmcnt(4)
    s_barrier
    s_add_u32 s40, s36, 54525952
    s_addc_u32 s41, s37, 0
    s_mov_b32 s42, 0
    s_mov_b32 s43, 0x20000
    ds_read_b128 v[24:27], v2 offset:0
    ds_read_b128 v[28:31], v2 offset:1024
    s_waitcnt lgkmcnt(0)
    v_mfma_f32_32x32x16_bf16 v[96:111], v[24:27], v[8:11], 0
    v_mfma_f32_32x32x16_bf16 v[96:111], v[28:31], v[12:15], v[96:111]
    v_mfma_f32_32x32x16_bf16 v[112:127], v[24:27], v[16:19], 0
    v_mfma_f32_32x32x16_bf16 v[112:127], v[28:31], v[20:23], v[112:127]
    ds_read_b128 v[24:27], v3 offset:0
    ds_read_b128 v[28:31], v3 offset:1024
    ds_read_b128 v[32:35], v3 offset:2048
    s_nop 6
    v_max3_f32 v5, v96, v97, v98
    v_max3_f32 v5, v5, v99, v100
    v_max3_f32 v5, v5, v101, v102
    v_max3_f32 v5, v5, v103, v104
    v_max3_f32 v5, v5, v105, v106
    v_max3_f32 v5, v5, v107, v108
    v_max3_f32 v5, v5, v109, v110
    v_max_f32 v5, v5, v111
    v_mov_b32 v6, v5
    s_nop 1
    v_permlane32_swap_b32 v5, v6
    v_max_f32 v5, v5, v6
    v_sub_f32 v64, 0, v5
    v_sub_f32 v65, 0, v5
    v_sub_f32 v66, 0, v5
    v_sub_f32 v67, 0, v5
    v_sub_f32 v68, 0, v5
    v_sub_f32 v69, 0, v5
    v_sub_f32 v70, 0, v5
    v_sub_f32 v71, 0, v5
    v_sub_f32 v72, 0, v5
    v_sub_f32 v73, 0, v5
    v_sub_f32 v74, 0, v5
    v_sub_f32 v75, 0, v5
    v_sub_f32 v76, 0, v5
    v_sub_f32 v77, 0, v5
    v_sub_f32 v78, 0, v5
    v_sub_f32 v79, 0, v5
    v_max3_f32 v5, v112, v113, v114
    v_max3_f32 v5, v5, v115, v116
    v_max3_f32 v5, v5, v117, v118
    v_max3_f32 v5, v5, v119, v120
    v_max3_f32 v5, v5, v121, v122
    v_max3_f32 v5, v5, v123, v124
    v_max3_f32 v5, v5, v125, v126
    v_max_f32 v5, v5, v127
    v_mov_b32 v6, v5
    s_nop 1
    v_permlane32_swap_b32 v5, v6
    v_max_f32 v5, v5, v6
    v_sub_f32 v80, 0, v5
    v_sub_f32 v81, 0, v5
    v_sub_f32 v82, 0, v5
    v_sub_f32 v83, 0, v5
    v_sub_f32 v84, 0, v5
    v_sub_f32 v85, 0, v5
    v_sub_f32 v86, 0, v5
    v_sub_f32 v87, 0, v5
    v_sub_f32 v88, 0, v5
    v_sub_f32 v89, 0, v5
    v_sub_f32 v90, 0, v5
    v_sub_f32 v91, 0, v5
    v_sub_f32 v92, 0, v5
    v_sub_f32 v93, 0, v5
    v_sub_f32 v94, 0, v5
    v_sub_f32 v95, 0, v5
    s_waitcnt lgkmcnt(1)
    v_mfma_f32_32x32x16_bf16 v[96:111], v[24:27], v[8:11], v[64:79]
    v_mfma_f32_32x32x16_bf16 v[96:111], v[28:31], v[12:15], v[96:111]
    s_nop 11
    v_exp_f32 v160, v96
    v_exp_f32 v161, v97
L_at1_loop:
    v_mfma_f32_32x32x16_bf16 v[144:159], v[36:39], v[56:59], v[144:159]
    ds_read_b128 v[36:39], v3 offset:3072
    v_exp_f32 v162, v98
    v_exp_f32 v163, v99
    v_exp_f32 v164, v100
    v_mfma_f32_16x16x32_bf16 v[48:51], v[40:43], v[56:59], v[48:51]
    ds_read_b64_tr_b16 v[176:177], v61 offset:0
    ds_read_b64_tr_b16 v[178:179], v61 offset:512
    ds_read_b64_tr_b16 v[180:181], v61 offset:1024
    ds_read_b64_tr_b16 v[182:183], v61 offset:1536
    s_mov_b32 s38, s55
    s_mov_b32 s39, s57
    s_cmp_eq_u32 s13, 0
    s_cselect_b32 s42, 0, 25165824
    v_exp_f32 v165, v101
    v_cvt_pk_bf16_f32 v52, v160, v161
    v_cvt_pk_bf16_f32 v53, v162, v163
    v_mfma_f32_32x32x16_bf16 v[112:127], v[24:27], v[16:19], v[80:95]
    v_exp_f32 v166, v102
    v_exp_f32 v167, v103
    v_exp_f32 v168, v104
    v_cvt_pk_bf16_f32 v54, v164, v165
    v_mfma_f32_32x32x16_bf16 v[112:127], v[28:31], v[20:23], v[112:127]
    ds_read_b128 v[24:27], v3 offset:4096
    ds_read_b128 v[28:31], v3 offset:5120
    v_cvt_pk_bf16_f32 v55, v166, v167
    v_exp_f32 v169, v105
    v_exp_f32 v170, v106
    v_exp_f32 v171, v107
    s_waitcnt lgkmcnt(3)
    v_mfma_f32_32x32x16_bf16 v[128:143], v[32:35], v[52:55], v[128:143]
    v_exp_f32 v172, v108
    v_exp_f32 v173, v109
    v_exp_f32 v174, v110
    v_cvt_pk_bf16_f32 v56, v168, v169
    v_mfma_f32_16x16x32_bf16 v[44:47], v[40:43], v[52:55], v[44:47]
    v_exp_f32 v175, v111
    v_cvt_pk_bf16_f32 v57, v170, v171
    v_cvt_pk_bf16_f32 v58, v172, v173
    v_cvt_pk_bf16_f32 v59, v174, v175
    v_exp_f32 v160, v112
    v_exp_f32 v161, v113
    s_waitcnt lgkmcnt(2)
    v_mfma_f32_32x32x16_bf16 v[128:143], v[36:39], v[56:59], v[128:143]
    v_exp_f32 v162, v114
    v_exp_f32 v163, v115
    v_exp_f32 v164, v116
    v_mfma_f32_16x16x32_bf16 v[44:47], v[40:43], v[56:59], v[44:47]
    v_exp_f32 v165, v117
    v_cvt_pk_bf16_f32 v52, v160, v161
    v_cvt_pk_bf16_f32 v53, v162, v163
    s_waitcnt lgkmcnt(0)
    v_mfma_f32_32x32x16_bf16 v[96:111], v[24:27], v[8:11], v[64:79]
    v_exp_f32 v166, v118
    v_exp_f32 v167, v119
    v_exp_f32 v168, v120
    v_cvt_pk_bf16_f32 v54, v164, v165
    v_mfma_f32_32x32x16_bf16 v[96:111], v[28:31], v[12:15], v[96:111]
    v_cvt_pk_bf16_f32 v55, v166, v167
    v_exp_f32 v169, v121
    v_exp_f32 v170, v122
    v_exp_f32 v171, v123
    v_mfma_f32_32x32x16_bf16 v[144:159], v[32:35], v[52:55], v[144:159]
    ds_read_b128 v[32:35], v3 offset:6144
    v_exp_f32 v172, v124
    v_exp_f32 v173, v125
    v_exp_f32 v174, v126
    v_cvt_pk_bf16_f32 v56, v168, v169
    v_mfma_f32_16x16x32_bf16 v[48:51], v[40:43], v[52:55], v[48:51]
    buffer_store_dwordx4 v[176:179], v2, s[40:43], s38 offen sc1
    s_add_u32 s38, s38, s39
    v_mfma_f32_16x16x32_bf16 v[188:191], v[176:179], v[184:187], 0
    v_exp_f32 v175, v127
    v_cvt_pk_bf16_f32 v57, v170, v171
    v_cvt_pk_bf16_f32 v58, v172, v173
    v_cvt_pk_bf16_f32 v59, v174, v175
    v_exp_f32 v160, v96
    v_exp_f32 v161, v97
    v_mfma_f32_32x32x16_bf16 v[144:159], v[36:39], v[56:59], v[144:159]
    ds_read_b128 v[36:39], v3 offset:7168
    v_exp_f32 v162, v98
    v_exp_f32 v163, v99
    v_exp_f32 v164, v100
    v_mfma_f32_16x16x32_bf16 v[48:51], v[40:43], v[56:59], v[48:51]
    v_exp_f32 v165, v101
    v_cvt_pk_bf16_f32 v52, v160, v161
    v_cvt_pk_bf16_f32 v53, v162, v163
    v_mfma_f32_32x32x16_bf16 v[112:127], v[24:27], v[16:19], v[80:95]
    v_exp_f32 v166, v102
    v_exp_f32 v167, v103
    v_exp_f32 v168, v104
    v_cvt_pk_bf16_f32 v54, v164, v165
    v_mfma_f32_32x32x16_bf16 v[112:127], v[28:31], v[20:23], v[112:127]
    ds_read_b128 v[24:27], v3 offset:8192
    ds_read_b128 v[28:31], v3 offset:9216
    v_cvt_pk_bf16_f32 v55, v166, v167
    v_exp_f32 v169, v105
    v_exp_f32 v170, v106
    v_exp_f32 v171, v107
    s_waitcnt lgkmcnt(3)
    v_mfma_f32_32x32x16_bf16 v[128:143], v[32:35], v[52:55], v[128:143]
    v_exp_f32 v172, v108
    v_exp_f32 v173, v109
    v_exp_f32 v174, v110
    v_cvt_pk_bf16_f32 v56, v168, v169
    v_mfma_f32_16x16x32_bf16 v[44:47], v[40:43], v[52:55], v[44:47]
    buffer_store_dwordx4 v[180:183], v2, s[40:43], s38 offen sc1
    s_add_u32 s38, s38, s39
    v_mfma_f32_16x16x32_bf16 v[188:191], v[180:183], v[184:187], v[188:191]
    v_exp_f32 v175, v111
    v_cvt_pk_bf16_f32 v57, v170, v171
    v_cvt_pk_bf16_f32 v58, v172, v173
    v_cvt_pk_bf16_f32 v59, v174, v175
    v_exp_f32 v160, v112
    v_exp_f32 v161, v113
    s_waitcnt lgkmcnt(2)
    v_mfma_f32_32x32x16_bf16 v[128:143], v[36:39], v[56:59], v[128:143]
    v_exp_f32 v162, v114
    v_exp_f32 v163, v115
    v_exp_f32 v164, v116
    v_mfma_f32_16x16x32_bf16 v[44:47], v[40:43], v[56:59], v[44:47]
    v_exp_f32 v165, v117
    v_cvt_pk_bf16_f32 v52, v160, v161
    v_cvt_pk_bf16_f32 v53, v162, v163
    s_waitcnt lgkmcnt(0)
    v_mfma_f32_32x32x16_bf16 v[96:111], v[24:27], v[8:11], v[64:79]
    v_exp_f32 v166, v118
    v_exp_f32 v167, v119
    v_exp_f32 v168, v120
    v_cvt_pk_bf16_f32 v54, v164, v165
    v_mfma_f32_32x32x16_bf16 v[96:111], v[28:31], v[12:15], v[96:111]
    v_cvt_pk_bf16_f32 v55, v166, v167
    v_exp_f32 v169, v121
    v_exp_f32 v170, v122
    v_exp_f32 v171, v123
    v_mfma_f32_32x32x16_bf16 v[144:159], v[32:35], v[52:55], v[144:159]
    ds_read_b128 v[32:35], v3 offset:10240
    v_exp_f32 v172, v124
    v_exp_f32 v173, v125
    v_exp_f32 v174, v126
    v_cvt_pk_bf16_f32 v56, v168, v169
    v_mfma_f32_16x16x32_bf16 v[48:51], v[40:43], v[52:55], v[48:51]
    s_add_u32 m0, s5, 98304
    s_nop 0
    buffer_load_dwordx4 v60, s[60:63], s52 offen lds
    s_add_u32 s52, s52, s54
    v_exp_f32 v175, v127
    v_cvt_pk_bf16_f32 v57, v170, v171
    v_cvt_pk_bf16_f32 v58, v172, v173
    v_cvt_pk_bf16_f32 v59, v174, v175
    v_exp_f32 v160, v96
    v_exp_f32 v161, v97
    v_mfma_f32_32x32x16_bf16 v[144:159], v[36:39], v[56:59], v[144:159]
    ds_read_b128 v[36:39], v3 offset:11264
    v_exp_f32 v162, v98
    v_exp_f32 v163, v99
    v_exp_f32 v164, v100
    v_mfma_f32_16x16x32_bf16 v[48:51], v[40:43], v[56:59], v[48:51]
    v_exp_f32 v165, v101
    v_cvt_pk_bf16_f32 v52, v160, v161
    v_cvt_pk_bf16_f32 v53, v162, v163
    v_mfma_f32_32x32x16_bf16 v[112:127], v[24:27], v[16:19], v[80:95]
    v_exp_f32 v166, v102
    v_exp_f32 v167, v103
    v_exp_f32 v168, v104
    v_cvt_pk_bf16_f32 v54, v164, v165
    v_mfma_f32_32x32x16_bf16 v[112:127], v[28:31], v[20:23], v[112:127]
    ds_read_b128 v[24:27], v3 offset:12288
    ds_read_b128 v[28:31], v3 offset:13312
    v_cvt_pk_bf16_f32 v55, v166, v167
    v_exp_f32 v169, v105
    v_exp_f32 v170, v106
    v_exp_f32 v171, v107
    s_waitcnt lgkmcnt(3)
    v_mfma_f32_32x32x16_bf16 v[128:143], v[32:35], v[52:55], v[128:143]
    v_exp_f32 v172, v108
    v_exp_f32 v173, v109
    v_exp_f32 v174, v110
    v_cvt_pk_bf16_f32 v56, v168, v169
    v_mfma_f32_16x16x32_bf16 v[44:47], v[40:43], v[52:55], v[44:47]
    v_exp_f32 v175, v111
    v_cvt_pk_bf16_f32 v57, v170, v171
    v_cvt_pk_bf16_f32 v58, v172, v173
    v_cvt_pk_bf16_f32 v59, v174, v175
    v_exp_f32 v160, v112
    v_exp_f32 v161, v113
    s_waitcnt lgkmcnt(2)
    v_mfma_f32_32x32x16_bf16 v[128:143], v[36:39], v[56:59], v[128:143]
    v_exp_f32 v162, v114
    v_exp_f32 v163, v115
    v_exp_f32 v164, v116
    v_mfma_f32_16x16x32_bf16 v[44:47], v[40:43], v[56:59], v[44:47]
    s_add_u32 m0, s5, 99328
    s_nop 0
    buffer_load_dwordx4 v60, s[60:63], s52 offen lds
    s_add_u32 s52, s52, s54
    v_exp_f32 v165, v117
    v_cvt_pk_bf16_f32 v52, v160, v161
    v_cvt_pk_bf16_f32 v53, v162, v163
    s_waitcnt lgkmcnt(0)
    v_mfma_f32_32x32x16_bf16 v[96:111], v[24:27], v[8:11], v[64:79]
    v_exp_f32 v166, v118
    v_exp_f32 v167, v119
    v_exp_f32 v168, v120
    v_cvt_pk_bf16_f32 v54, v164, v165
    v_mfma_f32_32x32x16_bf16 v[96:111], v[28:31], v[12:15], v[96:111]
    v_cvt_pk_bf16_f32 v55, v166, v167
    v_exp_f32 v169, v121
    v_exp_f32 v170, v122
    v_exp_f32 v171, v123
    v_mfma_f32_32x32x16_bf16 v[144:159], v[32:35], v[52:55], v[144:159]
    ds_read_b128 v[32:35], v3 offset:14336
    v_exp_f32 v172, v124
    v_exp_f32 v173, v125
    v_exp_f32 v174, v126
    v_cvt_pk_bf16_f32 v56, v168, v169
    v_mfma_f32_16x16x32_bf16 v[48:51], v[40:43], v[52:55], v[48:51]
    v_exp_f32 v175, v127
    v_cvt_pk_bf16_f32 v57, v170, v171
    v_cvt_pk_bf16_f32 v58, v172, v173
    v_cvt_pk_bf16_f32 v59, v174, v175
    v_exp_f32 v160, v96
    v_exp_f32 v161, v97
    v_mfma_f32_32x32x16_bf16 v[144:159], v[36:39], v[56:59], v[144:159]
    ds_read_b128 v[36:39], v3 offset:15360
    v_exp_f32 v162, v98
    v_exp_f32 v163, v99
    v_exp_f32 v164, v100
    v_mfma_f32_16x16x32_bf16 v[48:51], v[40:43], v[56:59], v[48:51]
    v_exp_f32 v165, v101
    v_cvt_pk_bf16_f32 v52, v160, v161
    v_cvt_pk_bf16_f32 v53, v162, v163
    v_mfma_f32_32x32x16_bf16 v[112:127], v[24:27], v[16:19], v[80:95]
    v_exp_f32 v166, v102
    v_exp_f32 v167, v103
    v_exp_f32 v168, v104
    v_cvt_pk_bf16_f32 v54, v164, v165
    v_mfma_f32_32x32x16_bf16 v[112:127], v[28:31], v[20:23], v[112:127]
    s_waitcnt vmcnt(4)
    s_barrier
    ds_read_b128 v[24:27], v4 offset:0
    ds_read_b128 v[28:31], v4 offset:1024
    s_mov_b32 m0, s12
    s_nop 0
    buffer_load_dwordx4 v2, s[44:47], s11 offen offset:0 lds
    v_cvt_pk_bf16_f32 v55, v166, v167
    v_exp_f32 v169, v105
    v_exp_f32 v170, v106
    v_exp_f32 v171, v107
    s_waitcnt lgkmcnt(3)
    v_mfma_f32_32x32x16_bf16 v[128:143], v[32:35], v[52:55], v[128:143]
    v_exp_f32 v172, v108
    v_exp_f32 v173, v109
    v_exp_f32 v174, v110
    v_cvt_pk_bf16_f32 v56, v168, v169
    v_mfma_f32_16x16x32_bf16 v[44:47], v[40:43], v[52:55], v[44:47]
    buffer_load_dwordx4 v2, s[44:47], s11 offen offset:1024 lds
    v_exp_f32 v175, v111
    v_cvt_pk_bf16_f32 v57, v170, v171
    v_cvt_pk_bf16_f32 v58, v172, v173
    v_cvt_pk_bf16_f32 v59, v174, v175
    v_exp_f32 v160, v112
    v_exp_f32 v161, v113
    s_waitcnt lgkmcnt(2)
    v_mfma_f32_32x32x16_bf16 v[128:143], v[36:39], v[56:59], v[128:143]
    v_exp_f32 v162, v114
    v_exp_f32 v163, v115
    v_exp_f32 v164, v116
    v_mfma_f32_16x16x32_bf16 v[44:47], v[40:43], v[56:59], v[44:47]
    buffer_load_dwordx4 v2, s[44:47], s11 offen offset:2048 lds
    v_exp_f32 v165, v117
    v_cvt_pk_bf16_f32 v52, v160, v161
    v_cvt_pk_bf16_f32 v53, v162, v163
    s_waitcnt lgkmcnt(0)
    v_mfma_f32_32x32x16_bf16 v[96:111], v[24:27], v[8:11], v[64:79]
    v_exp_f32 v166, v118
    v_exp_f32 v167, v119
    v_exp_f32 v168, v120
    v_cvt_pk_bf16_f32 v54, v164, v165
    v_mfma_f32_32x32x16_bf16 v[96:111], v[28:31], v[12:15], v[96:111]
    v_cvt_pk_bf16_f32 v55, v166, v167
    v_exp_f32 v169, v121
    v_exp_f32 v170, v122
    v_exp_f32 v171, v123
    v_mfma_f32_32x32x16_bf16 v[144:159], v[32:35], v[52:55], v[144:159]
    ds_read_b128 v[32:35], v4 offset:2048
    v_exp_f32 v172, v124
    v_exp_f32 v173, v125
    v_exp_f32 v174, v126
    v_cvt_pk_bf16_f32 v56, v168, v169
    v_mfma_f32_16x16x32_bf16 v[48:51], v[40:43], v[52:55], v[48:51]
    buffer_load_dwordx4 v2, s[44:47], s11 offen offset:3072 lds
    s_add_u32 s11, s11, 32768
    s_add_u32 s12, s12, 32768
    s_cmp_eq_u32 s12, s6
    s_cselect_b32 s12, s5, s12
    v_exp_f32 v175, v127
    v_cvt_pk_bf16_f32 v57, v170, v171
    v_cvt_pk_bf16_f32 v58, v172, v173
    v_cvt_pk_bf16_f32 v59, v174, v175
    v_exp_f32 v160, v96
    v_exp_f32 v161, v97
    v_mov_b32 v3, v4
    v_add_u32 v4, s14, v63
    s_add_u32 s14, s14, 32768
    s_cmp_eq_u32 s14, 98304
    s_cselect_b32 s14, 0, s14
    s_add_u32 s13, s13, 1
    v_mfma_f32_32x32x16_bf16 v[144:159], v[36:39], v[56:59], v[144:159]
    ds_read_b128 v[36:39], v3 offset:3072
    v_exp_f32 v162, v98
    v_exp_f32 v163, v99
    v_exp_f32 v164, v100
    v_mfma_f32_16x16x32_bf16 v[48:51], v[40:43], v[56:59], v[48:51]
    ds_read_b64_tr_b16 v[176:177], v61 offset:2048
    ds_read_b64_tr_b16 v[178:179], v61 offset:2560
    ds_read_b64_tr_b16 v[180:181], v61 offset:3072
    ds_read_b64_tr_b16 v[182:183], v61 offset:3584
    v_exp_f32 v165, v101
    v_cvt_pk_bf16_f32 v52, v160, v161
    v_cvt_pk_bf16_f32 v53, v162, v163
    v_mfma_f32_32x32x16_bf16 v[112:127], v[24:27], v[16:19], v[80:95]
    v_exp_f32 v166, v102
    v_exp_f32 v167, v103
    v_exp_f32 v168, v104
    v_cvt_pk_bf16_f32 v54, v164, v165
    v_mfma_f32_32x32x16_bf16 v[112:127], v[28:31], v[20:23], v[112:127]
    ds_read_b128 v[24:27], v3 offset:4096
    ds_read_b128 v[28:31], v3 offset:5120
    v_cvt_pk_bf16_f32 v55, v166, v167
    v_exp_f32 v169, v105
    v_exp_f32 v170, v106
    v_exp_f32 v171, v107
    s_waitcnt lgkmcnt(3)
    v_mfma_f32_32x32x16_bf16 v[128:143], v[32:35], v[52:55], v[128:143]
    v_exp_f32 v172, v108
    v_exp_f32 v173, v109
    v_exp_f32 v174, v110
    v_cvt_pk_bf16_f32 v56, v168, v169
    v_mfma_f32_16x16x32_bf16 v[44:47], v[40:43], v[52:55], v[44:47]
    v_exp_f32 v175, v111
    v_cvt_pk_bf16_f32 v57, v170, v171
    v_cvt_pk_bf16_f32 v58, v172, v173
    v_cvt_pk_bf16_f32 v59, v174, v175
    v_exp_f32 v160, v112
    v_exp_f32 v161, v113
    s_waitcnt lgkmcnt(2)
    v_mfma_f32_32x32x16_bf16 v[128:143], v[36:39], v[56:59], v[128:143]
    v_exp_f32 v162, v114
    v_exp_f32 v163, v115
    v_exp_f32 v164, v116
    v_mfma_f32_16x16x32_bf16 v[44:47], v[40:43], v[56:59], v[44:47]
    v_exp_f32 v165, v117
    v_cvt_pk_bf16_f32 v52, v160, v161
    v_cvt_pk_bf16_f32 v53, v162, v163
    s_waitcnt lgkmcnt(0)
    v_mfma_f32_32x32x16_bf16 v[96:111], v[24:27], v[8:11], v[64:79]
    v_exp_f32 v166, v118
    v_exp_f32 v167, v119
    v_exp_f32 v168, v120
    v_cvt_pk_bf16_f32 v54, v164, v165
    v_mfma_f32_32x32x16_bf16 v[96:111], v[28:31], v[12:15], v[96:111]
    v_cvt_pk_bf16_f32 v55, v166, v167
    v_exp_f32 v169, v121
    v_exp_f32 v170, v122
    v_exp_f32 v171, v123
    v_mfma_f32_32x32x16_bf16 v[144:159], v[32:35], v[52:55], v[144:159]
    ds_read_b128 v[32:35], v3 offset:6144
    v_exp_f32 v172, v124
    v_exp_f32 v173, v125
    v_exp_f32 v174, v126
    v_cvt_pk_bf16_f32 v56, v168, v169
    v_mfma_f32_16x16x32_bf16 v[48:51], v[40:43], v[52:55], v[48:51]
    buffer_store_dwordx4 v[176:179], v2, s[40:43], s38 offen sc1
    s_add_u32 s38, s38, s39
    v_mfma_f32_16x16x32_bf16 v[188:191], v[176:179], v[184:187], v[188:191]
    v_exp_f32 v175, v127
    v_cvt_pk_bf16_f32 v57, v170, v171
    v_cvt_pk_bf16_f32 v58, v172, v173
    v_cvt_pk_bf16_f32 v59, v174, v175
    v_exp_f32 v160, v96
    v_exp_f32 v161, v97
    v_mfma_f32_32x32x16_bf16 v[144:159], v[36:39], v[56:59], v[144:159]
    ds_read_b128 v[36:39], v3 offset:7168
    v_exp_f32 v162, v98
    v_exp_f32 v163, v99
    v_exp_f32 v164, v100
    v_mfma_f32_16x16x32_bf16 v[48:51], v[40:43], v[56:59], v[48:51]
    v_exp_f32 v165, v101
    v_cvt_pk_bf16_f32 v52, v160, v161
    v_cvt_pk_bf16_f32 v53, v162, v163
    v_mfma_f32_32x32x16_bf16 v[112:127], v[24:27], v[16:19], v[80:95]
    v_exp_f32 v166, v102
    v_exp_f32 v167, v103
    v_exp_f32 v168, v104
    v_cvt_pk_bf16_f32 v54, v164, v165
    v_mfma_f32_32x32x16_bf16 v[112:127], v[28:31], v[20:23], v[112:127]
    ds_read_b128 v[24:27], v3 offset:8192
    ds_read_b128 v[28:31], v3 offset:9216
    v_cvt_pk_bf16_f32 v55, v166, v167
    v_exp_f32 v169, v105
    v_exp_f32 v170, v106
    v_exp_f32 v171, v107
    s_waitcnt lgkmcnt(3)
    v_mfma_f32_32x32x16_bf16 v[128:143], v[32:35], v[52:55], v[128:143]
    v_exp_f32 v172, v108
    v_exp_f32 v173, v109
    v_exp_f32 v174, v110
    v_cvt_pk_bf16_f32 v56, v168, v169
    v_mfma_f32_16x16x32_bf16 v[44:47], v[40:43], v[52:55], v[44:47]
    buffer_store_dwordx4 v[180:183], v2, s[40:43], s38 offen sc1
    s_add_u32 s38, s38, s39
    v_mfma_f32_16x16x32_bf16 v[188:191], v[180:183], v[184:187], v[188:191]
    v_exp_f32 v175, v111
    v_cvt_pk_bf16_f32 v57, v170, v171
    v_cvt_pk_bf16_f32 v58, v172, v173
    v_cvt_pk_bf16_f32 v59, v174, v175
    v_exp_f32 v160, v112
    v_exp_f32 v161, v113
    s_waitcnt lgkmcnt(2)
    v_mfma_f32_32x32x16_bf16 v[128:143], v[36:39], v[56:59], v[128:143]
    v_exp_f32 v162, v114
    v_exp_f32 v163, v115
    v_exp_f32 v164, v116
    v_mfma_f32_16x16x32_bf16 v[44:47], v[40:43], v[56:59], v[44:47]
    v_exp_f32 v165, v117
    v_cvt_pk_bf16_f32 v52, v160, v161
    v_cvt_pk_bf16_f32 v53, v162, v163
    s_waitcnt lgkmcnt(0)
    v_mfma_f32_32x32x16_bf16 v[96:111], v[24:27], v[8:11], v[64:79]
    v_exp_f32 v166, v118
    v_exp_f32 v167, v119
    v_exp_f32 v168, v120
    v_cvt_pk_bf16_f32 v54, v164, v165
    v_mfma_f32_32x32x16_bf16 v[96:111], v[28:31], v[12:15], v[96:111]
    v_cvt_pk_bf16_f32 v55, v166, v167
    v_exp_f32 v169, v121
    v_exp_f32 v170, v122
    v_exp_f32 v171, v123
    v_mfma_f32_32x32x16_bf16 v[144:159], v[32:35], v[52:55], v[144:159]
    ds_read_b128 v[32:35], v3 offset:10240
    v_exp_f32 v172, v124
    v_exp_f32 v173, v125
    v_exp_f32 v174, v126
    v_cvt_pk_bf16_f32 v56, v168, v169
    v_mfma_f32_16x16x32_bf16 v[48:51], v[40:43], v[52:55], v[48:51]
    s_add_u32 m0, s5, 100352
    s_nop 0
    buffer_load_dwordx4 v60, s[60:63], s52 offen lds
    s_add_u32 s52, s52, s54
    v_exp_f32 v175, v127
    v_cvt_pk_bf16_f32 v57, v170, v171
    v_cvt_pk_bf16_f32 v58, v172, v173
    v_cvt_pk_bf16_f32 v59, v174, v175
    v_exp_f32 v160, v96
    v_exp_f32 v161, v97
    v_mfma_f32_32x32x16_bf16 v[144:159], v[36:39], v[56:59], v[144:159]
    ds_read_b128 v[36:39], v3 offset:11264
    v_exp_f32 v162, v98
    v_exp_f32 v163, v99
    v_exp_f32 v164, v100
    v_mfma_f32_16x16x32_bf16 v[48:51], v[40:43], v[56:59], v[48:51]
    s_cmp_eq_u32 s13, 3
    s_cselect_b32 s4, s58, 0x7ffffff0
    buffer_store_dwordx4 v[188:191], v192, s[48:51], s4 offen sc1
    s_cmp_eq_u32 s13, 7
    s_cselect_b32 s4, s59, 0x7ffffff0
    s_cselect_b32 s7, s101, 0x7ffffff0
    buffer_store_dword v193, v194, s[48:51], s4 offen sc1
    buffer_store_dword v193, v194, s[48:51], s7 offen sc1
    v_exp_f32 v165, v101
    v_cvt_pk_bf16_f32 v52, v160, v161
    v_cvt_pk_bf16_f32 v53, v162, v163
    v_mfma_f32_32x32x16_bf16 v[112:127], v[24:27], v[16:19], v[80:95]
    v_exp_f32 v166, v102
    v_exp_f32 v167, v103
    v_exp_f32 v168, v104
    v_cvt_pk_bf16_f32 v54, v164, v165
    v_mfma_f32_32x32x16_bf16 v[112:127], v[28:31], v[20:23], v[112:127]
    ds_read_b128 v[24:27], v3 offset:12288
    ds_read_b128 v[28:31], v3 offset:13312
    v_cvt_pk_bf16_f32 v55, v166, v167
    v_exp_f32 v169, v105
    v_exp_f32 v170, v106
    v_exp_f32 v171, v107
    s_waitcnt lgkmcnt(3)
    v_mfma_f32_32x32x16_bf16 v[128:143], v[32:35], v[52:55], v[128:143]
    v_exp_f32 v172, v108
    v_exp_f32 v173, v109
    v_exp_f32 v174, v110
    v_cvt_pk_bf16_f32 v56, v168, v169
    v_mfma_f32_16x16x32_bf16 v[44:47], v[40:43], v[52:55], v[44:47]
    v_exp_f32 v175, v111
    v_cvt_pk_bf16_f32 v57, v170, v171
    v_cvt_pk_bf16_f32 v58, v172, v173
    v_cvt_pk_bf16_f32 v59, v174, v175
    v_exp_f32 v160, v112
    v_exp_f32 v161, v113
    s_waitcnt lgkmcnt(2)
    v_mfma_f32_32x32x16_bf16 v[128:143], v[36:39], v[56:59], v[128:143]
    v_exp_f32 v162, v114
    v_exp_f32 v163, v115
    v_exp_f32 v164, v116
    v_mfma_f32_16x16x32_bf16 v[44:47], v[40:43], v[56:59], v[44:47]
    s_add_u32 m0, s5, 101376
    s_nop 0
    buffer_load_dwordx4 v60, s[60:63], s52 offen lds
    s_add_u32 s52, s52, s54
    v_exp_f32 v165, v117
    v_cvt_pk_bf16_f32 v52, v160, v161
    v_cvt_pk_bf16_f32 v53, v162, v163
    s_waitcnt lgkmcnt(0)
    v_mfma_f32_32x32x16_bf16 v[96:111], v[24:27], v[8:11], v[64:79]
    v_exp_f32 v166, v118
    v_exp_f32 v167, v119
    v_exp_f32 v168, v120
    v_cvt_pk_bf16_f32 v54, v164, v165
    v_mfma_f32_32x32x16_bf16 v[96:111], v[28:31], v[12:15], v[96:111]
    v_cvt_pk_bf16_f32 v55, v166, v167
    v_exp_f32 v169, v121
    v_exp_f32 v170, v122
    v_exp_f32 v171, v123
    v_mfma_f32_32x32x16_bf16 v[144:159], v[32:35], v[52:55], v[144:159]
    ds_read_b128 v[32:35], v3 offset:14336
    v_exp_f32 v172, v124
    v_exp_f32 v173, v125
    v_exp_f32 v174, v126
    v_cvt_pk_bf16_f32 v56, v168, v169
    v_mfma_f32_16x16x32_bf16 v[48:51], v[40:43], v[52:55], v[48:51]
    s_mov_b32 s55, s53
    s_mov_b32 s57, s56
    s_cmp_eq_u32 s13, 1
    s_cselect_b32 s60, s95, s18
    s_cselect_b32 s61, s96, s19
    s_cselect_b32 s62, s100, 6291456
    s_cselect_b32 s52, s97, s86
    s_cselect_b32 s53, s98, s87
    s_cselect_b32 s56, s99, 6144
    s_cselect_b32 s54, 2, 6
    s_lshl_b32 s54, s54, 10
    s_cmp_ge_u32 s13, 5
    s_cselect_b32 s62, 0, s62
    v_lshrrev_b32 v60, 2, v0
    v_mul_lo_u32 v60, v60, s54
    v_and_b32 v62, 3, v0
    v_lshl_add_u32 v60, v62, 4, v60
    s_lshl_b32 s54, s54, 4
    v_exp_f32 v175, v127
    v_cvt_pk_bf16_f32 v57, v170, v171
    v_cvt_pk_bf16_f32 v58, v172, v173
    v_cvt_pk_bf16_f32 v59, v174, v175
    v_exp_f32 v160, v96
    v_exp_f32 v161, v97
    v_mfma_f32_32x32x16_bf16 v[144:159], v[36:39], v[56:59], v[144:159]
    ds_read_b128 v[36:39], v3 offset:15360
    v_exp_f32 v162, v98
    v_exp_f32 v163, v99
    v_exp_f32 v164, v100
    v_mfma_f32_16x16x32_bf16 v[48:51], v[40:43], v[56:59], v[48:51]
    v_exp_f32 v165, v101
    v_cvt_pk_bf16_f32 v52, v160, v161
    v_cvt_pk_bf16_f32 v53, v162, v163
    v_mfma_f32_32x32x16_bf16 v[112:127], v[24:27], v[16:19], v[80:95]
    v_exp_f32 v166, v102
    v_exp_f32 v167, v103
    v_exp_f32 v168, v104
    v_cvt_pk_bf16_f32 v54, v164, v165
    v_mfma_f32_32x32x16_bf16 v[112:127], v[28:31], v[20:23], v[112:127]
    s_waitcnt vmcnt(7)
    s_barrier
    ds_read_b128 v[24:27], v4 offset:0
    ds_read_b128 v[28:31], v4 offset:1024
    s_mov_b32 m0, s12
    s_nop 0
    buffer_load_dwordx4 v2, s[44:47], s11 offen offset:0 lds
    v_cvt_pk_bf16_f32 v55, v166, v167
    v_exp_f32 v169, v105
    v_exp_f32 v170, v106
    v_exp_f32 v171, v107
    s_waitcnt lgkmcnt(3)
    v_mfma_f32_32x32x16_bf16 v[128:143], v[32:35], v[52:55], v[128:143]
    v_exp_f32 v172, v108
    v_exp_f32 v173, v109
    v_exp_f32 v174, v110
    v_cvt_pk_bf16_f32 v56, v168, v169
    v_mfma_f32_16x16x32_bf16 v[44:47], v[40:43], v[52:55], v[44:47]
    buffer_load_dwordx4 v2, s[44:47], s11 offen offset:1024 lds
    v_exp_f32 v175, v111
    v_cvt_pk_bf16_f32 v57, v170, v171
    v_cvt_pk_bf16_f32 v58, v172, v173
    v_cvt_pk_bf16_f32 v59, v174, v175
    v_exp_f32 v160, v112
    v_exp_f32 v161, v113
    s_waitcnt lgkmcnt(2)
    v_mfma_f32_32x32x16_bf16 v[128:143], v[36:39], v[56:59], v[128:143]
    v_exp_f32 v162, v114
    v_exp_f32 v163, v115
    v_exp_f32 v164, v116
    v_mfma_f32_16x16x32_bf16 v[44:47], v[40:43], v[56:59], v[44:47]
    buffer_load_dwordx4 v2, s[44:47], s11 offen offset:2048 lds
    v_exp_f32 v165, v117
    v_cvt_pk_bf16_f32 v52, v160, v161
    v_cvt_pk_bf16_f32 v53, v162, v163
    s_waitcnt lgkmcnt(0)
    v_mfma_f32_32x32x16_bf16 v[96:111], v[24:27], v[8:11], v[64:79]
    v_exp_f32 v166, v118
    v_exp_f32 v167, v119
    v_exp_f32 v168, v120
    v_cvt_pk_bf16_f32 v54, v164, v165
    v_mfma_f32_32x32x16_bf16 v[96:111], v[28:31], v[12:15], v[96:111]
    v_cvt_pk_bf16_f32 v55, v166, v167
    v_exp_f32 v169, v121
    v_exp_f32 v170, v122
    v_exp_f32 v171, v123
    v_mfma_f32_32x32x16_bf16 v[144:159], v[32:35], v[52:55], v[144:159]
    ds_read_b128 v[32:35], v4 offset:2048
    v_exp_f32 v172, v124
    v_exp_f32 v173, v125
    v_exp_f32 v174, v126
    v_cvt_pk_bf16_f32 v56, v168, v169
    v_mfma_f32_16x16x32_bf16 v[48:51], v[40:43], v[52:55], v[48:51]
    buffer_load_dwordx4 v2, s[44:47], s11 offen offset:3072 lds
    s_add_u32 s11, s11, 32768
    s_add_u32 s12, s12, 32768
    s_cmp_eq_u32 s12, s6
    s_cselect_b32 s12, s5, s12
    v_exp_f32 v175, v127
    v_cvt_pk_bf16_f32 v57, v170, v171
    v_cvt_pk_bf16_f32 v58, v172, v173
    v_cvt_pk_bf16_f32 v59, v174, v175
    v_exp_f32 v160, v96
    v_exp_f32 v161, v97
    v_mov_b32 v3, v4
    v_add_u32 v4, s14, v63
    s_add_u32 s14, s14, 32768
    s_cmp_eq_u32 s14, 98304
    s_cselect_b32 s14, 0, s14
    s_add_u32 s13, s13, 1
    s_cmp_lt_u32 s13, 8
    s_cbranch_scc1 L_at1_loop
    s_waitcnt vmcnt(0) lgkmcnt(0)
    v_mfma_f32_32x32x16_bf16 v[144:159], v[36:39], v[56:59], v[144:159]
    v_mfma_f32_16x16x32_bf16 v[48:51], v[40:43], v[56:59], v[48:51]
    s_add_u32 s4, s5, 98304
    v_add_u32 v5, s4, v2
    s_xor_b32 s4, s5, 16384
    s_add_u32 s4, s4, 98304
    v_add_u32 v6, s4, v2
    s_lshl_b32 s4, s8, 8
    s_add_u32 s4, s4, 131072
    v_lshl_add_u32 v60, v0, 2, s4
    v_xor_b32 v61, 1024, v60
    s_cmp_eq_u32 s15, 0
    s_cbranch_scc0 L_at1_kh1
    ds_write_b128 v5, v[144:147] offset:0
    ds_write_b128 v5, v[148:151] offset:1024
    ds_write_b128 v5, v[152:155] offset:2048
    ds_write_b128 v5, v[156:159] offset:3072
    ds_write_b32 v60, v48
    s_branch L_at1_khj
L_at1_kh1:
    ds_write_b128 v5, v[128:131] offset:0
    ds_write_b128 v5, v[132:135] offset:1024
    ds_write_b128 v5, v[136:139] offset:2048
    ds_write_b128 v5, v[140:143] offset:3072
    ds_write_b32 v60, v44
    s_waitcnt lgkmcnt(0)
    v_mov_b32 v128, v144
    v_mov_b32 v129, v145
    v_mov_b32 v130, v146
    v_mov_b32 v131, v147
    v_mov_b32 v132, v148
    v_mov_b32 v133, v149
    v_mov_b32 v134, v150
    v_mov_b32 v135, v151
    v_mov_b32 v136, v152
    v_mov_b32 v137, v153
    v_mov_b32 v138, v154
    v_mov_b32 v139, v155
    v_mov_b32 v140, v156
    v_mov_b32 v141, v157
    v_mov_b32 v142, v158
    v_mov_b32 v143, v159
    v_mov_b32 v8, v16
    v_mov_b32 v9, v17
    v_mov_b32 v10, v18
    v_mov_b32 v11, v19
    v_mov_b32 v12, v20
    v_mov_b32 v13, v21
    v_mov_b32 v14, v22
    v_mov_b32 v15, v23
    v_mov_b32 v44, v48
    v_mov_b32 v64, v80
    s_add_u32 s10, s10, 1
L_at1_khj:
    s_waitcnt lgkmcnt(0)
    s_barrier
    ds_read_b128 v[160:163], v6 offset:0
    ds_read_b128 v[164:167], v6 offset:1024
    ds_read_b128 v[168:171], v6 offset:2048
    ds_read_b128 v[172:175], v6 offset:3072
    ds_read_b32 v5, v61
    s_waitcnt lgkmcnt(0)
    v_add_f32 v128, v128, v160
    v_add_f32 v129, v129, v161
    v_add_f32 v130, v130, v162
    v_add_f32 v131, v131, v163
    v_add_f32 v132, v132, v164
    v_add_f32 v133, v133, v165
    v_add_f32 v134, v134, v166
    v_add_f32 v135, v135, v167
    v_add_f32 v136, v136, v168
    v_add_f32 v137, v137, v169
    v_add_f32 v138, v138, v170
    v_add_f32 v139, v139, v171
    v_add_f32 v140, v140, v172
    v_add_f32 v141, v141, v173
    v_add_f32 v142, v142, v174
    v_add_f32 v143, v143, v175
    v_add_f32 v44, v44, v5
    v_mov_b32 v5, v44
    v_max3_f32 v5, v5, abs(v128), abs(v129)
    v_max3_f32 v5, v5, abs(v130), abs(v131)
    v_max3_f32 v5, v5, abs(v132), abs(v133)
    v_max3_f32 v5, v5, abs(v134), abs(v135)
    v_max3_f32 v5, v5, abs(v136), abs(v137)
    v_max3_f32 v5, v5, abs(v138), abs(v139)
    v_max3_f32 v5, v5, abs(v140), abs(v141)
    v_max3_f32 v5, v5, abs(v142), abs(v143)
    v_mov_b32 v6, v44
    v_add_f32 v6, v6, v128
    v_add_f32 v6, v6, v129
    v_add_f32 v6, v6, v130
    v_add_f32 v6, v6, v131
    v_add_f32 v6, v6, v132
    v_add_f32 v6, v6, v133
    v_add_f32 v6, v6, v134
    v_add_f32 v6, v6, v135
    v_add_f32 v6, v6, v136
    v_add_f32 v6, v6, v137
    v_add_f32 v6, v6, v138
    v_add_f32 v6, v6, v139
    v_add_f32 v6, v6, v140
    v_add_f32 v6, v6, v141
    v_add_f32 v6, v6, v142
    v_add_f32 v6, v6, v143
    s_mov_b32 s4, 0x5d800000
    v_cmp_nle_f32 vcc, v5, s4
    v_cmp_u_f32 s[6:7], v6, v6
    s_nop 0
    s_or_b64 vcc, vcc, s[6:7]
    s_nop 1
    s_cbranch_vccz L_at1_fin
    v_sub_f32 v3, 0, v64
    v_mov_b32 v4, 0
    s_lshl_b32 s11, s9, 18
    s_mov_b32 s13, 0
    v_mov_b32 v128, 0
    v_mov_b32 v129, 0
    v_mov_b32 v130, 0
    v_mov_b32 v131, 0
    v_mov_b32 v132, 0
    v_mov_b32 v133, 0
    v_mov_b32 v134, 0
    v_mov_b32 v135, 0
    v_mov_b32 v136, 0
    v_mov_b32 v137, 0
    v_mov_b32 v138, 0
    v_mov_b32 v139, 0
    v_mov_b32 v140, 0
    v_mov_b32 v141, 0
    v_mov_b32 v142, 0
    v_mov_b32 v143, 0
L_at1_slow:
    buffer_load_dwordx4 v[24:27], v2, s[44:47], s11 offen
    buffer_load_dwordx4 v[28:31], v2, s[44:47], s11 offen offset:1024
    buffer_load_dwordx4 v[32:35], v2, s[44:47], s11 offen offset:2048
    buffer_load_dwordx4 v[36:39], v2, s[44:47], s11 offen offset:3072
    s_waitcnt vmcnt(0)
    v_mfma_f32_32x32x16_bf16 v[112:127], v[24:27], v[8:11], 0
    v_mfma_f32_32x32x16_bf16 v[112:127], v[28:31], v[12:15], v[112:127]
    s_nop 11
    v_max3_f32 v5, v112, v113, v114
    v_max3_f32 v5, v5, v115, v116
    v_max3_f32 v5, v5, v117, v118
    v_max3_f32 v5, v5, v119, v120
    v_max3_f32 v5, v5, v121, v122
    v_max3_f32 v5, v5, v123, v124
    v_max3_f32 v5, v5, v125, v126
    v_max_f32 v5, v5, v127
    v_mov_b32 v6, v5
    s_nop 1
    v_permlane32_swap_b32 v5, v6
    v_max3_f32 v5, v5, v6, v3
    v_sub_f32 v7, v3, v5
    v_exp_f32 v7, v7
    v_mov_b32 v3, v5
    v_mul_f32 v4, v4, v7
    v_sub_f32 v160, v112, v3
    v_sub_f32 v161, v113, v3
    v_sub_f32 v162, v114, v3
    v_sub_f32 v163, v115, v3
    v_sub_f32 v164, v116, v3
    v_sub_f32 v165, v117, v3
    v_sub_f32 v166, v118, v3
    v_sub_f32 v167, v119, v3
    v_sub_f32 v168, v120, v3
    v_sub_f32 v169, v121, v3
    v_sub_f32 v170, v122, v3
    v_sub_f32 v171, v123, v3
    v_sub_f32 v172, v124, v3
    v_sub_f32 v173, v125, v3
    v_sub_f32 v174, v126, v3
    v_sub_f32 v175, v127, v3
    v_exp_f32 v160, v160
    v_exp_f32 v161, v161
    v_exp_f32 v162, v162
    v_exp_f32 v163, v163
    v_exp_f32 v164, v164
    v_exp_f32 v165, v165
    v_exp_f32 v166, v166
    v_exp_f32 v167, v167
    v_exp_f32 v168, v168
    v_exp_f32 v169, v169
    v_exp_f32 v170, v170
    v_exp_f32 v171, v171
    v_exp_f32 v172, v172
    v_exp_f32 v173, v173
    v_exp_f32 v174, v174
    v_exp_f32 v175, v175
    v_mul_f32 v128, v128, v7
    v_mul_f32 v129, v129, v7
    v_mul_f32 v130, v130, v7
    v_mul_f32 v131, v131, v7
    v_mul_f32 v132, v132, v7
    v_mul_f32 v133, v133, v7
    v_mul_f32 v134, v134, v7
    v_mul_f32 v135, v135, v7
    v_mul_f32 v136, v136, v7
    v_mul_f32 v137, v137, v7
    v_mul_f32 v138, v138, v7
    v_mul_f32 v139, v139, v7
    v_mul_f32 v140, v140, v7
    v_mul_f32 v141, v141, v7
    v_mul_f32 v142, v142, v7
    v_mul_f32 v143, v143, v7
    v_cvt_pk_bf16_f32 v52, v160, v161
    v_cvt_pk_bf16_f32 v53, v162, v163
    v_cvt_pk_bf16_f32 v54, v164, v165
    v_cvt_pk_bf16_f32 v55, v166, v167
    v_cvt_pk_bf16_f32 v56, v168, v169
    v_cvt_pk_bf16_f32 v57, v170, v171
    v_cvt_pk_bf16_f32 v58, v172, v173
    v_cvt_pk_bf16_f32 v59, v174, v175
    v_lshlrev_b32 v5, 16, v52
    v_and_b32 v6, 0xffff0000, v52
    v_add_f32 v4, v4, v5
    v_add_f32 v4, v4, v6
    v_lshlrev_b32 v5, 16, v53
    v_and_b32 v6, 0xffff0000, v53
    v_add_f32 v4, v4, v5
    v_add_f32 v4, v4, v6
    v_lshlrev_b32 v5, 16, v54
    v_and_b32 v6, 0xffff0000, v54
    v_add_f32 v4, v4, v5
    v_add_f32 v4, v4, v6
    v_lshlrev_b32 v5, 16, v55
    v_and_b32 v6, 0xffff0000, v55
    v_add_f32 v4, v4, v5
    v_add_f32 v4, v4, v6
    v_lshlrev_b32 v5, 16, v56
    v_and_b32 v6, 0xffff0000, v56
    v_add_f32 v4, v4, v5
    v_add_f32 v4, v4, v6
    v_lshlrev_b32 v5, 16, v57
    v_and_b32 v6, 0xffff0000, v57
    v_add_f32 v4, v4, v5
    v_add_f32 v4, v4, v6
    v_lshlrev_b32 v5, 16, v58
    v_and_b32 v6, 0xffff0000, v58
    v_add_f32 v4, v4, v5
    v_add_f32 v4, v4, v6
    v_lshlrev_b32 v5, 16, v59
    v_and_b32 v6, 0xffff0000, v59
    v_add_f32 v4, v4, v5
    v_add_f32 v4, v4, v6
    v_mfma_f32_32x32x16_bf16 v[128:143], v[32:35], v[52:55], v[128:143]
    v_mfma_f32_32x32x16_bf16 v[128:143], v[36:39], v[56:59], v[128:143]
    s_add_u32 s11, s11, 4096
    s_add_u32 s13, s13, 1
    s_cmp_lt_u32 s13, 64
    s_cbranch_scc1 L_at1_slow
    v_mov_b32 v5, v4
    s_nop 1
    v_permlane32_swap_b32 v4, v5
    v_add_f32 v44, v4, v5
L_at1_fin:
    s_add_u32 s48, s36, 12582912
    s_addc_u32 s49, s37, 0
    s_mov_b32 s50, 4194304
    s_mov_b32 s51, 0x20000
    v_rcp_f32 v5, v44
    s_lshl_b32 s4, s10, 16
    s_lshl_b32 s7, s9, 11
    s_add_u32 s4, s4, s7
    v_mul_f32 v160, v128, v5
    v_mul_f32 v161, v129, v5
    v_mul_f32 v162, v130, v5
    v_mul_f32 v163, v131, v5
    v_mul_f32 v164, v132, v5
    v_mul_f32 v165, v133, v5
    v_mul_f32 v166, v134, v5
    v_mul_f32 v167, v135, v5
    v_mul_f32 v168, v136, v5
    v_mul_f32 v169, v137, v5
    v_mul_f32 v170, v138, v5
    v_mul_f32 v171, v139, v5
    v_mul_f32 v172, v140, v5
    v_mul_f32 v173, v141, v5
    v_mul_f32 v174, v142, v5
    v_mul_f32 v175, v143, v5
    v_cvt_pk_bf16_f32 v52, v160, v161
    v_cvt_pk_bf16_f32 v53, v162, v163
    v_cvt_pk_bf16_f32 v54, v164, v165
    v_cvt_pk_bf16_f32 v55, v166, v167
    v_cvt_pk_bf16_f32 v56, v168, v169
    v_cvt_pk_bf16_f32 v57, v170, v171
    v_cvt_pk_bf16_f32 v58, v172, v173
    v_cvt_pk_bf16_f32 v59, v174, v175
    buffer_store_dwordx4 v[52:55], v2, s[48:51], s4 offen sc1
    buffer_store_dwordx4 v[56:59], v2, s[48:51], s4 offen offset:1024 sc1
    s_add_u32 s52, s36, 48234496
    s_addc_u32 s53, s37, 0
    s_mov_b32 s54, 1048576
    s_mov_b32 s55, 0x20000
    s_lshl_b32 s4, s10, 11
    s_lshl_b32 s5, s9, 2
    s_add_u32 s4, s4, s5
    s_add_u32 s4, s4, 524288
    v_and_b32 v7, 15, v0
    v_lshlrev_b32 v7, 7, v7
    v_mov_b32 v5, 0
    v_mov_b32 v6, 1
    s_waitcnt vmcnt(0)
    s_mov_b64 exec, 0xffff
    buffer_store_dword v6, v7, s[52:55], s4 offen sc1
    s_mov_b64 exec, -1
    s_barrier
    s_lshr_b32 s4, s2, 4
    s_lshl_b32 s4, s4, 7
    s_and_b32 s5, s2, 15
    s_lshl_b32 s5, s5, 2
    s_add_u32 s4, s4, s5
    s_add_u32 s4, s4, 692224
    s_cmp_eq_u32 s8, 0
    s_cselect_b32 s4, s4, 0x7ffffff0
    buffer_store_dword v6, v5, s[52:55], s4 offen sc1
L_at1_end:
    s_and_b32 s10, s94, 3
    s_cmp_lt_u32 s94, 4
    s_cbranch_scc1 L_rest_kernel_c1
    s_setprio 0
    s_and_b32 s4, s2, 7
    s_lshr_b32 s5, s2, 3
    s_and_b32 s6, s4, 1
    s_lshr_b32 s7, s4, 1
    s_mul_i32 s9, s6, 8
    s_and_b32 s6, s5, 7
    s_add_u32 s9, s9, s6
    s_mul_i32 s8, s7, 4
    s_lshr_b32 s6, s5, 3
    s_add_u32 s8, s8, s6
    s_lshl_b32 s4, s8, 2
    s_add_u32 s4, s4, s10
    s_mul_i32 s48, s4, 65536
    v_lshlrev_b32 v8, 4, v0
    s_mul_i32 s49, s9, 131072
    s_mul_i32 s6, s10, 2048
    s_add_u32 s49, s49, s6
    v_add_u32 v12, 4096, v8
    s_lshl_b32 s5, s10, 12
    s_add_u32 s6, s6, 16384
    s_mov_b32 s50, 0
    s_waitcnt lgkmcnt(0)
    s_add_u32 s40, s36, 12582912
    s_addc_u32 s41, s37, 0
    s_mov_b32 s42, 4194304
    s_mov_b32 s43, 0x20000
    s_add_u32 s44, s36, 60817408
    s_addc_u32 s45, s37, 0
    s_mov_b32 s46, 2097152
    s_mov_b32 s47, 0x20000
    s_add_u32 s56, s36, 48234496
    s_addc_u32 s57, s37, 0
    s_mov_b32 s58, 1048576
    s_mov_b32 s59, 0x20000
    s_lshl_b32 s4, s9, 7
    s_add_u32 s4, s4, 688128
    v_and_b32 v20, 31, v0
    v_lshlrev_b32 v20, 2, v20
    s_mov_b32 s60, 0x40000
L_wo1_ww_poll:
    buffer_load_dword v21, v20, s[56:59], s4 offen sc1
    s_waitcnt vmcnt(0)
    v_cmp_ne_u32 vcc, 1, v21
    s_nop 4
    s_cbranch_vccz L_wo1_ww_got
    s_sleep 4
    s_sub_u32 s60, s60, 1
    s_cmp_lg_u32 s60, 0
    s_cbranch_scc1 L_wo1_ww_poll
L_wo1_ww_got:
    s_add_u32 m0, s50, s6
    s_nop 0
    buffer_load_dwordx4 v8, s[44:47], s49 offen offset:0 sc1 lds
    buffer_load_dwordx4 v8, s[44:47], s49 offen offset:1024 sc1 lds
    s_add_u32 s49, s49, 8192
    s_add_u32 s50, s50, 24576
    s_cmp_eq_u32 s50, 147456
    s_cselect_b32 s50, 0, s50
    s_add_u32 m0, s50, s6
    s_nop 0
    buffer_load_dwordx4 v8, s[44:47], s49 offen offset:0 sc1 lds
    buffer_load_dwordx4 v8, s[44:47], s49 offen offset:1024 sc1 lds
    s_add_u32 s49, s49, 8192
    s_add_u32 s50, s50, 24576
    s_cmp_eq_u32 s50, 147456
    s_cselect_b32 s50, 0, s50
    s_add_u32 m0, s50, s6
    s_nop 0
    buffer_load_dwordx4 v8, s[44:47], s49 offen offset:0 sc1 lds
    buffer_load_dwordx4 v8, s[44:47], s49 offen offset:1024 sc1 lds
    s_add_u32 s49, s49, 8192
    s_add_u32 s50, s50, 24576
    s_cmp_eq_u32 s50, 147456
    s_cselect_b32 s50, 0, s50
    s_add_u32 m0, s50, s6
    s_nop 0
    buffer_load_dwordx4 v8, s[44:47], s49 offen offset:0 sc1 lds
    buffer_load_dwordx4 v8, s[44:47], s49 offen offset:1024 sc1 lds
    s_add_u32 s49, s49, 8192
    s_add_u32 s50, s50, 24576
    s_cmp_eq_u32 s50, 147456
    s_cselect_b32 s50, 0, s50
    s_mov_b32 s50, 0
    s_lshl_b32 s4, s8, 2
    s_add_u32 s4, s4, s10
    s_lshl_b32 s4, s4, 4
    s_add_u32 s4, s4, s9
    s_lshl_b32 s4, s4, 7
    s_add_u32 s4, s4, 524288
    v_and_b32 v20, 31, v0
    v_lshlrev_b32 v20, 2, v20
    s_mov_b32 s60, 0x40000
L_wo1_w_poll:
    buffer_load_dword v21, v20, s[56:59], s4 offen sc1
    s_waitcnt vmcnt(0)
    v_cmp_ne_u32 vcc, 1, v21
    s_nop 4
    s_cbranch_vccz L_wo1_w_got
    s_sleep 4
    s_sub_u32 s60, s60, 1
    s_cmp_lg_u32 s60, 0
    s_cbranch_scc1 L_wo1_w_poll
L_wo1_w_got:
    s_add_u32 m0, s50, s5
    s_nop 0
    buffer_load_dwordx4 v8, s[40:43], s48 offen offset:0 sc1 lds
    buffer_load_dwordx4 v8, s[40:43], s48 offen offset:1024 sc1 lds
    buffer_load_dwordx4 v8, s[40:43], s48 offen offset:2048 sc1 lds
    buffer_load_dwordx4 v8, s[40:43], s48 offen offset:3072 sc1 lds
    s_add_u32 s48, s48, 4096
    s_add_u32 s50, s50, 24576
    s_cmp_eq_u32 s50, 147456
    s_cselect_b32 s50, 0, s50
    s_add_u32 m0, s50, s5
    s_nop 0
    buffer_load_dwordx4 v8, s[40:43], s48 offen offset:0 sc1 lds
    buffer_load_dwordx4 v8, s[40:43], s48 offen offset:1024 sc1 lds
    buffer_load_dwordx4 v8, s[40:43], s48 offen offset:2048 sc1 lds
    buffer_load_dwordx4 v8, s[40:43], s48 offen offset:3072 sc1 lds
    s_add_u32 s48, s48, 4096
    s_add_u32 s50, s50, 24576
    s_cmp_eq_u32 s50, 147456
    s_cselect_b32 s50, 0, s50
    s_waitcnt vmcnt(4)
    s_barrier
    s_add_u32 m0, s50, s5
    s_nop 0
    buffer_load_dwordx4 v8, s[40:43], s48 offen offset:0 sc1 lds
    buffer_load_dwordx4 v8, s[40:43], s48 offen offset:1024 sc1 lds
    buffer_load_dwordx4 v8, s[40:43], s48 offen offset:2048 sc1 lds
    buffer_load_dwordx4 v8, s[40:43], s48 offen offset:3072 sc1 lds
    s_add_u32 s48, s48, 4096
    s_add_u32 s50, s50, 24576
    s_cmp_eq_u32 s50, 147456
    s_cselect_b32 s50, 0, s50
    s_add_u32 m0, s50, s5
    s_nop 0
    buffer_load_dwordx4 v8, s[40:43], s48 offen offset:0 sc1 lds
    buffer_load_dwordx4 v8, s[40:43], s48 offen offset:1024 sc1 lds
    buffer_load_dwordx4 v8, s[40:43], s48 offen offset:2048 sc1 lds
    buffer_load_dwordx4 v8, s[40:43], s48 offen offset:3072 sc1 lds
    s_add_u32 s48, s48, 4096
    s_add_u32 s50, s50, 24576
    s_cmp_eq_u32 s50, 147456
    s_cselect_b32 s50, 0, s50
    s_waitcnt vmcnt(8)
    s_barrier
    s_add_u32 m0, s50, s5
    s_nop 0
    buffer_load_dwordx4 v8, s[40:43], s48 offen offset:0 sc1 lds
    buffer_load_dwordx4 v8, s[40:43], s48 offen offset:1024 sc1 lds
    buffer_load_dwordx4 v8, s[40:43], s48 offen offset:2048 sc1 lds
    buffer_load_dwordx4 v8, s[40:43], s48 offen offset:3072 sc1 lds
    s_add_u32 m0, s50, s6
    s_nop 0
    buffer_load_dwordx4 v8, s[44:47], s49 offen offset:0 sc1 lds
    buffer_load_dwordx4 v8, s[44:47], s49 offen offset:1024 sc1 lds
    s_add_u32 s48, s48, 4096
    s_add_u32 s49, s49, 8192
    s_add_u32 s50, s50, 24576
    s_cmp_eq_u32 s50, 147456
    s_cselect_b32 s50, 0, s50
    s_add_u32 m0, s50, s5
    s_nop 0
    buffer_load_dwordx4 v8, s[40:43], s48 offen offset:0 sc1 lds
    buffer_load_dwordx4 v8, s[40:43], s48 offen offset:1024 sc1 lds
    buffer_load_dwordx4 v8, s[40:43], s48 offen offset:2048 sc1 lds
    buffer_load_dwordx4 v8, s[40:43], s48 offen offset:3072 sc1 lds
    s_add_u32 m0, s50, s6
    s_nop 0
    buffer_load_dwordx4 v8, s[44:47], s49 offen offset:0 sc1 lds
    buffer_load_dwordx4 v8, s[44:47], s49 offen offset:1024 sc1 lds
    s_add_u32 s48, s48, 4096
    s_add_u32 s49, s49, 8192
    s_add_u32 s50, s50, 24576
    s_cmp_eq_u32 s50, 147456
    s_cselect_b32 s50, 0, s50
    s_waitcnt vmcnt(16)
    s_barrier
    s_add_u32 m0, s50, s5
    s_nop 0
    buffer_load_dwordx4 v8, s[40:43], s48 offen offset:0 sc1 lds
    buffer_load_dwordx4 v8, s[40:43], s48 offen offset:1024 sc1 lds
    buffer_load_dwordx4 v8, s[40:43], s48 offen offset:2048 sc1 lds
    buffer_load_dwordx4 v8, s[40:43], s48 offen offset:3072 sc1 lds
    s_add_u32 m0, s50, s6
    s_nop 0
    buffer_load_dwordx4 v8, s[44:47], s49 offen offset:0 sc1 lds
    buffer_load_dwordx4 v8, s[44:47], s49 offen offset:1024 sc1 lds
    s_add_u32 s48, s48, 4096
    s_add_u32 s49, s49, 8192
    s_add_u32 s50, s50, 24576
    s_cmp_eq_u32 s50, 147456
    s_cselect_b32 s50, 0, s50
    s_add_u32 m0, s50, s5
    s_nop 0
    buffer_load_dwordx4 v8, s[40:43], s48 offen offset:0 sc1 lds
    buffer_load_dwordx4 v8, s[40:43], s48 offen offset:1024 sc1 lds
    buffer_load_dwordx4 v8, s[40:43], s48 offen offset:2048 sc1 lds
    buffer_load_dwordx4 v8, s[40:43], s48 offen offset:3072 sc1 lds
    s_add_u32 m0, s50, s6
    s_nop 0
    buffer_load_dwordx4 v8, s[44:47], s49 offen offset:0 sc1 lds
    buffer_load_dwordx4 v8, s[44:47], s49 offen offset:1024 sc1 lds
    s_add_u32 s48, s48, 4096
    s_add_u32 s49, s49, 8192
    s_add_u32 s50, s50, 24576
    s_cmp_eq_u32 s50, 147456
    s_cselect_b32 s50, 0, s50
    s_mov_b32 s51, 8
L_wo1_ld_loop:
    s_waitcnt vmcnt(24)
    s_barrier
    s_add_u32 m0, s50, s5
    s_nop 0
    buffer_load_dwordx4 v8, s[40:43], s48 offen offset:0 sc1 lds
    buffer_load_dwordx4 v8, s[40:43], s48 offen offset:1024 sc1 lds
    buffer_load_dwordx4 v8, s[40:43], s48 offen offset:2048 sc1 lds
    buffer_load_dwordx4 v8, s[40:43], s48 offen offset:3072 sc1 lds
    s_add_u32 m0, s50, s6
    s_nop 0
    buffer_load_dwordx4 v8, s[44:47], s49 offen offset:0 sc1 lds
    buffer_load_dwordx4 v8, s[44:47], s49 offen offset:1024 sc1 lds
    s_add_u32 s48, s48, 4096
    s_add_u32 s49, s49, 8192
    s_add_u32 s50, s50, 24576
    s_cmp_eq_u32 s50, 147456
    s_cselect_b32 s50, 0, s50
    s_sub_u32 s51, s51, 1
    s_cmp_lg_u32 s51, 0
    s_cbranch_scc1 L_wo1_ld_loop
    s_waitcnt vmcnt(24)
    s_barrier
    s_waitcnt vmcnt(18)
    s_barrier
    s_waitcnt vmcnt(12)
    s_barrier
    s_waitcnt vmcnt(6)
    s_barrier
    s_waitcnt vmcnt(0)
    s_barrier
    s_barrier
    s_setprio 0
    s_and_b32 s4, s2, 7
    s_lshr_b32 s5, s2, 3
    s_and_b32 s6, s4, 3
    s_lshr_b32 s7, s4, 2
    s_mul_i32 s9, s6, 4
    s_and_b32 s6, s5, 3
    s_add_u32 s9, s9, s6
    s_mul_i32 s8, s7, 8
    s_lshr_b32 s6, s5, 2
    s_add_u32 s8, s8, s6
    s_lshl_b32 s4, s8, 2
    s_add_u32 s4, s4, s10
    s_mul_i32 s48, s4, 65536
    v_lshlrev_b32 v8, 4, v0
    s_mul_i32 s49, s9, 458752
    s_mul_i32 s6, s10, 7168
    s_add_u32 s49, s49, s6
    v_add_u32 v12, 4096, v8
    s_lshl_b32 s5, s10, 12
    s_add_u32 s6, s6, 16384
    s_mov_b32 s50, 0
    s_waitcnt lgkmcnt(0)
    s_add_u32 s40, s36, 33554432
    s_addc_u32 s41, s37, 0
    s_mov_b32 s42, 4194304
    s_mov_b32 s43, 0x20000
    s_add_u32 s44, s36, 62914560
    s_addc_u32 s45, s37, 0
    s_mov_b32 s46, 7340032
    s_mov_b32 s47, 0x20000
    s_add_u32 s56, s36, 48234496
    s_addc_u32 s57, s37, 0
    s_mov_b32 s58, 1048576
    s_mov_b32 s59, 0x20000
    s_lshr_b32 s4, s2, 4
    s_lshl_b32 s4, s4, 7
    s_add_u32 s4, s4, 696320
    v_and_b32 v20, 15, v0
    v_lshlrev_b32 v20, 2, v20
    s_mov_b32 s60, 0x40000
L_w1a_ww_poll:
    buffer_load_dword v21, v20, s[56:59], s4 offen sc1
    s_waitcnt vmcnt(0)
    v_cmp_ne_u32 vcc, 1, v21
    s_nop 4
    s_cbranch_vccz L_w1a_ww_got
    s_sleep 4
    s_sub_u32 s60, s60, 1
    s_cmp_lg_u32 s60, 0
    s_cbranch_scc1 L_w1a_ww_poll
L_w1a_ww_got:
    s_add_u32 m0, s50, s6
    s_nop 0
    buffer_load_dwordx4 v8, s[44:47], s49 offen offset:0 sc1 lds
    buffer_load_dwordx4 v8, s[44:47], s49 offen offset:1024 sc1 lds
    buffer_load_dwordx4 v8, s[44:47], s49 offen offset:2048 sc1 lds
    buffer_load_dwordx4 v8, s[44:47], s49 offen offset:3072 sc1 lds
    s_add_u32 m0, m0, 4096
    s_nop 0
    buffer_load_dwordx4 v12, s[44:47], s49 offen offset:0 sc1 lds
    buffer_load_dwordx4 v12, s[44:47], s49 offen offset:1024 sc1 lds
    buffer_load_dwordx4 v12, s[44:47], s49 offen offset:2048 sc1 lds
    s_add_u32 s49, s49, 28672
    s_add_u32 s50, s50, 45056
    s_cmp_eq_u32 s50, 135168
    s_cselect_b32 s50, 0, s50
    s_add_u32 m0, s50, s6
    s_nop 0
    buffer_load_dwordx4 v8, s[44:47], s49 offen offset:0 sc1 lds
    buffer_load_dwordx4 v8, s[44:47], s49 offen offset:1024 sc1 lds
    buffer_load_dwordx4 v8, s[44:47], s49 offen offset:2048 sc1 lds
    buffer_load_dwordx4 v8, s[44:47], s49 offen offset:3072 sc1 lds
    s_add_u32 m0, m0, 4096
    s_nop 0
    buffer_load_dwordx4 v12, s[44:47], s49 offen offset:0 sc1 lds
    buffer_load_dwordx4 v12, s[44:47], s49 offen offset:1024 sc1 lds
    buffer_load_dwordx4 v12, s[44:47], s49 offen offset:2048 sc1 lds
    s_add_u32 s49, s49, 28672
    s_add_u32 s50, s50, 45056
    s_cmp_eq_u32 s50, 135168
    s_cselect_b32 s50, 0, s50
    s_add_u32 m0, s50, s6
    s_nop 0
    buffer_load_dwordx4 v8, s[44:47], s49 offen offset:0 sc1 lds
    buffer_load_dwordx4 v8, s[44:47], s49 offen offset:1024 sc1 lds
    buffer_load_dwordx4 v8, s[44:47], s49 offen offset:2048 sc1 lds
    buffer_load_dwordx4 v8, s[44:47], s49 offen offset:3072 sc1 lds
    s_add_u32 m0, m0, 4096
    s_nop 0
    buffer_load_dwordx4 v12, s[44:47], s49 offen offset:0 sc1 lds
    buffer_load_dwordx4 v12, s[44:47], s49 offen offset:1024 sc1 lds
    buffer_load_dwordx4 v12, s[44:47], s49 offen offset:2048 sc1 lds
    s_add_u32 s49, s49, 28672
    s_add_u32 s50, s50, 45056
    s_cmp_eq_u32 s50, 135168
    s_cselect_b32 s50, 0, s50
    s_mov_b32 s50, 0
    s_lshl_b32 s4, s8, 2
    s_add_u32 s4, s4, s10
    s_lshl_b32 s4, s4, 4
    s_add_u32 s4, s4, s9
    s_lshl_b32 s4, s4, 7
    s_add_u32 s4, s4, 131072
    v_and_b32 v20, 15, v0
    v_lshlrev_b32 v20, 2, v20
    s_mov_b32 s60, 0x40000
L_w1a_w_poll:
    buffer_load_dword v21, v20, s[56:59], s4 offen sc1
    s_waitcnt vmcnt(0)
    v_cmp_ne_u32 vcc, 1, v21
    s_nop 4
    s_cbranch_vccz L_w1a_w_got
    s_sleep 4
    s_sub_u32 s60, s60, 1
    s_cmp_lg_u32 s60, 0
    s_cbranch_scc1 L_w1a_w_poll
L_w1a_w_got:
    s_add_u32 m0, s50, s5
    s_nop 0
    buffer_load_dwordx4 v8, s[40:43], s48 offen offset:0 sc1 lds
    buffer_load_dwordx4 v8, s[40:43], s48 offen offset:1024 sc1 lds
    buffer_load_dwordx4 v8, s[40:43], s48 offen offset:2048 sc1 lds
    buffer_load_dwordx4 v8, s[40:43], s48 offen offset:3072 sc1 lds
    s_add_u32 s48, s48, 4096
    s_add_u32 s50, s50, 45056
    s_cmp_eq_u32 s50, 135168
    s_cselect_b32 s50, 0, s50
    s_add_u32 m0, s50, s5
    s_nop 0
    buffer_load_dwordx4 v8, s[40:43], s48 offen offset:0 sc1 lds
    buffer_load_dwordx4 v8, s[40:43], s48 offen offset:1024 sc1 lds
    buffer_load_dwordx4 v8, s[40:43], s48 offen offset:2048 sc1 lds
    buffer_load_dwordx4 v8, s[40:43], s48 offen offset:3072 sc1 lds
    s_add_u32 s48, s48, 4096
    s_add_u32 s50, s50, 45056
    s_cmp_eq_u32 s50, 135168
    s_cselect_b32 s50, 0, s50
    s_add_u32 s60, s36, 46399488
    s_addc_u32 s61, s37, 0
    s_mov_b32 s62, 229376
    s_mov_b32 s63, 0x20000
    v_min_u32 v5, 55, v0
    v_lshlrev_b32 v5, 2, v5
    s_mul_i32 s4, s9, 896
    s_mul_i32 s7, s10, 224
    s_add_u32 s4, s4, s7
    buffer_load_dword v56, v5, s[60:63], s4 offen sc1
    s_add_u32 s4, s4, 14336
    buffer_load_dword v57, v5, s[60:63], s4 offen sc1
    s_add_u32 s4, s4, 14336
    buffer_load_dword v58, v5, s[60:63], s4 offen sc1
    s_add_u32 s4, s4, 14336
    buffer_load_dword v59, v5, s[60:63], s4 offen sc1
    s_add_u32 s4, s4, 14336
    buffer_load_dword v60, v5, s[60:63], s4 offen sc1
    s_add_u32 s4, s4, 14336
    buffer_load_dword v61, v5, s[60:63], s4 offen sc1
    s_add_u32 s4, s4, 14336
    buffer_load_dword v62, v5, s[60:63], s4 offen sc1
    s_add_u32 s4, s4, 14336
    buffer_load_dword v63, v5, s[60:63], s4 offen sc1
    s_add_u32 s4, s4, 14336
    buffer_load_dword v64, v5, s[60:63], s4 offen sc1
    s_add_u32 s4, s4, 14336
    buffer_load_dword v65, v5, s[60:63], s4 offen sc1
    s_add_u32 s4, s4, 14336
    buffer_load_dword v66, v5, s[60:63], s4 offen sc1
    s_add_u32 s4, s4, 14336
    buffer_load_dword v67, v5, s[60:63], s4 offen sc1
    s_add_u32 s4, s4, 14336
    buffer_load_dword v68, v5, s[60:63], s4 offen sc1
    s_add_u32 s4, s4, 14336
    buffer_load_dword v69, v5, s[60:63], s4 offen sc1
    s_add_u32 s4, s4, 14336
    buffer_load_dword v70, v5, s[60:63], s4 offen sc1
    s_add_u32 s4, s4, 14336
    buffer_load_dword v71, v5, s[60:63], s4 offen sc1
    s_waitcnt vmcnt(20)
    s_barrier
    s_add_u32 m0, s50, s5
    s_nop 0
    buffer_load_dwordx4 v8, s[40:43], s48 offen offset:0 sc1 lds
    buffer_load_dwordx4 v8, s[40:43], s48 offen offset:1024 sc1 lds
    buffer_load_dwordx4 v8, s[40:43], s48 offen offset:2048 sc1 lds
    buffer_load_dwordx4 v8, s[40:43], s48 offen offset:3072 sc1 lds
    s_add_u32 s48, s48, 4096
    s_add_u32 s50, s50, 45056
    s_cmp_eq_u32 s50, 135168
    s_cselect_b32 s50, 0, s50
    s_waitcnt vmcnt(4)
    s_barrier
    s_add_u32 m0, s50, s5
    s_nop 0
    buffer_load_dwordx4 v8, s[40:43], s48 offen offset:0 sc1 lds
    buffer_load_dwordx4 v8, s[40:43], s48 offen offset:1024 sc1 lds
    buffer_load_dwordx4 v8, s[40:43], s48 offen offset:2048 sc1 lds
    buffer_load_dwordx4 v8, s[40:43], s48 offen offset:3072 sc1 lds
    s_add_u32 m0, s50, s6
    s_nop 0
    buffer_load_dwordx4 v8, s[44:47], s49 offen offset:0 sc1 lds
    buffer_load_dwordx4 v8, s[44:47], s49 offen offset:1024 sc1 lds
    buffer_load_dwordx4 v8, s[44:47], s49 offen offset:2048 sc1 lds
    buffer_load_dwordx4 v8, s[44:47], s49 offen offset:3072 sc1 lds
    s_add_u32 m0, m0, 4096
    s_nop 0
    buffer_load_dwordx4 v12, s[44:47], s49 offen offset:0 sc1 lds
    buffer_load_dwordx4 v12, s[44:47], s49 offen offset:1024 sc1 lds
    buffer_load_dwordx4 v12, s[44:47], s49 offen offset:2048 sc1 lds
    s_add_u32 s48, s48, 4096
    s_add_u32 s49, s49, 28672
    s_add_u32 s50, s50, 45056
    s_cmp_eq_u32 s50, 135168
    s_cselect_b32 s50, 0, s50
    s_mov_b32 s51, 12
L_w1a_ld_loop:
    s_waitcnt vmcnt(11)
    s_barrier
    s_add_u32 m0, s50, s5
    s_nop 0
    buffer_load_dwordx4 v8, s[40:43], s48 offen offset:0 sc1 lds
    buffer_load_dwordx4 v8, s[40:43], s48 offen offset:1024 sc1 lds
    buffer_load_dwordx4 v8, s[40:43], s48 offen offset:2048 sc1 lds
    buffer_load_dwordx4 v8, s[40:43], s48 offen offset:3072 sc1 lds
    s_add_u32 m0, s50, s6
    s_nop 0
    buffer_load_dwordx4 v8, s[44:47], s49 offen offset:0 sc1 lds
    buffer_load_dwordx4 v8, s[44:47], s49 offen offset:1024 sc1 lds
    buffer_load_dwordx4 v8, s[44:47], s49 offen offset:2048 sc1 lds
    buffer_load_dwordx4 v8, s[44:47], s49 offen offset:3072 sc1 lds
    s_add_u32 m0, m0, 4096
    s_nop 0
    buffer_load_dwordx4 v12, s[44:47], s49 offen offset:0 sc1 lds
    buffer_load_dwordx4 v12, s[44:47], s49 offen offset:1024 sc1 lds
    buffer_load_dwordx4 v12, s[44:47], s49 offen offset:2048 sc1 lds
    s_add_u32 s48, s48, 4096
    s_add_u32 s49, s49, 28672
    s_add_u32 s50, s50, 45056
    s_cmp_eq_u32 s50, 135168
    s_cselect_b32 s50, 0, s50
    s_sub_u32 s51, s51, 1
    s_cmp_lg_u32 s51, 0
    s_cbranch_scc1 L_w1a_ld_loop
    s_add_u32 s40, s36, 47185920
    s_addc_u32 s41, s37, 0
    s_mov_b32 s42, 262144
    s_mov_b32 s43, 0x20000
    v_and_b32 v3, 31, v0
    v_lshlrev_b32 v3, 3, v3
    v_lshrrev_b32 v4, 5, v0
    v_lshl_add_u32 v3, v4, 17, v3
    s_lshl_b32 s4, s8, 10
    s_lshl_b32 s7, s10, 8
    s_add_u32 s4, s4, s7
    buffer_load_dwordx2 v[32:33], v3, s[40:43], s4 offen sc1
    s_add_u32 s4, s4, 16384
    buffer_load_dwordx2 v[34:35], v3, s[40:43], s4 offen sc1
    s_add_u32 s4, s4, 16384
    buffer_load_dwordx2 v[36:37], v3, s[40:43], s4 offen sc1
    s_add_u32 s4, s4, 16384
    buffer_load_dwordx2 v[38:39], v3, s[40:43], s4 offen sc1
    s_add_u32 s4, s4, 16384
    buffer_load_dwordx2 v[40:41], v3, s[40:43], s4 offen sc1
    s_add_u32 s4, s4, 16384
    buffer_load_dwordx2 v[42:43], v3, s[40:43], s4 offen sc1
    s_add_u32 s4, s4, 16384
    buffer_load_dwordx2 v[44:45], v3, s[40:43], s4 offen sc1
    s_add_u32 s4, s4, 16384
    buffer_load_dwordx2 v[46:47], v3, s[40:43], s4 offen sc1
    s_waitcnt vmcnt(19)
    s_barrier
    s_waitcnt vmcnt(8)
    s_barrier
    s_waitcnt vmcnt(0)
    v_add_f32 v32, v32, v40
    v_add_f32 v33, v33, v41
    v_add_f32 v34, v34, v42
    v_add_f32 v35, v35, v43
    v_add_f32 v36, v36, v44
    v_add_f32 v37, v37, v45
    v_add_f32 v38, v38, v46
    v_add_f32 v39, v39, v47
    v_add_f32 v32, v32, v36
    v_add_f32 v33, v33, v37
    v_add_f32 v34, v34, v38
    v_add_f32 v35, v35, v39
    v_add_f32 v32, v32, v34
    v_add_f32 v33, v33, v35
    v_mov_b32 v34, v32
    s_nop 1
    v_permlane32_swap_b32 v32, v34
    v_add_f32 v32, v32, v34
    v_mov_b32 v34, v33
    s_nop 1
    v_permlane32_swap_b32 v33, v34
    v_add_f32 v33, v33, v34
    v_and_b32 v3, 31, v0
    v_lshlrev_b32 v3, 2, v3
    s_lshl_b32 s4, s10, 7
    s_add_u32 s4, s4, 139264
    v_add_u32 v3, s4, v3
    v_mul_f32 v32, 0x3a800000, v32
    v_mul_f32 v33, 0x3a800000, v33
    v_fma_f32 v33, -v32, v32, v33
    v_max_f32 v33, 0, v33
    v_add_f32 v37, 0x3727c5ac, v33
    v_rsq_f32 v36, v37
    s_nop 0
    v_mul_f32 v37, v36, v36
    v_mul_f32 v37, v37, v33
    v_add_f32 v37, 0x3727c5ac, v37
    v_rsq_f32 v37, v37
    s_nop 0
    v_mul_f32 v36, v36, v37
    v_mul_f32 v32, v32, v36
    v_sub_f32 v32, 0, v32
    ds_write_b32 v3, v36 offset:0
    ds_write_b32 v3, v32 offset:512
    v_add_f32 v56, v56, v64
    v_add_f32 v57, v57, v65
    v_add_f32 v58, v58, v66
    v_add_f32 v59, v59, v67
    v_add_f32 v60, v60, v68
    v_add_f32 v61, v61, v69
    v_add_f32 v62, v62, v70
    v_add_f32 v63, v63, v71
    v_add_f32 v56, v56, v60
    v_add_f32 v57, v57, v61
    v_add_f32 v58, v58, v62
    v_add_f32 v59, v59, v63
    v_add_f32 v56, v56, v58
    v_add_f32 v57, v57, v59
    v_add_f32 v56, v56, v57
    s_mul_i32 s7, s10, 224
    s_add_u32 s7, s7, 148480
    v_add_u32 v5, s7, v5
    ds_write_b32 v5, v56
    s_waitcnt lgkmcnt(0)
    s_barrier
    s_barrier
    s_setprio 0
    s_and_b32 s4, s2, 7
    s_lshr_b32 s5, s2, 3
    s_and_b32 s3, s4, 1
    s_lshr_b32 s7, s4, 1
    s_and_b32 s9, s5, 7
    s_lshl_b32 s8, s7, 2
    s_lshr_b32 s6, s5, 3
    s_add_u32 s8, s8, s6
    s_lshl_b32 s4, s8, 2
    s_add_u32 s4, s4, s10
    s_mul_i32 s48, s4, 229376
    v_lshlrev_b32 v8, 4, v0
    s_mul_i32 s49, s9, 917504
    s_mul_i32 s6, s10, 4096
    s_add_u32 s49, s49, s6
    v_add_u32 v12, 4096, v8
    s_mul_i32 s4, s3, 114688
    s_add_u32 s48, s48, s4
    s_mul_i32 s4, s3, 458752
    s_add_u32 s49, s49, s4
    s_lshl_b32 s5, s10, 12
    s_add_u32 s6, s6, 16384
    s_mov_b32 s50, 0
    s_waitcnt lgkmcnt(0)
    s_add_u32 s40, s36, 16777216
    s_addc_u32 s41, s37, 0
    s_mov_b32 s42, 14680064
    s_mov_b32 s43, 0x20000
    s_add_u32 s44, s36, 71303168
    s_addc_u32 s45, s37, 0
    s_mov_b32 s46, 7340032
    s_mov_b32 s47, 0x20000
    s_add_u32 s56, s36, 48234496
    s_addc_u32 s57, s37, 0
    s_mov_b32 s58, 1048576
    s_mov_b32 s59, 0x20000
    s_add_u32 m0, s50, s6
    s_nop 0
    buffer_load_dwordx4 v8, s[44:47], s49 offen offset:0 sc1 lds
    buffer_load_dwordx4 v8, s[44:47], s49 offen offset:1024 sc1 lds
    buffer_load_dwordx4 v8, s[44:47], s49 offen offset:2048 sc1 lds
    buffer_load_dwordx4 v8, s[44:47], s49 offen offset:3072 sc1 lds
    s_add_u32 s49, s49, 16384
    s_add_u32 s50, s50, 32768
    s_cmp_eq_u32 s50, 163840
    s_cselect_b32 s50, 0, s50
    s_add_u32 m0, s50, s6
    s_nop 0
    buffer_load_dwordx4 v8, s[44:47], s49 offen offset:0 sc1 lds
    buffer_load_dwordx4 v8, s[44:47], s49 offen offset:1024 sc1 lds
    buffer_load_dwordx4 v8, s[44:47], s49 offen offset:2048 sc1 lds
    buffer_load_dwordx4 v8, s[44:47], s49 offen offset:3072 sc1 lds
    s_add_u32 s49, s49, 16384
    s_add_u32 s50, s50, 32768
    s_cmp_eq_u32 s50, 163840
    s_cselect_b32 s50, 0, s50
    s_add_u32 m0, s50, s6
    s_nop 0
    buffer_load_dwordx4 v8, s[44:47], s49 offen offset:0 sc1 lds
    buffer_load_dwordx4 v8, s[44:47], s49 offen offset:1024 sc1 lds
    buffer_load_dwordx4 v8, s[44:47], s49 offen offset:2048 sc1 lds
    buffer_load_dwordx4 v8, s[44:47], s49 offen offset:3072 sc1 lds
    s_add_u32 s49, s49, 16384
    s_add_u32 s50, s50, 32768
    s_cmp_eq_u32 s50, 163840
    s_cselect_b32 s50, 0, s50
    s_add_u32 m0, s50, s6
    s_nop 0
    buffer_load_dwordx4 v8, s[44:47], s49 offen offset:0 sc1 lds
    buffer_load_dwordx4 v8, s[44:47], s49 offen offset:1024 sc1 lds
    buffer_load_dwordx4 v8, s[44:47], s49 offen offset:2048 sc1 lds
    buffer_load_dwordx4 v8, s[44:47], s49 offen offset:3072 sc1 lds
    s_add_u32 s49, s49, 16384
    s_add_u32 s50, s50, 32768
    s_cmp_eq_u32 s50, 163840
    s_cselect_b32 s50, 0, s50
    s_mov_b32 s50, 0
    s_lshl_b32 s4, s8, 1
    s_add_u32 s4, s4, s3
    s_lshl_b32 s4, s4, 3
    s_add_u32 s4, s4, s9
    s_lshl_b32 s4, s4, 2
    s_add_u32 s4, s4, s10
    s_lshl_b32 s4, s4, 7
    s_add_u32 s4, s4, 262144
    v_and_b32 v20, 15, v0
    v_lshlrev_b32 v20, 2, v20
    s_mov_b32 s60, 0x40000
L_w2a_w_poll:
    buffer_load_dword v21, v20, s[56:59], s4 offen sc1
    s_waitcnt vmcnt(0)
    v_cmp_ne_u32 vcc, 1, v21
    s_nop 4
    s_cbranch_vccz L_w2a_w_got
    s_sleep 4
    s_sub_u32 s60, s60, 1
    s_cmp_lg_u32 s60, 0
    s_cbranch_scc1 L_w2a_w_poll
L_w2a_w_got:
    s_add_u32 m0, s50, s5
    s_nop 0
    buffer_load_dwordx4 v8, s[40:43], s48 offen offset:0 sc1 lds
    buffer_load_dwordx4 v8, s[40:43], s48 offen offset:1024 sc1 lds
    buffer_load_dwordx4 v8, s[40:43], s48 offen offset:2048 sc1 lds
    buffer_load_dwordx4 v8, s[40:43], s48 offen offset:3072 sc1 lds
    s_add_u32 s48, s48, 4096
    s_add_u32 s50, s50, 32768
    s_cmp_eq_u32 s50, 163840
    s_cselect_b32 s50, 0, s50
    s_add_u32 m0, s50, s5
    s_nop 0
    buffer_load_dwordx4 v8, s[40:43], s48 offen offset:0 sc1 lds
    buffer_load_dwordx4 v8, s[40:43], s48 offen offset:1024 sc1 lds
    buffer_load_dwordx4 v8, s[40:43], s48 offen offset:2048 sc1 lds
    buffer_load_dwordx4 v8, s[40:43], s48 offen offset:3072 sc1 lds
    s_add_u32 s48, s48, 4096
    s_add_u32 s50, s50, 32768
    s_cmp_eq_u32 s50, 163840
    s_cselect_b32 s50, 0, s50
    s_waitcnt vmcnt(4)
    s_barrier
    s_add_u32 m0, s50, s5
    s_nop 0
    buffer_load_dwordx4 v8, s[40:43], s48 offen offset:0 sc1 lds
    buffer_load_dwordx4 v8, s[40:43], s48 offen offset:1024 sc1 lds
    buffer_load_dwordx4 v8, s[40:43], s48 offen offset:2048 sc1 lds
    buffer_load_dwordx4 v8, s[40:43], s48 offen offset:3072 sc1 lds
    s_add_u32 s48, s48, 4096
    s_add_u32 s50, s50, 32768
    s_cmp_eq_u32 s50, 163840
    s_cselect_b32 s50, 0, s50
    s_add_u32 m0, s50, s5
    s_nop 0
    buffer_load_dwordx4 v8, s[40:43], s48 offen offset:0 sc1 lds
    buffer_load_dwordx4 v8, s[40:43], s48 offen offset:1024 sc1 lds
    buffer_load_dwordx4 v8, s[40:43], s48 offen offset:2048 sc1 lds
    buffer_load_dwordx4 v8, s[40:43], s48 offen offset:3072 sc1 lds
    s_add_u32 s48, s48, 4096
    s_add_u32 s50, s50, 32768
    s_cmp_eq_u32 s50, 163840
    s_cselect_b32 s50, 0, s50
    s_waitcnt vmcnt(8)
    s_barrier
    s_add_u32 m0, s50, s5
    s_nop 0
    buffer_load_dwordx4 v8, s[40:43], s48 offen offset:0 sc1 lds
    buffer_load_dwordx4 v8, s[40:43], s48 offen offset:1024 sc1 lds
    buffer_load_dwordx4 v8, s[40:43], s48 offen offset:2048 sc1 lds
    buffer_load_dwordx4 v8, s[40:43], s48 offen offset:3072 sc1 lds
    s_add_u32 m0, s50, s6
    s_nop 0
    buffer_load_dwordx4 v8, s[44:47], s49 offen offset:0 sc1 lds
    buffer_load_dwordx4 v8, s[44:47], s49 offen offset:1024 sc1 lds
    buffer_load_dwordx4 v8, s[44:47], s49 offen offset:2048 sc1 lds
    buffer_load_dwordx4 v8, s[44:47], s49 offen offset:3072 sc1 lds
    s_add_u32 s48, s48, 4096
    s_add_u32 s49, s49, 16384
    s_add_u32 s50, s50, 32768
    s_cmp_eq_u32 s50, 163840
    s_cselect_b32 s50, 0, s50
    s_add_u32 m0, s50, s5
    s_nop 0
    buffer_load_dwordx4 v8, s[40:43], s48 offen offset:0 sc1 lds
    buffer_load_dwordx4 v8, s[40:43], s48 offen offset:1024 sc1 lds
    buffer_load_dwordx4 v8, s[40:43], s48 offen offset:2048 sc1 lds
    buffer_load_dwordx4 v8, s[40:43], s48 offen offset:3072 sc1 lds
    s_add_u32 m0, s50, s6
    s_nop 0
    buffer_load_dwordx4 v8, s[44:47], s49 offen offset:0 sc1 lds
    buffer_load_dwordx4 v8, s[44:47], s49 offen offset:1024 sc1 lds
    buffer_load_dwordx4 v8, s[44:47], s49 offen offset:2048 sc1 lds
    buffer_load_dwordx4 v8, s[44:47], s49 offen offset:3072 sc1 lds
    s_add_u32 s48, s48, 4096
    s_add_u32 s49, s49, 16384
    s_add_u32 s50, s50, 32768
    s_cmp_eq_u32 s50, 163840
    s_cselect_b32 s50, 0, s50
    s_waitcnt vmcnt(20)
    s_barrier
    s_add_u32 m0, s50, s5
    s_nop 0
    buffer_load_dwordx4 v8, s[40:43], s48 offen offset:0 sc1 lds
    buffer_load_dwordx4 v8, s[40:43], s48 offen offset:1024 sc1 lds
    buffer_load_dwordx4 v8, s[40:43], s48 offen offset:2048 sc1 lds
    buffer_load_dwordx4 v8, s[40:43], s48 offen offset:3072 sc1 lds
    s_add_u32 m0, s50, s6
    s_nop 0
    buffer_load_dwordx4 v8, s[44:47], s49 offen offset:0 sc1 lds
    buffer_load_dwordx4 v8, s[44:47], s49 offen offset:1024 sc1 lds
    buffer_load_dwordx4 v8, s[44:47], s49 offen offset:2048 sc1 lds
    buffer_load_dwordx4 v8, s[44:47], s49 offen offset:3072 sc1 lds
    s_add_u32 s48, s48, 4096
    s_add_u32 s49, s49, 16384
    s_add_u32 s50, s50, 32768
    s_cmp_eq_u32 s50, 163840
    s_cselect_b32 s50, 0, s50
    s_mov_b32 s51, 21
L_w2a_ld_loop:
    s_waitcnt vmcnt(24)
    s_barrier
    s_add_u32 m0, s50, s5
    s_nop 0
    buffer_load_dwordx4 v8, s[40:43], s48 offen offset:0 sc1 lds
    buffer_load_dwordx4 v8, s[40:43], s48 offen offset:1024 sc1 lds
    buffer_load_dwordx4 v8, s[40:43], s48 offen offset:2048 sc1 lds
    buffer_load_dwordx4 v8, s[40:43], s48 offen offset:3072 sc1 lds
    s_add_u32 m0, s50, s6
    s_nop 0
    buffer_load_dwordx4 v8, s[44:47], s49 offen offset:0 sc1 lds
    buffer_load_dwordx4 v8, s[44:47], s49 offen offset:1024 sc1 lds
    buffer_load_dwordx4 v8, s[44:47], s49 offen offset:2048 sc1 lds
    buffer_load_dwordx4 v8, s[44:47], s49 offen offset:3072 sc1 lds
    s_add_u32 s48, s48, 4096
    s_add_u32 s49, s49, 16384
    s_add_u32 s50, s50, 32768
    s_cmp_eq_u32 s50, 163840
    s_cselect_b32 s50, 0, s50
    s_sub_u32 s51, s51, 1
    s_cmp_lg_u32 s51, 0
    s_cbranch_scc1 L_w2a_ld_loop
    s_waitcnt vmcnt(24)
    s_barrier
    s_waitcnt vmcnt(16)
    s_barrier
    s_waitcnt vmcnt(8)
    s_barrier
    s_waitcnt vmcnt(0)
    s_barrier
    s_barrier
    s_setprio 0
    s_and_b32 s4, s2, 7
    s_lshr_b32 s5, s2, 3
    s_and_b32 s6, s4, 3
    s_lshr_b32 s7, s4, 2
    s_mul_i32 s9, s6, 4
    s_and_b32 s6, s5, 3
    s_add_u32 s9, s9, s6
    s_mul_i32 s8, s7, 8
    s_lshr_b32 s6, s5, 2
    s_add_u32 s8, s8, s6
    s_lshl_b32 s4, s8, 2
    s_add_u32 s4, s4, s10
    s_mul_i32 s48, s4, 65536
    v_lshlrev_b32 v8, 4, v0
    s_mul_i32 s49, s9, 393216
    s_mul_i32 s6, s10, 6144
    s_add_u32 s49, s49, s6
    v_add_u32 v12, 4096, v8
    s_lshl_b32 s5, s10, 12
    s_add_u32 s6, s6, 16384
    s_mov_b32 s50, 0
    s_waitcnt lgkmcnt(0)
    s_add_u32 s40, s36, 37748736
    s_addc_u32 s41, s37, 0
    s_mov_b32 s42, 4194304
    s_mov_b32 s43, 0x20000
    s_add_u32 s44, s36, 54525952
    s_addc_u32 s45, s37, 0
    s_mov_b32 s46, 6291456
    s_mov_b32 s47, 0x20000
    s_add_u32 s56, s36, 48234496
    s_addc_u32 s57, s37, 0
    s_mov_b32 s58, 1048576
    s_mov_b32 s59, 0x20000
    s_add_u32 m0, s50, s6
    s_nop 0
    buffer_load_dwordx4 v8, s[44:47], s49 offen offset:0 sc1 lds
    buffer_load_dwordx4 v8, s[44:47], s49 offen offset:1024 sc1 lds
    buffer_load_dwordx4 v8, s[44:47], s49 offen offset:2048 sc1 lds
    buffer_load_dwordx4 v8, s[44:47], s49 offen offset:3072 sc1 lds
    s_add_u32 m0, m0, 4096
    s_nop 0
    buffer_load_dwordx4 v12, s[44:47], s49 offen offset:0 sc1 lds
    buffer_load_dwordx4 v12, s[44:47], s49 offen offset:1024 sc1 lds
    s_add_u32 s49, s49, 24576
    s_add_u32 s50, s50, 40960
    s_cmp_eq_u32 s50, 163840
    s_cselect_b32 s50, 0, s50
    s_add_u32 m0, s50, s6
    s_nop 0
    buffer_load_dwordx4 v8, s[44:47], s49 offen offset:0 sc1 lds
    buffer_load_dwordx4 v8, s[44:47], s49 offen offset:1024 sc1 lds
    buffer_load_dwordx4 v8, s[44:47], s49 offen offset:2048 sc1 lds
    buffer_load_dwordx4 v8, s[44:47], s49 offen offset:3072 sc1 lds
    s_add_u32 m0, m0, 4096
    s_nop 0
    buffer_load_dwordx4 v12, s[44:47], s49 offen offset:0 sc1 lds
    buffer_load_dwordx4 v12, s[44:47], s49 offen offset:1024 sc1 lds
    s_add_u32 s49, s49, 24576
    s_add_u32 s50, s50, 40960
    s_cmp_eq_u32 s50, 163840
    s_cselect_b32 s50, 0, s50
    s_add_u32 m0, s50, s6
    s_nop 0
    buffer_load_dwordx4 v8, s[44:47], s49 offen offset:0 sc1 lds
    buffer_load_dwordx4 v8, s[44:47], s49 offen offset:1024 sc1 lds
    buffer_load_dwordx4 v8, s[44:47], s49 offen offset:2048 sc1 lds
    buffer_load_dwordx4 v8, s[44:47], s49 offen offset:3072 sc1 lds
    s_add_u32 m0, m0, 4096
    s_nop 0
    buffer_load_dwordx4 v12, s[44:47], s49 offen offset:0 sc1 lds
    buffer_load_dwordx4 v12, s[44:47], s49 offen offset:1024 sc1 lds
    s_add_u32 s49, s49, 24576
    s_add_u32 s50, s50, 40960
    s_cmp_eq_u32 s50, 163840
    s_cselect_b32 s50, 0, s50
    s_add_u32 m0, s50, s6
    s_nop 0
    buffer_load_dwordx4 v8, s[44:47], s49 offen offset:0 sc1 lds
    buffer_load_dwordx4 v8, s[44:47], s49 offen offset:1024 sc1 lds
    buffer_load_dwordx4 v8, s[44:47], s49 offen offset:2048 sc1 lds
    buffer_load_dwordx4 v8, s[44:47], s49 offen offset:3072 sc1 lds
    s_add_u32 m0, m0, 4096
    s_nop 0
    buffer_load_dwordx4 v12, s[44:47], s49 offen offset:0 sc1 lds
    buffer_load_dwordx4 v12, s[44:47], s49 offen offset:1024 sc1 lds
    s_add_u32 s49, s49, 24576
    s_add_u32 s50, s50, 40960
    s_cmp_eq_u32 s50, 163840
    s_cselect_b32 s50, 0, s50
    s_mov_b32 s50, 0
    s_lshl_b32 s4, s8, 2
    s_add_u32 s4, s4, s10
    s_lshl_b32 s4, s4, 4
    s_add_u32 s4, s4, s9
    s_lshl_b32 s4, s4, 7
    s_add_u32 s4, s4, 393216
    v_and_b32 v20, 15, v0
    v_lshlrev_b32 v20, 2, v20
    s_mov_b32 s60, 0x40000
L_qkv2_w_poll:
    buffer_load_dword v21, v20, s[56:59], s4 offen sc1
    s_waitcnt vmcnt(0)
    v_cmp_ne_u32 vcc, 1, v21
    s_nop 4
    s_cbranch_vccz L_qkv2_w_got
    s_sleep 4
    s_sub_u32 s60, s60, 1
    s_cmp_lg_u32 s60, 0
    s_cbranch_scc1 L_qkv2_w_poll
L_qkv2_w_got:
    s_add_u32 m0, s50, s5
    s_nop 0
    buffer_load_dwordx4 v8, s[40:43], s48 offen offset:0 sc1 lds
    buffer_load_dwordx4 v8, s[40:43], s48 offen offset:1024 sc1 lds
    buffer_load_dwordx4 v8, s[40:43], s48 offen offset:2048 sc1 lds
    buffer_load_dwordx4 v8, s[40:43], s48 offen offset:3072 sc1 lds
    s_add_u32 s48, s48, 4096
    s_add_u32 s50, s50, 40960
    s_cmp_eq_u32 s50, 163840
    s_cselect_b32 s50, 0, s50
    s_add_u32 m0, s50, s5
    s_nop 0
    buffer_load_dwordx4 v8, s[40:43], s48 offen offset:0 sc1 lds
    buffer_load_dwordx4 v8, s[40:43], s48 offen offset:1024 sc1 lds
    buffer_load_dwordx4 v8, s[40:43], s48 offen offset:2048 sc1 lds
    buffer_load_dwordx4 v8, s[40:43], s48 offen offset:3072 sc1 lds
    s_add_u32 s48, s48, 4096
    s_add_u32 s50, s50, 40960
    s_cmp_eq_u32 s50, 163840
    s_cselect_b32 s50, 0, s50
    s_waitcnt vmcnt(4)
    s_barrier
    s_add_u32 m0, s50, s5
    s_nop 0
    buffer_load_dwordx4 v8, s[40:43], s48 offen offset:0 sc1 lds
    buffer_load_dwordx4 v8, s[40:43], s48 offen offset:1024 sc1 lds
    buffer_load_dwordx4 v8, s[40:43], s48 offen offset:2048 sc1 lds
    buffer_load_dwordx4 v8, s[40:43], s48 offen offset:3072 sc1 lds
    s_add_u32 s48, s48, 4096
    s_add_u32 s50, s50, 40960
    s_cmp_eq_u32 s50, 163840
    s_cselect_b32 s50, 0, s50
    s_add_u32 m0, s50, s5
    s_nop 0
    buffer_load_dwordx4 v8, s[40:43], s48 offen offset:0 sc1 lds
    buffer_load_dwordx4 v8, s[40:43], s48 offen offset:1024 sc1 lds
    buffer_load_dwordx4 v8, s[40:43], s48 offen offset:2048 sc1 lds
    buffer_load_dwordx4 v8, s[40:43], s48 offen offset:3072 sc1 lds
    s_add_u32 s48, s48, 4096
    s_add_u32 s50, s50, 40960
    s_cmp_eq_u32 s50, 163840
    s_cselect_b32 s50, 0, s50
    s_waitcnt vmcnt(8)
    s_barrier
    s_add_u32 m0, s50, s5
    s_nop 0
    buffer_load_dwordx4 v8, s[40:43], s48 offen offset:0 sc1 lds
    buffer_load_dwordx4 v8, s[40:43], s48 offen offset:1024 sc1 lds
    buffer_load_dwordx4 v8, s[40:43], s48 offen offset:2048 sc1 lds
    buffer_load_dwordx4 v8, s[40:43], s48 offen offset:3072 sc1 lds
    s_add_u32 m0, s50, s6
    s_nop 0
    buffer_load_dwordx4 v8, s[44:47], s49 offen offset:0 sc1 lds
    buffer_load_dwordx4 v8, s[44:47], s49 offen offset:1024 sc1 lds
    buffer_load_dwordx4 v8, s[44:47], s49 offen offset:2048 sc1 lds
    buffer_load_dwordx4 v8, s[44:47], s49 offen offset:3072 sc1 lds
    s_add_u32 m0, m0, 4096
    s_nop 0
    buffer_load_dwordx4 v12, s[44:47], s49 offen offset:0 sc1 lds
    buffer_load_dwordx4 v12, s[44:47], s49 offen offset:1024 sc1 lds
    s_add_u32 s48, s48, 4096
    s_add_u32 s49, s49, 24576
    s_add_u32 s50, s50, 40960
    s_cmp_eq_u32 s50, 163840
    s_cselect_b32 s50, 0, s50
    s_waitcnt vmcnt(14)
    s_barrier
    s_add_u32 m0, s50, s5
    s_nop 0
    buffer_load_dwordx4 v8, s[40:43], s48 offen offset:0 sc1 lds
    buffer_load_dwordx4 v8, s[40:43], s48 offen offset:1024 sc1 lds
    buffer_load_dwordx4 v8, s[40:43], s48 offen offset:2048 sc1 lds
    buffer_load_dwordx4 v8, s[40:43], s48 offen offset:3072 sc1 lds
    s_add_u32 m0, s50, s6
    s_nop 0
    buffer_load_dwordx4 v8, s[44:47], s49 offen offset:0 sc1 lds
    buffer_load_dwordx4 v8, s[44:47], s49 offen offset:1024 sc1 lds
    buffer_load_dwordx4 v8, s[44:47], s49 offen offset:2048 sc1 lds
    buffer_load_dwordx4 v8, s[44:47], s49 offen offset:3072 sc1 lds
    s_add_u32 m0, m0, 4096
    s_nop 0
    buffer_load_dwordx4 v12, s[44:47], s49 offen offset:0 sc1 lds
    buffer_load_dwordx4 v12, s[44:47], s49 offen offset:1024 sc1 lds
    s_add_u32 s48, s48, 4096
    s_add_u32 s49, s49, 24576
    s_add_u32 s50, s50, 40960
    s_cmp_eq_u32 s50, 163840
    s_cselect_b32 s50, 0, s50
    s_mov_b32 s51, 10
L_qkv2_ld_loop:
    s_waitcnt vmcnt(20)
    s_barrier
    s_add_u32 m0, s50, s5
    s_nop 0
    buffer_load_dwordx4 v8, s[40:43], s48 offen offset:0 sc1 lds
    buffer_load_dwordx4 v8, s[40:43], s48 offen offset:1024 sc1 lds
    buffer_load_dwordx4 v8, s[40:43], s48 offen offset:2048 sc1 lds
    buffer_load_dwordx4 v8, s[40:43], s48 offen offset:3072 sc1 lds
    s_add_u32 m0, s50, s6
    s_nop 0
    buffer_load_dwordx4 v8, s[44:47], s49 offen offset:0 sc1 lds
    buffer_load_dwordx4 v8, s[44:47], s49 offen offset:1024 sc1 lds
    buffer_load_dwordx4 v8, s[44:47], s49 offen offset:2048 sc1 lds
    buffer_load_dwordx4 v8, s[44:47], s49 offen offset:3072 sc1 lds
    s_add_u32 m0, m0, 4096
    s_nop 0
    buffer_load_dwordx4 v12, s[44:47], s49 offen offset:0 sc1 lds
    buffer_load_dwordx4 v12, s[44:47], s49 offen offset:1024 sc1 lds
    s_add_u32 s48, s48, 4096
    s_add_u32 s49, s49, 24576
    s_add_u32 s50, s50, 40960
    s_cmp_eq_u32 s50, 163840
    s_cselect_b32 s50, 0, s50
    s_sub_u32 s51, s51, 1
    s_cmp_lg_u32 s51, 0
    s_cbranch_scc1 L_qkv2_ld_loop
    s_add_u32 s40, s36, 47448064
    s_addc_u32 s41, s37, 0
    s_mov_b32 s42, 262144
    s_mov_b32 s43, 0x20000
    v_and_b32 v3, 31, v0
    v_lshlrev_b32 v3, 3, v3
    v_lshrrev_b32 v4, 5, v0
    v_lshl_add_u32 v3, v4, 17, v3
    s_lshl_b32 s4, s8, 10
    s_lshl_b32 s7, s10, 8
    s_add_u32 s4, s4, s7
    buffer_load_dwordx2 v[32:33], v3, s[40:43], s4 offen sc1
    s_add_u32 s4, s4, 16384
    buffer_load_dwordx2 v[34:35], v3, s[40:43], s4 offen sc1
    s_add_u32 s4, s4, 16384
    buffer_load_dwordx2 v[36:37], v3, s[40:43], s4 offen sc1
    s_add_u32 s4, s4, 16384
    buffer_load_dwordx2 v[38:39], v3, s[40:43], s4 offen sc1
    s_add_u32 s4, s4, 16384
    buffer_load_dwordx2 v[40:41], v3, s[40:43], s4 offen sc1
    s_add_u32 s4, s4, 16384
    buffer_load_dwordx2 v[42:43], v3, s[40:43], s4 offen sc1
    s_add_u32 s4, s4, 16384
    buffer_load_dwordx2 v[44:45], v3, s[40:43], s4 offen sc1
    s_add_u32 s4, s4, 16384
    buffer_load_dwordx2 v[46:47], v3, s[40:43], s4 offen sc1
    s_waitcnt vmcnt(28)
    s_barrier
    s_waitcnt vmcnt(18)
    s_barrier
    s_waitcnt vmcnt(8)
    s_barrier
    s_waitcnt vmcnt(0)
    v_add_f32 v32, v32, v40
    v_add_f32 v33, v33, v41
    v_add_f32 v34, v34, v42
    v_add_f32 v35, v35, v43
    v_add_f32 v36, v36, v44
    v_add_f32 v37, v37, v45
    v_add_f32 v38, v38, v46
    v_add_f32 v39, v39, v47
    v_add_f32 v32, v32, v36
    v_add_f32 v33, v33, v37
    v_add_f32 v34, v34, v38
    v_add_f32 v35, v35, v39
    v_add_f32 v32, v32, v34
    v_add_f32 v33, v33, v35
    v_mov_b32 v34, v32
    s_nop 1
    v_permlane32_swap_b32 v32, v34
    v_add_f32 v32, v32, v34
    v_mov_b32 v34, v33
    s_nop 1
    v_permlane32_swap_b32 v33, v34
    v_add_f32 v33, v33, v34
    v_and_b32 v3, 31, v0
    v_lshlrev_b32 v3, 2, v3
    s_lshl_b32 s4, s10, 7
    s_add_u32 s4, s4, 98304
    v_add_u32 v3, s4, v3
    v_mul_f32 v32, 0x3a800000, v32
    v_mul_f32 v33, 0x3a800000, v33
    v_fma_f32 v33, -v32, v32, v33
    v_max_f32 v33, 0, v33
    v_add_f32 v37, 0x3727c5ac, v33
    v_rsq_f32 v36, v37
    s_nop 0
    v_mul_f32 v32, v32, v36
    v_sub_f32 v32, 0, v32
    ds_write_b32 v3, v36 offset:0
    ds_write_b32 v3, v32 offset:512
    s_waitcnt lgkmcnt(0)
    s_barrier
    s_barrier
    s_branch L_rest_kernel_j1
L_rest_kernel_c1:
    s_and_b32 s4, s2, 7
    s_lshr_b32 s5, s2, 3
    s_and_b32 s6, s4, 1
    s_lshr_b32 s7, s4, 1
    s_mul_i32 s9, s6, 8
    s_and_b32 s6, s5, 7
    s_add_u32 s9, s9, s6
    s_mul_i32 s8, s7, 4
    s_lshr_b32 s6, s5, 3
    s_add_u32 s8, s8, s6
    s_and_b32 s11, s10, 1
    s_lshr_b32 s12, s10, 1
    s_mov_b32 s14, s10
    s_mov_b32 s15, s10
    v_and_b32 v2, 31, v0
    v_lshrrev_b32 v3, 5, v0
    s_lshl_b32 s6, s14, 12
    s_lshl_b32 s7, s15, 12
    v_lshlrev_b32 v4, 4, v0
    v_add_u32 v8, s6, v4
    v_add_u32 v9, s7, v4
    s_mov_b32 s4, 0
    s_add_u32 s4, s4, 16384
    v_add_u32 v24, s4, v4
    v_mov_b32 v60, 0
    v_mov_b32 v61, 0
    v_mov_b32 v62, 0
    v_mov_b32 v63, 0
    v_mov_b32 v64, 0
    v_mov_b32 v65, 0
    v_mov_b32 v66, 0
    v_mov_b32 v67, 0
    v_mov_b32 v68, 0
    v_mov_b32 v69, 0
    v_mov_b32 v70, 0
    v_mov_b32 v71, 0
    v_mov_b32 v72, 0
    v_mov_b32 v73, 0
    v_mov_b32 v74, 0
    v_mov_b32 v75, 0
    v_mov_b32 v76, 0
    v_mov_b32 v77, 0
    v_mov_b32 v78, 0
    v_mov_b32 v79, 0
    v_mov_b32 v80, 0
    v_mov_b32 v81, 0
    v_mov_b32 v82, 0
    v_mov_b32 v83, 0
    v_mov_b32 v84, 0
    v_mov_b32 v85, 0
    v_mov_b32 v86, 0
    v_mov_b32 v87, 0
    v_mov_b32 v88, 0
    v_mov_b32 v89, 0
    v_mov_b32 v90, 0
    v_mov_b32 v91, 0
    s_waitcnt lgkmcnt(0)
    s_and_b32 s4, s2, 15
    s_or_b32 s4, s4, s10
    s_cmp_lg_u32 s4, 0
    s_cbranch_scc1 L_wo1_nolead
    s_add_u32 s56, s36, 48234496
    s_addc_u32 s57, s37, 0
    s_mov_b32 s58, 1048576
    s_mov_b32 s59, 0x20000
    s_lshr_b32 s5, s2, 4
    s_lshl_b32 s4, s5, 7
    s_add_u32 s4, s4, 692224
    v_and_b32 v4, 15, v0
    v_lshlrev_b32 v4, 2, v4
    s_mov_b32 s60, 0x40000
L_wo1_lead_poll:
    buffer_load_dword v5, v4, s[56:59], s4 offen sc1
    s_waitcnt vmcnt(0)
    v_cmp_ne_u32 vcc, 1, v5
    s_nop 4
    s_cbranch_vccz L_wo1_lead_got
    s_sleep 4
    s_sub_u32 s60, s60, 1
    s_cmp_lg_u32 s60, 0
    s_cbranch_scc1 L_wo1_lead_poll
L_wo1_lead_got:
    v_lshlrev_b32 v4, 5, v4
    s_lshl_b32 s4, s5, 2
    s_add_u32 s4, s4, 696320
    buffer_store_dword v5, v4, s[56:59], s4 offen sc1
L_wo1_nolead:
    s_mov_b32 s40, s16
    s_mov_b32 s41, s17
    s_mov_b32 s42, 4194304
    s_mov_b32 s43, 0x20000
    s_mov_b32 s59, s9
    s_lshl_b32 s4, s8, 2
    s_add_u32 s58, s4, s14
    s_lshl_b32 s4, s58, 16
    s_lshl_b32 s5, s59, 7
    s_add_u32 s56, s4, s5
    s_lshl_b32 s6, s59, 12
    s_add_u32 s57, s4, s6
    v_lshlrev_b32 v124, 11, v2
    v_lshl_add_u32 v124, v3, 3, v124
    v_lshlrev_b32 v125, 4, v0
    buffer_load_dwordx2 v[92:93], v124, s[40:43], s56 offen offset:0
    buffer_load_dwordx2 v[94:95], v124, s[40:43], s56 offen offset:16
    buffer_load_dwordx2 v[96:97], v124, s[40:43], s56 offen offset:32
    buffer_load_dwordx2 v[98:99], v124, s[40:43], s56 offen offset:48
    buffer_load_dwordx2 v[100:101], v124, s[40:43], s56 offen offset:64
    buffer_load_dwordx2 v[102:103], v124, s[40:43], s56 offen offset:80
    buffer_load_dwordx2 v[104:105], v124, s[40:43], s56 offen offset:96
    buffer_load_dwordx2 v[106:107], v124, s[40:43], s56 offen offset:112
    s_mov_b32 s13, 0
    s_mov_b32 s51, 15
    v_add_u32 v16, s13, v8
    v_add_u32 v26, s13, v24
    s_add_u32 s13, s13, 24576
    s_cmp_eq_u32 s13, 147456
    s_cselect_b32 s13, 0, s13
    s_barrier
    ds_read_b128 v[36:39], v16 offset:0
    ds_read_b128 v[40:43], v26 offset:0
    ds_read_b128 v[44:47], v26 offset:1024
L_wo1_c_loop:
    s_waitcnt lgkmcnt(1)
    v_mfma_f32_32x32x16_bf16 v[60:75], v[40:43], v[36:39], v[60:75]
    ds_read_b128 v[48:51], v16 offset:1024
    ds_read_b128 v[52:55], v26 offset:2048
    s_waitcnt lgkmcnt(2)
    v_mfma_f32_32x32x16_bf16 v[76:91], v[44:47], v[36:39], v[76:91]
    ds_read_b128 v[56:59], v26 offset:3072
    s_waitcnt lgkmcnt(1)
    v_mfma_f32_32x32x16_bf16 v[60:75], v[52:55], v[48:51], v[60:75]
    ds_read_b128 v[36:39], v16 offset:2048
    ds_read_b128 v[40:43], v26 offset:4096
    s_waitcnt lgkmcnt(2)
    v_mfma_f32_32x32x16_bf16 v[76:91], v[56:59], v[48:51], v[76:91]
    ds_read_b128 v[44:47], v26 offset:5120
    s_waitcnt lgkmcnt(1)
    v_mfma_f32_32x32x16_bf16 v[60:75], v[40:43], v[36:39], v[60:75]
    ds_read_b128 v[48:51], v16 offset:3072
    ds_read_b128 v[52:55], v26 offset:6144
    s_waitcnt lgkmcnt(2)
    v_mfma_f32_32x32x16_bf16 v[76:91], v[44:47], v[36:39], v[76:91]
    ds_read_b128 v[56:59], v26 offset:7168
    s_waitcnt lgkmcnt(0)
    v_add_u32 v16, s13, v8
    v_add_u32 v26, s13, v24
    s_add_u32 s13, s13, 24576
    s_cmp_eq_u32 s13, 147456
    s_cselect_b32 s13, 0, s13
    s_barrier
    v_mfma_f32_32x32x16_bf16 v[60:75], v[52:55], v[48:51], v[60:75]
    ds_read_b128 v[36:39], v16 offset:0
    ds_read_b128 v[40:43], v26 offset:0
    v_mfma_f32_32x32x16_bf16 v[76:91], v[56:59], v[48:51], v[76:91]
    ds_read_b128 v[44:47], v26 offset:1024
    s_sub_u32 s51, s51, 1
    s_cmp_lg_u32 s51, 0
    s_cbranch_scc1 L_wo1_c_loop
    s_waitcnt lgkmcnt(1)
    v_mfma_f32_32x32x16_bf16 v[60:75], v[40:43], v[36:39], v[60:75]
    ds_read_b128 v[48:51], v16 offset:1024
    ds_read_b128 v[52:55], v26 offset:2048
    s_waitcnt lgkmcnt(2)
    v_mfma_f32_32x32x16_bf16 v[76:91], v[44:47], v[36:39], v[76:91]
    ds_read_b128 v[56:59], v26 offset:3072
    s_waitcnt lgkmcnt(1)
    v_mfma_f32_32x32x16_bf16 v[60:75], v[52:55], v[48:51], v[60:75]
    ds_read_b128 v[36:39], v16 offset:2048
    ds_read_b128 v[40:43], v26 offset:4096
    s_waitcnt lgkmcnt(2)
    v_mfma_f32_32x32x16_bf16 v[76:91], v[56:59], v[48:51], v[76:91]
    ds_read_b128 v[44:47], v26 offset:5120
    s_waitcnt lgkmcnt(1)
    v_mfma_f32_32x32x16_bf16 v[60:75], v[40:43], v[36:39], v[60:75]
    ds_read_b128 v[48:51], v16 offset:3072
    ds_read_b128 v[52:55], v26 offset:6144
    s_waitcnt lgkmcnt(2)
    v_mfma_f32_32x32x16_bf16 v[76:91], v[44:47], v[36:39], v[76:91]
    ds_read_b128 v[56:59], v26 offset:7168
    s_waitcnt lgkmcnt(1)
    v_mfma_f32_32x32x16_bf16 v[60:75], v[52:55], v[48:51], v[60:75]
    s_waitcnt lgkmcnt(0)
    v_mfma_f32_32x32x16_bf16 v[76:91], v[56:59], v[48:51], v[76:91]
    s_waitcnt vmcnt(0)
    v_lshlrev_b32 v6, 16, v92
    v_and_b32 v7, 0xffff0000, v92
    s_nop 6
    v_pk_add_f32 v[60:61], v[60:61], v[6:7]
    v_lshlrev_b32 v6, 16, v93
    v_and_b32 v7, 0xffff0000, v93
    v_pk_add_f32 v[62:63], v[62:63], v[6:7]
    v_lshlrev_b32 v6, 16, v94
    v_and_b32 v7, 0xffff0000, v94
    v_pk_add_f32 v[64:65], v[64:65], v[6:7]
    v_lshlrev_b32 v6, 16, v95
    v_and_b32 v7, 0xffff0000, v95
    v_pk_add_f32 v[66:67], v[66:67], v[6:7]
    v_lshlrev_b32 v6, 16, v96
    v_and_b32 v7, 0xffff0000, v96
    v_pk_add_f32 v[68:69], v[68:69], v[6:7]
    v_lshlrev_b32 v6, 16, v97
    v_and_b32 v7, 0xffff0000, v97
    v_pk_add_f32 v[70:71], v[70:71], v[6:7]
    v_lshlrev_b32 v6, 16, v98
    v_and_b32 v7, 0xffff0000, v98
    v_pk_add_f32 v[72:73], v[72:73], v[6:7]
    v_lshlrev_b32 v6, 16, v99
    v_and_b32 v7, 0xffff0000, v99
    v_pk_add_f32 v[74:75], v[74:75], v[6:7]
    v_lshlrev_b32 v6, 16, v100
    v_and_b32 v7, 0xffff0000, v100
    v_pk_add_f32 v[76:77], v[76:77], v[6:7]
    v_lshlrev_b32 v6, 16, v101
    v_and_b32 v7, 0xffff0000, v101
    v_pk_add_f32 v[78:79], v[78:79], v[6:7]
    v_lshlrev_b32 v6, 16, v102
    v_and_b32 v7, 0xffff0000, v102
    v_pk_add_f32 v[80:81], v[80:81], v[6:7]
    v_lshlrev_b32 v6, 16, v103
    v_and_b32 v7, 0xffff0000, v103
    v_pk_add_f32 v[82:83], v[82:83], v[6:7]
    v_lshlrev_b32 v6, 16, v104
    v_and_b32 v7, 0xffff0000, v104
    v_pk_add_f32 v[84:85], v[84:85], v[6:7]
    v_lshlrev_b32 v6, 16, v105
    v_and_b32 v7, 0xffff0000, v105
    v_pk_add_f32 v[86:87], v[86:87], v[6:7]
    v_lshlrev_b32 v6, 16, v106
    v_and_b32 v7, 0xffff0000, v106
    v_pk_add_f32 v[88:89], v[88:89], v[6:7]
    v_lshlrev_b32 v6, 16, v107
    v_and_b32 v7, 0xffff0000, v107
    v_pk_add_f32 v[90:91], v[90:91], v[6:7]
    s_add_u32 s48, s36, 33554432
    s_addc_u32 s49, s37, 0
    s_mov_b32 s50, 4194304
    s_mov_b32 s51, 0x20000
    v_cvt_pk_bf16_f32 v36, v60, v61
    v_cvt_pk_bf16_f32 v37, v62, v63
    v_cvt_pk_bf16_f32 v38, v64, v65
    v_cvt_pk_bf16_f32 v39, v66, v67
    v_cvt_pk_bf16_f32 v40, v68, v69
    v_cvt_pk_bf16_f32 v41, v70, v71
    v_cvt_pk_bf16_f32 v42, v72, v73
    v_cvt_pk_bf16_f32 v43, v74, v75
    buffer_store_dwordx4 v[36:39], v125, s[48:51], s57 offen offset:0 sc1
    buffer_store_dwordx4 v[40:43], v125, s[48:51], s57 offen offset:1024 sc1
    v_cvt_pk_bf16_f32 v44, v76, v77
    v_cvt_pk_bf16_f32 v45, v78, v79
    v_cvt_pk_bf16_f32 v46, v80, v81
    v_cvt_pk_bf16_f32 v47, v82, v83
    v_cvt_pk_bf16_f32 v48, v84, v85
    v_cvt_pk_bf16_f32 v49, v86, v87
    v_cvt_pk_bf16_f32 v50, v88, v89
    v_cvt_pk_bf16_f32 v51, v90, v91
    buffer_store_dwordx4 v[44:47], v125, s[48:51], s57 offen offset:2048 sc1
    buffer_store_dwordx4 v[48:51], v125, s[48:51], s57 offen offset:3072 sc1
    v_pk_add_f32 v[92:93], v[60:61], v[76:77]
    v_pk_mul_f32 v[94:95], v[60:61], v[60:61]
    v_pk_fma_f32 v[94:95], v[76:77], v[76:77], v[94:95]
    v_pk_add_f32 v[92:93], v[92:93], v[62:63]
    v_pk_fma_f32 v[94:95], v[62:63], v[62:63], v[94:95]
    v_pk_add_f32 v[92:93], v[92:93], v[78:79]
    v_pk_fma_f32 v[94:95], v[78:79], v[78:79], v[94:95]
    v_pk_add_f32 v[92:93], v[92:93], v[64:65]
    v_pk_fma_f32 v[94:95], v[64:65], v[64:65], v[94:95]
    v_pk_add_f32 v[92:93], v[92:93], v[80:81]
    v_pk_fma_f32 v[94:95], v[80:81], v[80:81], v[94:95]
    v_pk_add_f32 v[92:93], v[92:93], v[66:67]
    v_pk_fma_f32 v[94:95], v[66:67], v[66:67], v[94:95]
    v_pk_add_f32 v[92:93], v[92:93], v[82:83]
    v_pk_fma_f32 v[94:95], v[82:83], v[82:83], v[94:95]
    v_pk_add_f32 v[92:93], v[92:93], v[68:69]
    v_pk_fma_f32 v[94:95], v[68:69], v[68:69], v[94:95]
    v_pk_add_f32 v[92:93], v[92:93], v[84:85]
    v_pk_fma_f32 v[94:95], v[84:85], v[84:85], v[94:95]
    v_pk_add_f32 v[92:93], v[92:93], v[70:71]
    v_pk_fma_f32 v[94:95], v[70:71], v[70:71], v[94:95]
    v_pk_add_f32 v[92:93], v[92:93], v[86:87]
    v_pk_fma_f32 v[94:95], v[86:87], v[86:87], v[94:95]
    v_pk_add_f32 v[92:93], v[92:93], v[72:73]
    v_pk_fma_f32 v[94:95], v[72:73], v[72:73], v[94:95]
    v_pk_add_f32 v[92:93], v[92:93], v[88:89]
    v_pk_fma_f32 v[94:95], v[88:89], v[88:89], v[94:95]
    v_pk_add_f32 v[92:93], v[92:93], v[74:75]
    v_pk_fma_f32 v[94:95], v[74:75], v[74:75], v[94:95]
    v_pk_add_f32 v[92:93], v[92:93], v[90:91]
    v_pk_fma_f32 v[94:95], v[90:91], v[90:91], v[94:95]
    s_add_u32 s40, s36, 47185920
    s_addc_u32 s41, s37, 0
    s_mov_b32 s42, 262144
    s_mov_b32 s43, 0x20000
    v_add_f32 v92, v92, v93
    v_add_f32 v93, v94, v95
    v_mov_b32 v94, v92
    v_mov_b32 v95, v93
    s_nop 0
    v_permlane32_swap_b32 v92, v94
    v_permlane32_swap_b32 v93, v95
    v_pk_add_f32 v[92:93], v[92:93], v[94:95]
    s_lshl_b32 s4, s59, 14
    s_lshl_b32 s5, s58, 8
    s_add_u32 s4, s4, s5
    v_lshlrev_b32 v4, 3, v2
    buffer_store_dwordx2 v[92:93], v4, s[40:43], s4 offen sc1
    s_add_u32 s52, s36, 48234496
    s_addc_u32 s53, s37, 0
    s_mov_b32 s54, 1048576
    s_mov_b32 s55, 0x20000
    s_lshl_b32 s4, s58, 11
    s_mov_b32 s5, s59
    v_and_b32 v4, 15, v0
    v_lshlrev_b32 v4, 7, v4
    s_lshl_b32 s5, s5, 2
    s_add_u32 s4, s4, s5
    s_add_u32 s4, s4, 131072
    v_mov_b32 v5, 1
    s_waitcnt vmcnt(0)
    s_mov_b64 exec, 0xffff
    buffer_store_dword v5, v4, s[52:55], s4 offen sc1
    s_mov_b64 exec, -1
    s_barrier
L_wo1_dend:
    s_and_b32 s4, s2, 7
    s_lshr_b32 s5, s2, 3
    s_and_b32 s6, s4, 3
    s_lshr_b32 s7, s4, 2
    s_mul_i32 s9, s6, 4
    s_and_b32 s6, s5, 3
    s_add_u32 s9, s9, s6
    s_mul_i32 s8, s7, 8
    s_lshr_b32 s6, s5, 2
    s_add_u32 s8, s8, s6
    s_and_b32 s11, s10, 1
    s_lshr_b32 s12, s10, 1
    s_lshl_b32 s14, s11, 1
    s_add_u32 s14, s14, s12
    s_xor_b32 s15, s14, 1
    v_and_b32 v2, 31, v0
    v_lshrrev_b32 v3, 5, v0
    s_lshl_b32 s6, s14, 12
    s_lshl_b32 s7, s15, 12
    v_lshlrev_b32 v4, 4, v0
    v_add_u32 v8, s6, v4
    v_add_u32 v9, s7, v4
    s_mul_i32 s4, s12, 3072
    v_add_u32 v25, 22528, v4
    s_add_u32 s4, s4, 16384
    v_add_u32 v24, s4, v4
    v_mov_b32 v84, 0
    v_mov_b32 v85, 0
    v_mov_b32 v86, 0
    v_mov_b32 v87, 0
    v_mov_b32 v88, 0
    v_mov_b32 v89, 0
    v_mov_b32 v90, 0
    v_mov_b32 v91, 0
    v_mov_b32 v92, 0
    v_mov_b32 v93, 0
    v_mov_b32 v94, 0
    v_mov_b32 v95, 0
    v_mov_b32 v96, 0
    v_mov_b32 v97, 0
    v_mov_b32 v98, 0
    v_mov_b32 v99, 0
    v_mov_b32 v100, 0
    v_mov_b32 v101, 0
    v_mov_b32 v102, 0
    v_mov_b32 v103, 0
    v_mov_b32 v104, 0
    v_mov_b32 v105, 0
    v_mov_b32 v106, 0
    v_mov_b32 v107, 0
    v_mov_b32 v108, 0
    v_mov_b32 v109, 0
    v_mov_b32 v110, 0
    v_mov_b32 v111, 0
    v_mov_b32 v112, 0
    v_mov_b32 v113, 0
    v_mov_b32 v114, 0
    v_mov_b32 v115, 0
    v_mov_b32 v116, 0
    v_mov_b32 v117, 0
    v_mov_b32 v118, 0
    v_mov_b32 v119, 0
    v_mov_b32 v120, 0
    v_mov_b32 v121, 0
    v_mov_b32 v122, 0
    v_mov_b32 v123, 0
    v_mov_b32 v124, 0
    v_mov_b32 v125, 0
    v_mov_b32 v126, 0
    v_mov_b32 v127, 0
    v_mov_b32 v128, 0
    v_mov_b32 v129, 0
    v_mov_b32 v130, 0
    v_mov_b32 v131, 0
    v_mov_b32 v132, 0
    v_mov_b32 v133, 0
    v_mov_b32 v134, 0
    v_mov_b32 v135, 0
    v_mov_b32 v136, 0
    v_mov_b32 v137, 0
    v_mov_b32 v138, 0
    v_mov_b32 v139, 0
    v_mov_b32 v140, 0
    v_mov_b32 v141, 0
    v_mov_b32 v142, 0
    v_mov_b32 v143, 0
    v_mov_b32 v144, 0
    v_mov_b32 v145, 0
    v_mov_b32 v146, 0
    v_mov_b32 v147, 0
    v_mov_b32 v148, 0
    v_mov_b32 v149, 0
    v_mov_b32 v150, 0
    v_mov_b32 v151, 0
    v_mov_b32 v152, 0
    v_mov_b32 v153, 0
    v_mov_b32 v154, 0
    v_mov_b32 v155, 0
    v_mov_b32 v156, 0
    v_mov_b32 v157, 0
    v_mov_b32 v158, 0
    v_mov_b32 v159, 0
    v_mov_b32 v160, 0
    v_mov_b32 v161, 0
    v_mov_b32 v162, 0
    v_mov_b32 v163, 0
    v_mov_b32 v164, 0
    v_mov_b32 v165, 0
    v_mov_b32 v166, 0
    v_mov_b32 v167, 0
    v_mov_b32 v168, 0
    v_mov_b32 v169, 0
    v_mov_b32 v170, 0
    v_mov_b32 v171, 0
    v_mov_b32 v172, 0
    v_mov_b32 v173, 0
    v_mov_b32 v174, 0
    v_mov_b32 v175, 0
    v_mov_b32 v176, 0
    v_mov_b32 v177, 0
    v_mov_b32 v178, 0
    v_mov_b32 v179, 0
    v_mov_b32 v180, 0
    v_mov_b32 v181, 0
    v_mov_b32 v182, 0
    v_mov_b32 v183, 0
    v_mov_b32 v184, 0
    v_mov_b32 v185, 0
    v_mov_b32 v186, 0
    v_mov_b32 v187, 0
    v_mov_b32 v188, 0
    v_mov_b32 v189, 0
    v_mov_b32 v190, 0
    v_mov_b32 v191, 0
    v_mov_b32 v192, 0
    v_mov_b32 v193, 0
    v_mov_b32 v194, 0
    v_mov_b32 v195, 0
    s_waitcnt lgkmcnt(0)
    s_mul_i32 s4, s9, 896
    s_mul_i32 s5, s12, 384
    s_add_u32 s56, s4, s5
    s_add_u32 s57, s56, 128
    s_add_u32 s58, s56, 256
    s_add_u32 s59, s4, 768
    s_mov_b32 s40, s26
    s_mov_b32 s41, s27
    s_mov_b32 s42, 7168
    s_mov_b32 s43, 0x20000
    s_lshr_b32 s5, s56, 1
    s_lshr_b32 s4, s59, 1
    v_lshlrev_b32 v4, 1, v2
    buffer_load_ushort v32, v4, s[40:43], s5 offen
    buffer_load_ushort v33, v4, s[40:43], s5 offen offset:64
    buffer_load_ushort v34, v4, s[40:43], s5 offen offset:128
    buffer_load_ushort v35, v4, s[40:43], s4 offen
    s_mov_b32 s13, 0
    s_mov_b32 s51, 15
    v_add_u32 v16, s13, v8
    v_add_u32 v17, s13, v9
    v_add_u32 v26, s13, v24
    v_add_u32 v27, s13, v25
    s_add_u32 s13, s13, 45056
    s_cmp_eq_u32 s13, 135168
    s_cselect_b32 s13, 0, s13
    s_barrier
    ds_read_b128 v[36:39], v16 offset:0
    ds_read_b128 v[44:47], v26 offset:0
    ds_read_b128 v[40:43], v17 offset:0
    ds_read_b128 v[48:51], v26 offset:1024
    ds_read_b128 v[52:55], v26 offset:2048
    ds_read_b128 v[56:59], v27 offset:0
L_w1a_c_loop:
    s_waitcnt lgkmcnt(4)
    v_mfma_f32_32x32x16_bf16 v[84:99], v[44:47], v[36:39], v[84:99]
    ds_read_b128 v[60:63], v16 offset:1024
    ds_read_b128 v[68:71], v26 offset:7168
    s_waitcnt lgkmcnt(5)
    v_mfma_f32_32x32x16_bf16 v[100:115], v[44:47], v[40:43], v[100:115]
    ds_read_b128 v[64:67], v17 offset:1024
    ds_read_b128 v[72:75], v26 offset:8192
    s_waitcnt lgkmcnt(6)
    v_mfma_f32_32x32x16_bf16 v[116:131], v[48:51], v[36:39], v[116:131]
    ds_read_b128 v[76:79], v26 offset:9216
    ds_read_b128 v[80:83], v27 offset:7168
    v_mfma_f32_32x32x16_bf16 v[132:147], v[48:51], v[40:43], v[132:147]
    s_waitcnt lgkmcnt(7)
    v_mfma_f32_32x32x16_bf16 v[148:163], v[52:55], v[36:39], v[148:163]
    v_mfma_f32_32x32x16_bf16 v[164:179], v[52:55], v[40:43], v[164:179]
    s_waitcnt lgkmcnt(6)
    v_mfma_f32_32x32x16_bf16 v[180:195], v[56:59], v[36:39], v[180:195]
    s_waitcnt lgkmcnt(4)
    v_mfma_f32_32x32x16_bf16 v[84:99], v[68:71], v[60:63], v[84:99]
    ds_read_b128 v[36:39], v16 offset:2048
    ds_read_b128 v[44:47], v26 offset:14336
    s_waitcnt lgkmcnt(5)
    v_mfma_f32_32x32x16_bf16 v[100:115], v[68:71], v[64:67], v[100:115]
    ds_read_b128 v[40:43], v17 offset:2048
    ds_read_b128 v[48:51], v26 offset:15360
    s_waitcnt lgkmcnt(6)
    v_mfma_f32_32x32x16_bf16 v[116:131], v[72:75], v[60:63], v[116:131]
    ds_read_b128 v[52:55], v26 offset:16384
    ds_read_b128 v[56:59], v27 offset:14336
    v_mfma_f32_32x32x16_bf16 v[132:147], v[72:75], v[64:67], v[132:147]
    s_waitcnt lgkmcnt(7)
    v_mfma_f32_32x32x16_bf16 v[148:163], v[76:79], v[60:63], v[148:163]
    v_mfma_f32_32x32x16_bf16 v[164:179], v[76:79], v[64:67], v[164:179]
    s_waitcnt lgkmcnt(6)
    v_mfma_f32_32x32x16_bf16 v[180:195], v[80:83], v[60:63], v[180:195]
    s_waitcnt lgkmcnt(4)
    v_mfma_f32_32x32x16_bf16 v[84:99], v[44:47], v[36:39], v[84:99]
    ds_read_b128 v[60:63], v16 offset:3072
    ds_read_b128 v[68:71], v26 offset:21504
    s_waitcnt lgkmcnt(5)
    v_mfma_f32_32x32x16_bf16 v[100:115], v[44:47], v[40:43], v[100:115]
    ds_read_b128 v[64:67], v17 offset:3072
    ds_read_b128 v[72:75], v26 offset:22528
    s_waitcnt lgkmcnt(6)
    v_mfma_f32_32x32x16_bf16 v[116:131], v[48:51], v[36:39], v[116:131]
    ds_read_b128 v[76:79], v26 offset:23552
    ds_read_b128 v[80:83], v27 offset:21504
    v_mfma_f32_32x32x16_bf16 v[132:147], v[48:51], v[40:43], v[132:147]
    s_waitcnt lgkmcnt(7)
    v_mfma_f32_32x32x16_bf16 v[148:163], v[52:55], v[36:39], v[148:163]
    v_mfma_f32_32x32x16_bf16 v[164:179], v[52:55], v[40:43], v[164:179]
    s_waitcnt lgkmcnt(6)
    v_mfma_f32_32x32x16_bf16 v[180:195], v[56:59], v[36:39], v[180:195]
    s_waitcnt lgkmcnt(0)
    v_add_u32 v16, s13, v8
    v_add_u32 v17, s13, v9
    v_add_u32 v26, s13, v24
    v_add_u32 v27, s13, v25
    s_add_u32 s13, s13, 45056
    s_cmp_eq_u32 s13, 135168
    s_cselect_b32 s13, 0, s13
    s_barrier
    v_mfma_f32_32x32x16_bf16 v[84:99], v[68:71], v[60:63], v[84:99]
    ds_read_b128 v[36:39], v16 offset:0
    ds_read_b128 v[44:47], v26 offset:0
    v_mfma_f32_32x32x16_bf16 v[100:115], v[68:71], v[64:67], v[100:115]
    ds_read_b128 v[40:43], v17 offset:0
    ds_read_b128 v[48:51], v26 offset:1024
    v_mfma_f32_32x32x16_bf16 v[116:131], v[72:75], v[60:63], v[116:131]
    ds_read_b128 v[52:55], v26 offset:2048
    ds_read_b128 v[56:59], v27 offset:0
    v_mfma_f32_32x32x16_bf16 v[132:147], v[72:75], v[64:67], v[132:147]
    v_mfma_f32_32x32x16_bf16 v[148:163], v[76:79], v[60:63], v[148:163]
    v_mfma_f32_32x32x16_bf16 v[164:179], v[76:79], v[64:67], v[164:179]
    v_mfma_f32_32x32x16_bf16 v[180:195], v[80:83], v[60:63], v[180:195]
    s_sub_u32 s51, s51, 1
    s_cmp_lg_u32 s51, 0
    s_cbranch_scc1 L_w1a_c_loop
    s_waitcnt lgkmcnt(4)
    v_mfma_f32_32x32x16_bf16 v[84:99], v[44:47], v[36:39], v[84:99]
    ds_read_b128 v[60:63], v16 offset:1024
    ds_read_b128 v[68:71], v26 offset:7168
    s_waitcnt lgkmcnt(5)
    v_mfma_f32_32x32x16_bf16 v[100:115], v[44:47], v[40:43], v[100:115]
    ds_read_b128 v[64:67], v17 offset:1024
    ds_read_b128 v[72:75], v26 offset:8192
    s_waitcnt lgkmcnt(6)
    v_mfma_f32_32x32x16_bf16 v[116:131], v[48:51], v[36:39], v[116:131]
    ds_read_b128 v[76:79], v26 offset:9216
    ds_read_b128 v[80:83], v27 offset:7168
    v_mfma_f32_32x32x16_bf16 v[132:147], v[48:51], v[40:43], v[132:147]
    s_waitcnt lgkmcnt(7)
    v_mfma_f32_32x32x16_bf16 v[148:163], v[52:55], v[36:39], v[148:163]
    v_mfma_f32_32x32x16_bf16 v[164:179], v[52:55], v[40:43], v[164:179]
    s_waitcnt lgkmcnt(6)
    v_mfma_f32_32x32x16_bf16 v[180:195], v[56:59], v[36:39], v[180:195]
    s_waitcnt lgkmcnt(4)
    v_mfma_f32_32x32x16_bf16 v[84:99], v[68:71], v[60:63], v[84:99]
    ds_read_b128 v[36:39], v16 offset:2048
    ds_read_b128 v[44:47], v26 offset:14336
    s_waitcnt lgkmcnt(5)
    v_mfma_f32_32x32x16_bf16 v[100:115], v[68:71], v[64:67], v[100:115]
    ds_read_b128 v[40:43], v17 offset:2048
    ds_read_b128 v[48:51], v26 offset:15360
    s_waitcnt lgkmcnt(6)
    v_mfma_f32_32x32x16_bf16 v[116:131], v[72:75], v[60:63], v[116:131]
    ds_read_b128 v[52:55], v26 offset:16384
    ds_read_b128 v[56:59], v27 offset:14336
    v_mfma_f32_32x32x16_bf16 v[132:147], v[72:75], v[64:67], v[132:147]
    s_waitcnt lgkmcnt(7)
    v_mfma_f32_32x32x16_bf16 v[148:163], v[76:79], v[60:63], v[148:163]
    v_mfma_f32_32x32x16_bf16 v[164:179], v[76:79], v[64:67], v[164:179]
    s_waitcnt lgkmcnt(6)
    v_mfma_f32_32x32x16_bf16 v[180:195], v[80:83], v[60:63], v[180:195]
    s_waitcnt lgkmcnt(4)
    v_mfma_f32_32x32x16_bf16 v[84:99], v[44:47], v[36:39], v[84:99]
    ds_read_b128 v[60:63], v16 offset:3072
    ds_read_b128 v[68:71], v26 offset:21504
    s_waitcnt lgkmcnt(5)
    v_mfma_f32_32x32x16_bf16 v[100:115], v[44:47], v[40:43], v[100:115]
    ds_read_b128 v[64:67], v17 offset:3072
    ds_read_b128 v[72:75], v26 offset:22528
    s_waitcnt lgkmcnt(6)
    v_mfma_f32_32x32x16_bf16 v[116:131], v[48:51], v[36:39], v[116:131]
    ds_read_b128 v[76:79], v26 offset:23552
    ds_read_b128 v[80:83], v27 offset:21504
    v_mfma_f32_32x32x16_bf16 v[132:147], v[48:51], v[40:43], v[132:147]
    s_waitcnt lgkmcnt(7)
    v_mfma_f32_32x32x16_bf16 v[148:163], v[52:55], v[36:39], v[148:163]
    v_mfma_f32_32x32x16_bf16 v[164:179], v[52:55], v[40:43], v[164:179]
    s_waitcnt lgkmcnt(6)
    v_mfma_f32_32x32x16_bf16 v[180:195], v[56:59], v[36:39], v[180:195]
    s_waitcnt lgkmcnt(4)
    v_mfma_f32_32x32x16_bf16 v[84:99], v[68:71], v[60:63], v[84:99]
    s_waitcnt lgkmcnt(3)
    v_mfma_f32_32x32x16_bf16 v[100:115], v[68:71], v[64:67], v[100:115]
    s_waitcnt lgkmcnt(2)
    v_mfma_f32_32x32x16_bf16 v[116:131], v[72:75], v[60:63], v[116:131]
    v_mfma_f32_32x32x16_bf16 v[132:147], v[72:75], v[64:67], v[132:147]
    s_waitcnt lgkmcnt(1)
    v_mfma_f32_32x32x16_bf16 v[148:163], v[76:79], v[60:63], v[148:163]
    v_mfma_f32_32x32x16_bf16 v[164:179], v[76:79], v[64:67], v[164:179]
    s_waitcnt lgkmcnt(0)
    v_mfma_f32_32x32x16_bf16 v[180:195], v[80:83], v[60:63], v[180:195]
    s_lshl_b32 s4, s10, 11
    s_add_u32 s4, s4, 140288
    v_lshlrev_b32 v4, 2, v2
    v_add_u32 v4, s4, v4
    v_lshlrev_b32 v5, 4, v3
    v_add_u32 v5, s4, v5
    s_waitcnt vmcnt(0)
    v_lshlrev_b32 v32, 16, v32
    v_mul_f32 v32, 0x3eeff558, v32
    ds_write_b32 v4, v32 offset:512
    v_lshlrev_b32 v33, 16, v33
    v_mul_f32 v33, 0x3eeff558, v33
    ds_write_b32 v4, v33 offset:640
    v_lshlrev_b32 v34, 16, v34
    v_mul_f32 v34, 0x3eeff558, v34
    ds_write_b32 v4, v34 offset:768
    v_lshlrev_b32 v35, 16, v35
    v_mul_f32 v35, 0x3eeff558, v35
    ds_write_b32 v4, v35 offset:896
    s_mul_i32 s4, s12, 384
    s_add_u32 s4, s4, 148480
    v_lshlrev_b32 v28, 4, v3
    v_add_u32 v29, 149248, v28
    v_add_u32 v28, s4, v28
    s_waitcnt lgkmcnt(0)
    s_barrier
    s_add_u32 s40, s36, 16777216
    s_addc_u32 s41, s37, 0
    s_mov_b32 s42, 14680064
    s_mov_b32 s43, 0x20000
    v_mov_b32 v10, v8
    v_mov_b32 v11, v9
    s_lshl_b32 s4, s14, 7
    s_add_u32 s4, s4, 139264
    s_lshl_b32 s5, s15, 7
    s_add_u32 s5, s5, 139264
    v_lshlrev_b32 v7, 2, v2
    v_add_u32 v8, s4, v7
    v_add_u32 v9, s5, v7
    s_lshl_b32 s4, s8, 2
    s_add_u32 s6, s4, s14
    s_add_u32 s7, s4, s15
    s_mul_i32 s6, s6, 229376
    s_mul_i32 s7, s7, 229376
    s_mul_i32 s4, s9, 14336
    s_add_u32 s6, s6, s4
    s_add_u32 s7, s7, s4
    s_add_u32 s13, s6, 12288
    s_mul_i32 s4, s12, 6144
    s_add_u32 s14, s6, s4
    s_add_u32 s15, s7, s4
    v_lshlrev_b32 v6, 4, v0
    ds_read_b32 v196, v8
    ds_read_b32 v197, v8 offset:512
    ds_read_b32 v198, v9
    ds_read_b32 v199, v9 offset:512
    v_mov_b32 v200, 0x409d30fc
    v_mov_b32 v202, 0x3eeff558
    v_mov_b32 v201, 0x409d30fc
    v_mov_b32 v203, 0x3eeff558
    s_waitcnt lgkmcnt(0)
    v_mul_f32 v196, 0x3eeff558, v196
    v_mul_f32 v197, 0x3eeff558, v197
    v_mul_f32 v198, 0x3eeff558, v198
    v_mul_f32 v199, 0x3eeff558, v199
    ds_read_b128 v[36:39], v28 offset:0
    ds_read_b128 v[52:55], v5 offset:512
    ds_read_b128 v[40:43], v28 offset:32
    ds_read_b128 v[56:59], v5 offset:544
    ds_read_b128 v[44:47], v28 offset:64
    ds_read_b128 v[60:63], v5 offset:576
    ds_read_b128 v[48:51], v28 offset:96
    ds_read_b128 v[64:67], v5 offset:608
    s_waitcnt lgkmcnt(0)
    v_pk_fma_f32 v[208:209], v[36:37], v[196:197], v[52:53] op_sel:[0,1,0]
    v_pk_fma_f32 v[210:211], v[38:39], v[196:197], v[54:55] op_sel:[0,1,0]
    v_pk_fma_f32 v[212:213], v[40:41], v[196:197], v[56:57] op_sel:[0,1,0]
    v_pk_fma_f32 v[214:215], v[42:43], v[196:197], v[58:59] op_sel:[0,1,0]
    v_pk_fma_f32 v[216:217], v[44:45], v[196:197], v[60:61] op_sel:[0,1,0]
    v_pk_fma_f32 v[218:219], v[46:47], v[196:197], v[62:63] op_sel:[0,1,0]
    v_pk_fma_f32 v[220:221], v[48:49], v[196:197], v[64:65] op_sel:[0,1,0]
    v_pk_fma_f32 v[222:223], v[50:51], v[196:197], v[66:67] op_sel:[0,1,0]
    v_pk_fma_f32 v[84:85], v[84:85], v[196:197], v[208:209] op_sel_hi:[1,0,1]
    v_pk_fma_f32 v[86:87], v[86:87], v[196:197], v[210:211] op_sel_hi:[1,0,1]
    v_pk_fma_f32 v[88:89], v[88:89], v[196:197], v[212:213] op_sel_hi:[1,0,1]
    v_pk_fma_f32 v[90:91], v[90:91], v[196:197], v[214:215] op_sel_hi:[1,0,1]
    v_pk_fma_f32 v[92:93], v[92:93], v[196:197], v[216:217] op_sel_hi:[1,0,1]
    v_pk_fma_f32 v[94:95], v[94:95], v[196:197], v[218:219] op_sel_hi:[1,0,1]
    v_pk_fma_f32 v[96:97], v[96:97], v[196:197], v[220:221] op_sel_hi:[1,0,1]
    v_pk_fma_f32 v[98:99], v[98:99], v[196:197], v[222:223] op_sel_hi:[1,0,1]
    v_pk_fma_f32 v[208:209], v[84:85], v[84:85], v[200:201]
    v_pk_fma_f32 v[210:211], v[86:87], v[86:87], v[200:201]
    v_pk_fma_f32 v[212:213], v[88:89], v[88:89], v[200:201]
    v_pk_fma_f32 v[214:215], v[90:91], v[90:91], v[200:201]
    v_pk_fma_f32 v[216:217], v[92:93], v[92:93], v[200:201]
    v_pk_fma_f32 v[218:219], v[94:95], v[94:95], v[200:201]
    v_pk_fma_f32 v[220:221], v[96:97], v[96:97], v[200:201]
    v_pk_fma_f32 v[222:223], v[98:99], v[98:99], v[200:201]
    v_pk_mul_f32 v[208:209], v[208:209], v[84:85]
    v_pk_mul_f32 v[210:211], v[210:211], v[86:87]
    v_pk_mul_f32 v[212:213], v[212:213], v[88:89]
    v_pk_mul_f32 v[214:215], v[214:215], v[90:91]
    v_pk_mul_f32 v[216:217], v[216:217], v[92:93]
    v_pk_mul_f32 v[218:219], v[218:219], v[94:95]
    v_pk_mul_f32 v[220:221], v[220:221], v[96:97]
    v_pk_mul_f32 v[222:223], v[222:223], v[98:99]
    v_exp_f32_e64 v208, -v208
    v_exp_f32_e64 v209, -v209
    v_exp_f32_e64 v210, -v210
    v_exp_f32_e64 v211, -v211
    v_exp_f32_e64 v212, -v212
    v_exp_f32_e64 v213, -v213
    v_exp_f32_e64 v214, -v214
    v_exp_f32_e64 v215, -v215
    v_exp_f32_e64 v216, -v216
    v_exp_f32_e64 v217, -v217
    v_exp_f32_e64 v218, -v218
    v_exp_f32_e64 v219, -v219
    v_exp_f32_e64 v220, -v220
    v_exp_f32_e64 v221, -v221
    v_exp_f32_e64 v222, -v222
    v_exp_f32_e64 v223, -v223
    v_pk_fma_f32 v[208:209], v[208:209], v[202:203], v[202:203]
    v_pk_fma_f32 v[210:211], v[210:211], v[202:203], v[202:203]
    v_pk_fma_f32 v[212:213], v[212:213], v[202:203], v[202:203]
    v_pk_fma_f32 v[214:215], v[214:215], v[202:203], v[202:203]
    v_pk_fma_f32 v[216:217], v[216:217], v[202:203], v[202:203]
    v_pk_fma_f32 v[218:219], v[218:219], v[202:203], v[202:203]
    v_pk_fma_f32 v[220:221], v[220:221], v[202:203], v[202:203]
    v_pk_fma_f32 v[222:223], v[222:223], v[202:203], v[202:203]
    v_rcp_f32 v208, v208
    v_rcp_f32 v209, v209
    v_rcp_f32 v210, v210
    v_rcp_f32 v211, v211
    v_rcp_f32 v212, v212
    v_rcp_f32 v213, v213
    v_rcp_f32 v214, v214
    v_rcp_f32 v215, v215
    v_rcp_f32 v216, v216
    v_rcp_f32 v217, v217
    v_rcp_f32 v218, v218
    v_rcp_f32 v219, v219
    v_rcp_f32 v220, v220
    v_rcp_f32 v221, v221
    v_rcp_f32 v222, v222
    v_rcp_f32 v223, v223
    v_pk_mul_f32 v[208:209], v[84:85], v[208:209]
    v_pk_mul_f32 v[210:211], v[86:87], v[210:211]
    v_pk_mul_f32 v[212:213], v[88:89], v[212:213]
    v_pk_mul_f32 v[214:215], v[90:91], v[214:215]
    v_pk_mul_f32 v[216:217], v[92:93], v[216:217]
    v_pk_mul_f32 v[218:219], v[94:95], v[218:219]
    v_pk_mul_f32 v[220:221], v[96:97], v[220:221]
    v_pk_mul_f32 v[222:223], v[98:99], v[222:223]
    v_cvt_pk_bf16_f32 v84, v208, v209
    v_cvt_pk_bf16_f32 v85, v210, v211
    v_cvt_pk_bf16_f32 v86, v212, v213
    v_cvt_pk_bf16_f32 v87, v214, v215
    v_cvt_pk_bf16_f32 v88, v216, v217
    v_cvt_pk_bf16_f32 v89, v218, v219
    v_cvt_pk_bf16_f32 v90, v220, v221
    v_cvt_pk_bf16_f32 v91, v222, v223
    buffer_store_dwordx4 v[84:87], v6, s[40:43], s14 offen offset:0 sc1
    buffer_store_dwordx4 v[88:91], v6, s[40:43], s14 offen offset:1024 sc1
    v_pk_fma_f32 v[208:209], v[36:37], v[198:199], v[52:53] op_sel:[0,1,0]
    v_pk_fma_f32 v[210:211], v[38:39], v[198:199], v[54:55] op_sel:[0,1,0]
    v_pk_fma_f32 v[212:213], v[40:41], v[198:199], v[56:57] op_sel:[0,1,0]
    v_pk_fma_f32 v[214:215], v[42:43], v[198:199], v[58:59] op_sel:[0,1,0]
    v_pk_fma_f32 v[216:217], v[44:45], v[198:199], v[60:61] op_sel:[0,1,0]
    v_pk_fma_f32 v[218:219], v[46:47], v[198:199], v[62:63] op_sel:[0,1,0]
    v_pk_fma_f32 v[220:221], v[48:49], v[198:199], v[64:65] op_sel:[0,1,0]
    v_pk_fma_f32 v[222:223], v[50:51], v[198:199], v[66:67] op_sel:[0,1,0]
    v_pk_fma_f32 v[100:101], v[100:101], v[198:199], v[208:209] op_sel_hi:[1,0,1]
    v_pk_fma_f32 v[102:103], v[102:103], v[198:199], v[210:211] op_sel_hi:[1,0,1]
    v_pk_fma_f32 v[104:105], v[104:105], v[198:199], v[212:213] op_sel_hi:[1,0,1]
    v_pk_fma_f32 v[106:107], v[106:107], v[198:199], v[214:215] op_sel_hi:[1,0,1]
    v_pk_fma_f32 v[108:109], v[108:109], v[198:199], v[216:217] op_sel_hi:[1,0,1]
    v_pk_fma_f32 v[110:111], v[110:111], v[198:199], v[218:219] op_sel_hi:[1,0,1]
    v_pk_fma_f32 v[112:113], v[112:113], v[198:199], v[220:221] op_sel_hi:[1,0,1]
    v_pk_fma_f32 v[114:115], v[114:115], v[198:199], v[222:223] op_sel_hi:[1,0,1]
    v_pk_fma_f32 v[208:209], v[100:101], v[100:101], v[200:201]
    v_pk_fma_f32 v[210:211], v[102:103], v[102:103], v[200:201]
    v_pk_fma_f32 v[212:213], v[104:105], v[104:105], v[200:201]
    v_pk_fma_f32 v[214:215], v[106:107], v[106:107], v[200:201]
    v_pk_fma_f32 v[216:217], v[108:109], v[108:109], v[200:201]
    v_pk_fma_f32 v[218:219], v[110:111], v[110:111], v[200:201]
    v_pk_fma_f32 v[220:221], v[112:113], v[112:113], v[200:201]
    v_pk_fma_f32 v[222:223], v[114:115], v[114:115], v[200:201]
    v_pk_mul_f32 v[208:209], v[208:209], v[100:101]
    v_pk_mul_f32 v[210:211], v[210:211], v[102:103]
    v_pk_mul_f32 v[212:213], v[212:213], v[104:105]
    v_pk_mul_f32 v[214:215], v[214:215], v[106:107]
    v_pk_mul_f32 v[216:217], v[216:217], v[108:109]
    v_pk_mul_f32 v[218:219], v[218:219], v[110:111]
    v_pk_mul_f32 v[220:221], v[220:221], v[112:113]
    v_pk_mul_f32 v[222:223], v[222:223], v[114:115]
    v_exp_f32_e64 v208, -v208
    v_exp_f32_e64 v209, -v209
    v_exp_f32_e64 v210, -v210
    v_exp_f32_e64 v211, -v211
    v_exp_f32_e64 v212, -v212
    v_exp_f32_e64 v213, -v213
    v_exp_f32_e64 v214, -v214
    v_exp_f32_e64 v215, -v215
    v_exp_f32_e64 v216, -v216
    v_exp_f32_e64 v217, -v217
    v_exp_f32_e64 v218, -v218
    v_exp_f32_e64 v219, -v219
    v_exp_f32_e64 v220, -v220
    v_exp_f32_e64 v221, -v221
    v_exp_f32_e64 v222, -v222
    v_exp_f32_e64 v223, -v223
    v_pk_fma_f32 v[208:209], v[208:209], v[202:203], v[202:203]
    v_pk_fma_f32 v[210:211], v[210:211], v[202:203], v[202:203]
    v_pk_fma_f32 v[212:213], v[212:213], v[202:203], v[202:203]
    v_pk_fma_f32 v[214:215], v[214:215], v[202:203], v[202:203]
    v_pk_fma_f32 v[216:217], v[216:217], v[202:203], v[202:203]
    v_pk_fma_f32 v[218:219], v[218:219], v[202:203], v[202:203]
    v_pk_fma_f32 v[220:221], v[220:221], v[202:203], v[202:203]
    v_pk_fma_f32 v[222:223], v[222:223], v[202:203], v[202:203]
    v_rcp_f32 v208, v208
    v_rcp_f32 v209, v209
    v_rcp_f32 v210, v210
    v_rcp_f32 v211, v211
    v_rcp_f32 v212, v212
    v_rcp_f32 v213, v213
    v_rcp_f32 v214, v214
    v_rcp_f32 v215, v215
    v_rcp_f32 v216, v216
    v_rcp_f32 v217, v217
    v_rcp_f32 v218, v218
    v_rcp_f32 v219, v219
    v_rcp_f32 v220, v220
    v_rcp_f32 v221, v221
    v_rcp_f32 v222, v222
    v_rcp_f32 v223, v223
    v_pk_mul_f32 v[208:209], v[100:101], v[208:209]
    v_pk_mul_f32 v[210:211], v[102:103], v[210:211]
    v_pk_mul_f32 v[212:213], v[104:105], v[212:213]
    v_pk_mul_f32 v[214:215], v[106:107], v[214:215]
    v_pk_mul_f32 v[216:217], v[108:109], v[216:217]
    v_pk_mul_f32 v[218:219], v[110:111], v[218:219]
    v_pk_mul_f32 v[220:221], v[112:113], v[220:221]
    v_pk_mul_f32 v[222:223], v[114:115], v[222:223]
    v_cvt_pk_bf16_f32 v100, v208, v209
    v_cvt_pk_bf16_f32 v101, v210, v211
    v_cvt_pk_bf16_f32 v102, v212, v213
    v_cvt_pk_bf16_f32 v103, v214, v215
    v_cvt_pk_bf16_f32 v104, v216, v217
    v_cvt_pk_bf16_f32 v105, v218, v219
    v_cvt_pk_bf16_f32 v106, v220, v221
    v_cvt_pk_bf16_f32 v107, v222, v223
    buffer_store_dwordx4 v[100:103], v6, s[40:43], s15 offen offset:0 sc1
    buffer_store_dwordx4 v[104:107], v6, s[40:43], s15 offen offset:1024 sc1
    ds_read_b128 v[36:39], v28 offset:128
    ds_read_b128 v[52:55], v5 offset:640
    ds_read_b128 v[40:43], v28 offset:160
    ds_read_b128 v[56:59], v5 offset:672
    ds_read_b128 v[44:47], v28 offset:192
    ds_read_b128 v[60:63], v5 offset:704
    ds_read_b128 v[48:51], v28 offset:224
    ds_read_b128 v[64:67], v5 offset:736
    s_waitcnt lgkmcnt(0)
    v_pk_fma_f32 v[208:209], v[36:37], v[196:197], v[52:53] op_sel:[0,1,0]
    v_pk_fma_f32 v[210:211], v[38:39], v[196:197], v[54:55] op_sel:[0,1,0]
    v_pk_fma_f32 v[212:213], v[40:41], v[196:197], v[56:57] op_sel:[0,1,0]
    v_pk_fma_f32 v[214:215], v[42:43], v[196:197], v[58:59] op_sel:[0,1,0]
    v_pk_fma_f32 v[216:217], v[44:45], v[196:197], v[60:61] op_sel:[0,1,0]
    v_pk_fma_f32 v[218:219], v[46:47], v[196:197], v[62:63] op_sel:[0,1,0]
    v_pk_fma_f32 v[220:221], v[48:49], v[196:197], v[64:65] op_sel:[0,1,0]
    v_pk_fma_f32 v[222:223], v[50:51], v[196:197], v[66:67] op_sel:[0,1,0]
    v_pk_fma_f32 v[116:117], v[116:117], v[196:197], v[208:209] op_sel_hi:[1,0,1]
    v_pk_fma_f32 v[118:119], v[118:119], v[196:197], v[210:211] op_sel_hi:[1,0,1]
    v_pk_fma_f32 v[120:121], v[120:121], v[196:197], v[212:213] op_sel_hi:[1,0,1]
    v_pk_fma_f32 v[122:123], v[122:123], v[196:197], v[214:215] op_sel_hi:[1,0,1]
    v_pk_fma_f32 v[124:125], v[124:125], v[196:197], v[216:217] op_sel_hi:[1,0,1]
    v_pk_fma_f32 v[126:127], v[126:127], v[196:197], v[218:219] op_sel_hi:[1,0,1]
    v_pk_fma_f32 v[128:129], v[128:129], v[196:197], v[220:221] op_sel_hi:[1,0,1]
    v_pk_fma_f32 v[130:131], v[130:131], v[196:197], v[222:223] op_sel_hi:[1,0,1]
    v_pk_fma_f32 v[208:209], v[116:117], v[116:117], v[200:201]
    v_pk_fma_f32 v[210:211], v[118:119], v[118:119], v[200:201]
    v_pk_fma_f32 v[212:213], v[120:121], v[120:121], v[200:201]
    v_pk_fma_f32 v[214:215], v[122:123], v[122:123], v[200:201]
    v_pk_fma_f32 v[216:217], v[124:125], v[124:125], v[200:201]
    v_pk_fma_f32 v[218:219], v[126:127], v[126:127], v[200:201]
    v_pk_fma_f32 v[220:221], v[128:129], v[128:129], v[200:201]
    v_pk_fma_f32 v[222:223], v[130:131], v[130:131], v[200:201]
    v_pk_mul_f32 v[208:209], v[208:209], v[116:117]
    v_pk_mul_f32 v[210:211], v[210:211], v[118:119]
    v_pk_mul_f32 v[212:213], v[212:213], v[120:121]
    v_pk_mul_f32 v[214:215], v[214:215], v[122:123]
    v_pk_mul_f32 v[216:217], v[216:217], v[124:125]
    v_pk_mul_f32 v[218:219], v[218:219], v[126:127]
    v_pk_mul_f32 v[220:221], v[220:221], v[128:129]
    v_pk_mul_f32 v[222:223], v[222:223], v[130:131]
    v_exp_f32_e64 v208, -v208
    v_exp_f32_e64 v209, -v209
    v_exp_f32_e64 v210, -v210
    v_exp_f32_e64 v211, -v211
    v_exp_f32_e64 v212, -v212
    v_exp_f32_e64 v213, -v213
    v_exp_f32_e64 v214, -v214
    v_exp_f32_e64 v215, -v215
    v_exp_f32_e64 v216, -v216
    v_exp_f32_e64 v217, -v217
    v_exp_f32_e64 v218, -v218
    v_exp_f32_e64 v219, -v219
    v_exp_f32_e64 v220, -v220
    v_exp_f32_e64 v221, -v221
    v_exp_f32_e64 v222, -v222
    v_exp_f32_e64 v223, -v223
    v_pk_fma_f32 v[208:209], v[208:209], v[202:203], v[202:203]
    v_pk_fma_f32 v[210:211], v[210:211], v[202:203], v[202:203]
    v_pk_fma_f32 v[212:213], v[212:213], v[202:203], v[202:203]
    v_pk_fma_f32 v[214:215], v[214:215], v[202:203], v[202:203]
    v_pk_fma_f32 v[216:217], v[216:217], v[202:203], v[202:203]
    v_pk_fma_f32 v[218:219], v[218:219], v[202:203], v[202:203]
    v_pk_fma_f32 v[220:221], v[220:221], v[202:203], v[202:203]
    v_pk_fma_f32 v[222:223], v[222:223], v[202:203], v[202:203]
    v_rcp_f32 v208, v208
    v_rcp_f32 v209, v209
    v_rcp_f32 v210, v210
    v_rcp_f32 v211, v211
    v_rcp_f32 v212, v212
    v_rcp_f32 v213, v213
    v_rcp_f32 v214, v214
    v_rcp_f32 v215, v215
    v_rcp_f32 v216, v216
    v_rcp_f32 v217, v217
    v_rcp_f32 v218, v218
    v_rcp_f32 v219, v219
    v_rcp_f32 v220, v220
    v_rcp_f32 v221, v221
    v_rcp_f32 v222, v222
    v_rcp_f32 v223, v223
    v_pk_mul_f32 v[208:209], v[116:117], v[208:209]
    v_pk_mul_f32 v[210:211], v[118:119], v[210:211]
    v_pk_mul_f32 v[212:213], v[120:121], v[212:213]
    v_pk_mul_f32 v[214:215], v[122:123], v[214:215]
    v_pk_mul_f32 v[216:217], v[124:125], v[216:217]
    v_pk_mul_f32 v[218:219], v[126:127], v[218:219]
    v_pk_mul_f32 v[220:221], v[128:129], v[220:221]
    v_pk_mul_f32 v[222:223], v[130:131], v[222:223]
    v_cvt_pk_bf16_f32 v116, v208, v209
    v_cvt_pk_bf16_f32 v117, v210, v211
    v_cvt_pk_bf16_f32 v118, v212, v213
    v_cvt_pk_bf16_f32 v119, v214, v215
    v_cvt_pk_bf16_f32 v120, v216, v217
    v_cvt_pk_bf16_f32 v121, v218, v219
    v_cvt_pk_bf16_f32 v122, v220, v221
    v_cvt_pk_bf16_f32 v123, v222, v223
    buffer_store_dwordx4 v[116:119], v6, s[40:43], s14 offen offset:2048 sc1
    buffer_store_dwordx4 v[120:123], v6, s[40:43], s14 offen offset:3072 sc1
    v_pk_fma_f32 v[208:209], v[36:37], v[198:199], v[52:53] op_sel:[0,1,0]
    v_pk_fma_f32 v[210:211], v[38:39], v[198:199], v[54:55] op_sel:[0,1,0]
    v_pk_fma_f32 v[212:213], v[40:41], v[198:199], v[56:57] op_sel:[0,1,0]
    v_pk_fma_f32 v[214:215], v[42:43], v[198:199], v[58:59] op_sel:[0,1,0]
    v_pk_fma_f32 v[216:217], v[44:45], v[198:199], v[60:61] op_sel:[0,1,0]
    v_pk_fma_f32 v[218:219], v[46:47], v[198:199], v[62:63] op_sel:[0,1,0]
    v_pk_fma_f32 v[220:221], v[48:49], v[198:199], v[64:65] op_sel:[0,1,0]
    v_pk_fma_f32 v[222:223], v[50:51], v[198:199], v[66:67] op_sel:[0,1,0]
    v_pk_fma_f32 v[132:133], v[132:133], v[198:199], v[208:209] op_sel_hi:[1,0,1]
    v_pk_fma_f32 v[134:135], v[134:135], v[198:199], v[210:211] op_sel_hi:[1,0,1]
    v_pk_fma_f32 v[136:137], v[136:137], v[198:199], v[212:213] op_sel_hi:[1,0,1]
    v_pk_fma_f32 v[138:139], v[138:139], v[198:199], v[214:215] op_sel_hi:[1,0,1]
    v_pk_fma_f32 v[140:141], v[140:141], v[198:199], v[216:217] op_sel_hi:[1,0,1]
    v_pk_fma_f32 v[142:143], v[142:143], v[198:199], v[218:219] op_sel_hi:[1,0,1]
    v_pk_fma_f32 v[144:145], v[144:145], v[198:199], v[220:221] op_sel_hi:[1,0,1]
    v_pk_fma_f32 v[146:147], v[146:147], v[198:199], v[222:223] op_sel_hi:[1,0,1]
    v_pk_fma_f32 v[208:209], v[132:133], v[132:133], v[200:201]
    v_pk_fma_f32 v[210:211], v[134:135], v[134:135], v[200:201]
    v_pk_fma_f32 v[212:213], v[136:137], v[136:137], v[200:201]
    v_pk_fma_f32 v[214:215], v[138:139], v[138:139], v[200:201]
    v_pk_fma_f32 v[216:217], v[140:141], v[140:141], v[200:201]
    v_pk_fma_f32 v[218:219], v[142:143], v[142:143], v[200:201]
    v_pk_fma_f32 v[220:221], v[144:145], v[144:145], v[200:201]
    v_pk_fma_f32 v[222:223], v[146:147], v[146:147], v[200:201]
    v_pk_mul_f32 v[208:209], v[208:209], v[132:133]
    v_pk_mul_f32 v[210:211], v[210:211], v[134:135]
    v_pk_mul_f32 v[212:213], v[212:213], v[136:137]
    v_pk_mul_f32 v[214:215], v[214:215], v[138:139]
    v_pk_mul_f32 v[216:217], v[216:217], v[140:141]
    v_pk_mul_f32 v[218:219], v[218:219], v[142:143]
    v_pk_mul_f32 v[220:221], v[220:221], v[144:145]
    v_pk_mul_f32 v[222:223], v[222:223], v[146:147]
    v_exp_f32_e64 v208, -v208
    v_exp_f32_e64 v209, -v209
    v_exp_f32_e64 v210, -v210
    v_exp_f32_e64 v211, -v211
    v_exp_f32_e64 v212, -v212
    v_exp_f32_e64 v213, -v213
    v_exp_f32_e64 v214, -v214
    v_exp_f32_e64 v215, -v215
    v_exp_f32_e64 v216, -v216
    v_exp_f32_e64 v217, -v217
    v_exp_f32_e64 v218, -v218
    v_exp_f32_e64 v219, -v219
    v_exp_f32_e64 v220, -v220
    v_exp_f32_e64 v221, -v221
    v_exp_f32_e64 v222, -v222
    v_exp_f32_e64 v223, -v223
    v_pk_fma_f32 v[208:209], v[208:209], v[202:203], v[202:203]
    v_pk_fma_f32 v[210:211], v[210:211], v[202:203], v[202:203]
    v_pk_fma_f32 v[212:213], v[212:213], v[202:203], v[202:203]
    v_pk_fma_f32 v[214:215], v[214:215], v[202:203], v[202:203]
    v_pk_fma_f32 v[216:217], v[216:217], v[202:203], v[202:203]
    v_pk_fma_f32 v[218:219], v[218:219], v[202:203], v[202:203]
    v_pk_fma_f32 v[220:221], v[220:221], v[202:203], v[202:203]
    v_pk_fma_f32 v[222:223], v[222:223], v[202:203], v[202:203]
    v_rcp_f32 v208, v208
    v_rcp_f32 v209, v209
    v_rcp_f32 v210, v210
    v_rcp_f32 v211, v211
    v_rcp_f32 v212, v212
    v_rcp_f32 v213, v213
    v_rcp_f32 v214, v214
    v_rcp_f32 v215, v215
    v_rcp_f32 v216, v216
    v_rcp_f32 v217, v217
    v_rcp_f32 v218, v218
    v_rcp_f32 v219, v219
    v_rcp_f32 v220, v220
    v_rcp_f32 v221, v221
    v_rcp_f32 v222, v222
    v_rcp_f32 v223, v223
    v_pk_mul_f32 v[208:209], v[132:133], v[208:209]
    v_pk_mul_f32 v[210:211], v[134:135], v[210:211]
    v_pk_mul_f32 v[212:213], v[136:137], v[212:213]
    v_pk_mul_f32 v[214:215], v[138:139], v[214:215]
    v_pk_mul_f32 v[216:217], v[140:141], v[216:217]
    v_pk_mul_f32 v[218:219], v[142:143], v[218:219]
    v_pk_mul_f32 v[220:221], v[144:145], v[220:221]
    v_pk_mul_f32 v[222:223], v[146:147], v[222:223]
    v_cvt_pk_bf16_f32 v132, v208, v209
    v_cvt_pk_bf16_f32 v133, v210, v211
    v_cvt_pk_bf16_f32 v134, v212, v213
    v_cvt_pk_bf16_f32 v135, v214, v215
    v_cvt_pk_bf16_f32 v136, v216, v217
    v_cvt_pk_bf16_f32 v137, v218, v219
    v_cvt_pk_bf16_f32 v138, v220, v221
    v_cvt_pk_bf16_f32 v139, v222, v223
    buffer_store_dwordx4 v[132:135], v6, s[40:43], s15 offen offset:2048 sc1
    buffer_store_dwordx4 v[136:139], v6, s[40:43], s15 offen offset:3072 sc1
    ds_read_b128 v[36:39], v28 offset:256
    ds_read_b128 v[52:55], v5 offset:768
    ds_read_b128 v[40:43], v28 offset:288
    ds_read_b128 v[56:59], v5 offset:800
    ds_read_b128 v[44:47], v28 offset:320
    ds_read_b128 v[60:63], v5 offset:832
    ds_read_b128 v[48:51], v28 offset:352
    ds_read_b128 v[64:67], v5 offset:864
    s_waitcnt lgkmcnt(0)
    v_pk_fma_f32 v[208:209], v[36:37], v[196:197], v[52:53] op_sel:[0,1,0]
    v_pk_fma_f32 v[210:211], v[38:39], v[196:197], v[54:55] op_sel:[0,1,0]
    v_pk_fma_f32 v[212:213], v[40:41], v[196:197], v[56:57] op_sel:[0,1,0]
    v_pk_fma_f32 v[214:215], v[42:43], v[196:197], v[58:59] op_sel:[0,1,0]
    v_pk_fma_f32 v[216:217], v[44:45], v[196:197], v[60:61] op_sel:[0,1,0]
    v_pk_fma_f32 v[218:219], v[46:47], v[196:197], v[62:63] op_sel:[0,1,0]
    v_pk_fma_f32 v[220:221], v[48:49], v[196:197], v[64:65] op_sel:[0,1,0]
    v_pk_fma_f32 v[222:223], v[50:51], v[196:197], v[66:67] op_sel:[0,1,0]
    v_pk_fma_f32 v[148:149], v[148:149], v[196:197], v[208:209] op_sel_hi:[1,0,1]
    v_pk_fma_f32 v[150:151], v[150:151], v[196:197], v[210:211] op_sel_hi:[1,0,1]
    v_pk_fma_f32 v[152:153], v[152:153], v[196:197], v[212:213] op_sel_hi:[1,0,1]
    v_pk_fma_f32 v[154:155], v[154:155], v[196:197], v[214:215] op_sel_hi:[1,0,1]
    v_pk_fma_f32 v[156:157], v[156:157], v[196:197], v[216:217] op_sel_hi:[1,0,1]
    v_pk_fma_f32 v[158:159], v[158:159], v[196:197], v[218:219] op_sel_hi:[1,0,1]
    v_pk_fma_f32 v[160:161], v[160:161], v[196:197], v[220:221] op_sel_hi:[1,0,1]
    v_pk_fma_f32 v[162:163], v[162:163], v[196:197], v[222:223] op_sel_hi:[1,0,1]
    v_pk_fma_f32 v[208:209], v[148:149], v[148:149], v[200:201]
    v_pk_fma_f32 v[210:211], v[150:151], v[150:151], v[200:201]
    v_pk_fma_f32 v[212:213], v[152:153], v[152:153], v[200:201]
    v_pk_fma_f32 v[214:215], v[154:155], v[154:155], v[200:201]
    v_pk_fma_f32 v[216:217], v[156:157], v[156:157], v[200:201]
    v_pk_fma_f32 v[218:219], v[158:159], v[158:159], v[200:201]
    v_pk_fma_f32 v[220:221], v[160:161], v[160:161], v[200:201]
    v_pk_fma_f32 v[222:223], v[162:163], v[162:163], v[200:201]
    v_pk_mul_f32 v[208:209], v[208:209], v[148:149]
    v_pk_mul_f32 v[210:211], v[210:211], v[150:151]
    v_pk_mul_f32 v[212:213], v[212:213], v[152:153]
    v_pk_mul_f32 v[214:215], v[214:215], v[154:155]
    v_pk_mul_f32 v[216:217], v[216:217], v[156:157]
    v_pk_mul_f32 v[218:219], v[218:219], v[158:159]
    v_pk_mul_f32 v[220:221], v[220:221], v[160:161]
    v_pk_mul_f32 v[222:223], v[222:223], v[162:163]
    v_exp_f32_e64 v208, -v208
    v_exp_f32_e64 v209, -v209
    v_exp_f32_e64 v210, -v210
    v_exp_f32_e64 v211, -v211
    v_exp_f32_e64 v212, -v212
    v_exp_f32_e64 v213, -v213
    v_exp_f32_e64 v214, -v214
    v_exp_f32_e64 v215, -v215
    v_exp_f32_e64 v216, -v216
    v_exp_f32_e64 v217, -v217
    v_exp_f32_e64 v218, -v218
    v_exp_f32_e64 v219, -v219
    v_exp_f32_e64 v220, -v220
    v_exp_f32_e64 v221, -v221
    v_exp_f32_e64 v222, -v222
    v_exp_f32_e64 v223, -v223
    v_pk_fma_f32 v[208:209], v[208:209], v[202:203], v[202:203]
    v_pk_fma_f32 v[210:211], v[210:211], v[202:203], v[202:203]
    v_pk_fma_f32 v[212:213], v[212:213], v[202:203], v[202:203]
    v_pk_fma_f32 v[214:215], v[214:215], v[202:203], v[202:203]
    v_pk_fma_f32 v[216:217], v[216:217], v[202:203], v[202:203]
    v_pk_fma_f32 v[218:219], v[218:219], v[202:203], v[202:203]
    v_pk_fma_f32 v[220:221], v[220:221], v[202:203], v[202:203]
    v_pk_fma_f32 v[222:223], v[222:223], v[202:203], v[202:203]
    v_rcp_f32 v208, v208
    v_rcp_f32 v209, v209
    v_rcp_f32 v210, v210
    v_rcp_f32 v211, v211
    v_rcp_f32 v212, v212
    v_rcp_f32 v213, v213
    v_rcp_f32 v214, v214
    v_rcp_f32 v215, v215
    v_rcp_f32 v216, v216
    v_rcp_f32 v217, v217
    v_rcp_f32 v218, v218
    v_rcp_f32 v219, v219
    v_rcp_f32 v220, v220
    v_rcp_f32 v221, v221
    v_rcp_f32 v222, v222
    v_rcp_f32 v223, v223
    v_pk_mul_f32 v[208:209], v[148:149], v[208:209]
    v_pk_mul_f32 v[210:211], v[150:151], v[210:211]
    v_pk_mul_f32 v[212:213], v[152:153], v[212:213]
    v_pk_mul_f32 v[214:215], v[154:155], v[214:215]
    v_pk_mul_f32 v[216:217], v[156:157], v[216:217]
    v_pk_mul_f32 v[218:219], v[158:159], v[218:219]
    v_pk_mul_f32 v[220:221], v[160:161], v[220:221]
    v_pk_mul_f32 v[222:223], v[162:163], v[222:223]
    v_cvt_pk_bf16_f32 v148, v208, v209
    v_cvt_pk_bf16_f32 v149, v210, v211
    v_cvt_pk_bf16_f32 v150, v212, v213
    v_cvt_pk_bf16_f32 v151, v214, v215
    v_cvt_pk_bf16_f32 v152, v216, v217
    v_cvt_pk_bf16_f32 v153, v218, v219
    v_cvt_pk_bf16_f32 v154, v220, v221
    v_cvt_pk_bf16_f32 v155, v222, v223
    s_add_u32 s6, s14, 4096
    buffer_store_dwordx4 v[148:151], v6, s[40:43], s6 offen offset:0 sc1
    buffer_store_dwordx4 v[152:155], v6, s[40:43], s6 offen offset:1024 sc1
    v_pk_fma_f32 v[208:209], v[36:37], v[198:199], v[52:53] op_sel:[0,1,0]
    v_pk_fma_f32 v[210:211], v[38:39], v[198:199], v[54:55] op_sel:[0,1,0]
    v_pk_fma_f32 v[212:213], v[40:41], v[198:199], v[56:57] op_sel:[0,1,0]
    v_pk_fma_f32 v[214:215], v[42:43], v[198:199], v[58:59] op_sel:[0,1,0]
    v_pk_fma_f32 v[216:217], v[44:45], v[198:199], v[60:61] op_sel:[0,1,0]
    v_pk_fma_f32 v[218:219], v[46:47], v[198:199], v[62:63] op_sel:[0,1,0]
    v_pk_fma_f32 v[220:221], v[48:49], v[198:199], v[64:65] op_sel:[0,1,0]
    v_pk_fma_f32 v[222:223], v[50:51], v[198:199], v[66:67] op_sel:[0,1,0]
    v_pk_fma_f32 v[164:165], v[164:165], v[198:199], v[208:209] op_sel_hi:[1,0,1]
    v_pk_fma_f32 v[166:167], v[166:167], v[198:199], v[210:211] op_sel_hi:[1,0,1]
    v_pk_fma_f32 v[168:169], v[168:169], v[198:199], v[212:213] op_sel_hi:[1,0,1]
    v_pk_fma_f32 v[170:171], v[170:171], v[198:199], v[214:215] op_sel_hi:[1,0,1]
    v_pk_fma_f32 v[172:173], v[172:173], v[198:199], v[216:217] op_sel_hi:[1,0,1]
    v_pk_fma_f32 v[174:175], v[174:175], v[198:199], v[218:219] op_sel_hi:[1,0,1]
    v_pk_fma_f32 v[176:177], v[176:177], v[198:199], v[220:221] op_sel_hi:[1,0,1]
    v_pk_fma_f32 v[178:179], v[178:179], v[198:199], v[222:223] op_sel_hi:[1,0,1]
    v_pk_fma_f32 v[208:209], v[164:165], v[164:165], v[200:201]
    v_pk_fma_f32 v[210:211], v[166:167], v[166:167], v[200:201]
    v_pk_fma_f32 v[212:213], v[168:169], v[168:169], v[200:201]
    v_pk_fma_f32 v[214:215], v[170:171], v[170:171], v[200:201]
    v_pk_fma_f32 v[216:217], v[172:173], v[172:173], v[200:201]
    v_pk_fma_f32 v[218:219], v[174:175], v[174:175], v[200:201]
    v_pk_fma_f32 v[220:221], v[176:177], v[176:177], v[200:201]
    v_pk_fma_f32 v[222:223], v[178:179], v[178:179], v[200:201]
    v_pk_mul_f32 v[208:209], v[208:209], v[164:165]
    v_pk_mul_f32 v[210:211], v[210:211], v[166:167]
    v_pk_mul_f32 v[212:213], v[212:213], v[168:169]
    v_pk_mul_f32 v[214:215], v[214:215], v[170:171]
    v_pk_mul_f32 v[216:217], v[216:217], v[172:173]
    v_pk_mul_f32 v[218:219], v[218:219], v[174:175]
    v_pk_mul_f32 v[220:221], v[220:221], v[176:177]
    v_pk_mul_f32 v[222:223], v[222:223], v[178:179]
    v_exp_f32_e64 v208, -v208
    v_exp_f32_e64 v209, -v209
    v_exp_f32_e64 v210, -v210
    v_exp_f32_e64 v211, -v211
    v_exp_f32_e64 v212, -v212
    v_exp_f32_e64 v213, -v213
    v_exp_f32_e64 v214, -v214
    v_exp_f32_e64 v215, -v215
    v_exp_f32_e64 v216, -v216
    v_exp_f32_e64 v217, -v217
    v_exp_f32_e64 v218, -v218
    v_exp_f32_e64 v219, -v219
    v_exp_f32_e64 v220, -v220
    v_exp_f32_e64 v221, -v221
    v_exp_f32_e64 v222, -v222
    v_exp_f32_e64 v223, -v223
    v_pk_fma_f32 v[208:209], v[208:209], v[202:203], v[202:203]
    v_pk_fma_f32 v[210:211], v[210:211], v[202:203], v[202:203]
    v_pk_fma_f32 v[212:213], v[212:213], v[202:203], v[202:203]
    v_pk_fma_f32 v[214:215], v[214:215], v[202:203], v[202:203]
    v_pk_fma_f32 v[216:217], v[216:217], v[202:203], v[202:203]
    v_pk_fma_f32 v[218:219], v[218:219], v[202:203], v[202:203]
    v_pk_fma_f32 v[220:221], v[220:221], v[202:203], v[202:203]
    v_pk_fma_f32 v[222:223], v[222:223], v[202:203], v[202:203]
    v_rcp_f32 v208, v208
    v_rcp_f32 v209, v209
    v_rcp_f32 v210, v210
    v_rcp_f32 v211, v211
    v_rcp_f32 v212, v212
    v_rcp_f32 v213, v213
    v_rcp_f32 v214, v214
    v_rcp_f32 v215, v215
    v_rcp_f32 v216, v216
    v_rcp_f32 v217, v217
    v_rcp_f32 v218, v218
    v_rcp_f32 v219, v219
    v_rcp_f32 v220, v220
    v_rcp_f32 v221, v221
    v_rcp_f32 v222, v222
    v_rcp_f32 v223, v223
    v_pk_mul_f32 v[208:209], v[164:165], v[208:209]
    v_pk_mul_f32 v[210:211], v[166:167], v[210:211]
    v_pk_mul_f32 v[212:213], v[168:169], v[212:213]
    v_pk_mul_f32 v[214:215], v[170:171], v[214:215]
    v_pk_mul_f32 v[216:217], v[172:173], v[216:217]
    v_pk_mul_f32 v[218:219], v[174:175], v[218:219]
    v_pk_mul_f32 v[220:221], v[176:177], v[220:221]
    v_pk_mul_f32 v[222:223], v[178:179], v[222:223]
    v_cvt_pk_bf16_f32 v164, v208, v209
    v_cvt_pk_bf16_f32 v165, v210, v211
    v_cvt_pk_bf16_f32 v166, v212, v213
    v_cvt_pk_bf16_f32 v167, v214, v215
    v_cvt_pk_bf16_f32 v168, v216, v217
    v_cvt_pk_bf16_f32 v169, v218, v219
    v_cvt_pk_bf16_f32 v170, v220, v221
    v_cvt_pk_bf16_f32 v171, v222, v223
    s_add_u32 s6, s15, 4096
    buffer_store_dwordx4 v[164:167], v6, s[40:43], s6 offen offset:0 sc1
    buffer_store_dwordx4 v[168:171], v6, s[40:43], s6 offen offset:1024 sc1
    ds_read_b128 v[36:39], v29 offset:0
    ds_read_b128 v[52:55], v5 offset:896
    ds_read_b128 v[40:43], v29 offset:32
    ds_read_b128 v[56:59], v5 offset:928
    ds_read_b128 v[44:47], v29 offset:64
    ds_read_b128 v[60:63], v5 offset:960
    ds_read_b128 v[48:51], v29 offset:96
    ds_read_b128 v[64:67], v5 offset:992
    s_waitcnt lgkmcnt(0)
    v_pk_fma_f32 v[208:209], v[36:37], v[196:197], v[52:53] op_sel:[0,1,0]
    v_pk_fma_f32 v[210:211], v[38:39], v[196:197], v[54:55] op_sel:[0,1,0]
    v_pk_fma_f32 v[212:213], v[40:41], v[196:197], v[56:57] op_sel:[0,1,0]
    v_pk_fma_f32 v[214:215], v[42:43], v[196:197], v[58:59] op_sel:[0,1,0]
    v_pk_fma_f32 v[216:217], v[44:45], v[196:197], v[60:61] op_sel:[0,1,0]
    v_pk_fma_f32 v[218:219], v[46:47], v[196:197], v[62:63] op_sel:[0,1,0]
    v_pk_fma_f32 v[220:221], v[48:49], v[196:197], v[64:65] op_sel:[0,1,0]
    v_pk_fma_f32 v[222:223], v[50:51], v[196:197], v[66:67] op_sel:[0,1,0]
    v_pk_fma_f32 v[180:181], v[180:181], v[196:197], v[208:209] op_sel_hi:[1,0,1]
    v_pk_fma_f32 v[182:183], v[182:183], v[196:197], v[210:211] op_sel_hi:[1,0,1]
    v_pk_fma_f32 v[184:185], v[184:185], v[196:197], v[212:213] op_sel_hi:[1,0,1]
    v_pk_fma_f32 v[186:187], v[186:187], v[196:197], v[214:215] op_sel_hi:[1,0,1]
    v_pk_fma_f32 v[188:189], v[188:189], v[196:197], v[216:217] op_sel_hi:[1,0,1]
    v_pk_fma_f32 v[190:191], v[190:191], v[196:197], v[218:219] op_sel_hi:[1,0,1]
    v_pk_fma_f32 v[192:193], v[192:193], v[196:197], v[220:221] op_sel_hi:[1,0,1]
    v_pk_fma_f32 v[194:195], v[194:195], v[196:197], v[222:223] op_sel_hi:[1,0,1]
    v_pk_fma_f32 v[208:209], v[180:181], v[180:181], v[200:201]
    v_pk_fma_f32 v[210:211], v[182:183], v[182:183], v[200:201]
    v_pk_fma_f32 v[212:213], v[184:185], v[184:185], v[200:201]
    v_pk_fma_f32 v[214:215], v[186:187], v[186:187], v[200:201]
    v_pk_fma_f32 v[216:217], v[188:189], v[188:189], v[200:201]
    v_pk_fma_f32 v[218:219], v[190:191], v[190:191], v[200:201]
    v_pk_fma_f32 v[220:221], v[192:193], v[192:193], v[200:201]
    v_pk_fma_f32 v[222:223], v[194:195], v[194:195], v[200:201]
    v_pk_mul_f32 v[208:209], v[208:209], v[180:181]
    v_pk_mul_f32 v[210:211], v[210:211], v[182:183]
    v_pk_mul_f32 v[212:213], v[212:213], v[184:185]
    v_pk_mul_f32 v[214:215], v[214:215], v[186:187]
    v_pk_mul_f32 v[216:217], v[216:217], v[188:189]
    v_pk_mul_f32 v[218:219], v[218:219], v[190:191]
    v_pk_mul_f32 v[220:221], v[220:221], v[192:193]
    v_pk_mul_f32 v[222:223], v[222:223], v[194:195]
    v_exp_f32_e64 v208, -v208
    v_exp_f32_e64 v209, -v209
    v_exp_f32_e64 v210, -v210
    v_exp_f32_e64 v211, -v211
    v_exp_f32_e64 v212, -v212
    v_exp_f32_e64 v213, -v213
    v_exp_f32_e64 v214, -v214
    v_exp_f32_e64 v215, -v215
    v_exp_f32_e64 v216, -v216
    v_exp_f32_e64 v217, -v217
    v_exp_f32_e64 v218, -v218
    v_exp_f32_e64 v219, -v219
    v_exp_f32_e64 v220, -v220
    v_exp_f32_e64 v221, -v221
    v_exp_f32_e64 v222, -v222
    v_exp_f32_e64 v223, -v223
    v_pk_fma_f32 v[208:209], v[208:209], v[202:203], v[202:203]
    v_pk_fma_f32 v[210:211], v[210:211], v[202:203], v[202:203]
    v_pk_fma_f32 v[212:213], v[212:213], v[202:203], v[202:203]
    v_pk_fma_f32 v[214:215], v[214:215], v[202:203], v[202:203]
    v_pk_fma_f32 v[216:217], v[216:217], v[202:203], v[202:203]
    v_pk_fma_f32 v[218:219], v[218:219], v[202:203], v[202:203]
    v_pk_fma_f32 v[220:221], v[220:221], v[202:203], v[202:203]
    v_pk_fma_f32 v[222:223], v[222:223], v[202:203], v[202:203]
    v_rcp_f32 v208, v208
    v_rcp_f32 v209, v209
    v_rcp_f32 v210, v210
    v_rcp_f32 v211, v211
    v_rcp_f32 v212, v212
    v_rcp_f32 v213, v213
    v_rcp_f32 v214, v214
    v_rcp_f32 v215, v215
    v_rcp_f32 v216, v216
    v_rcp_f32 v217, v217
    v_rcp_f32 v218, v218
    v_rcp_f32 v219, v219
    v_rcp_f32 v220, v220
    v_rcp_f32 v221, v221
    v_rcp_f32 v222, v222
    v_rcp_f32 v223, v223
    v_pk_mul_f32 v[208:209], v[180:181], v[208:209]
    v_pk_mul_f32 v[210:211], v[182:183], v[210:211]
    v_pk_mul_f32 v[212:213], v[184:185], v[212:213]
    v_pk_mul_f32 v[214:215], v[186:187], v[214:215]
    v_pk_mul_f32 v[216:217], v[188:189], v[216:217]
    v_pk_mul_f32 v[218:219], v[190:191], v[218:219]
    v_pk_mul_f32 v[220:221], v[192:193], v[220:221]
    v_pk_mul_f32 v[222:223], v[194:195], v[222:223]
    v_cvt_pk_bf16_f32 v180, v208, v209
    v_cvt_pk_bf16_f32 v181, v210, v211
    v_cvt_pk_bf16_f32 v182, v212, v213
    v_cvt_pk_bf16_f32 v183, v214, v215
    v_cvt_pk_bf16_f32 v184, v216, v217
    v_cvt_pk_bf16_f32 v185, v218, v219
    v_cvt_pk_bf16_f32 v186, v220, v221
    v_cvt_pk_bf16_f32 v187, v222, v223
    buffer_store_dwordx4 v[180:183], v6, s[40:43], s13 offen offset:0 sc1
    buffer_store_dwordx4 v[184:187], v6, s[40:43], s13 offen offset:1024 sc1
    s_add_u32 s52, s36, 48234496
    s_addc_u32 s53, s37, 0
    s_mov_b32 s54, 1048576
    s_mov_b32 s55, 0x20000
    s_lshl_b32 s4, s8, 1
    s_lshr_b32 s5, s9, 3
    s_add_u32 s4, s4, s5
    s_lshl_b32 s4, s4, 4
    s_add_u32 s4, s4, s11
    s_lshl_b32 s4, s4, 8
    s_and_b32 s5, s9, 7
    s_lshl_b32 s5, s5, 1
    s_add_u32 s5, s5, s12
    v_bfe_u32 v4, v0, 1, 3
    v_lshlrev_b32 v4, 9, v4
    v_and_b32 v5, 1, v0
    v_lshl_add_u32 v4, v5, 7, v4
    s_lshl_b32 s5, s5, 2
    s_add_u32 s4, s4, s5
    s_add_u32 s4, s4, 262144
    v_mov_b32 v5, 1
    s_waitcnt vmcnt(0)
    s_mov_b64 exec, 0xffff
    buffer_store_dword v5, v4, s[52:55], s4 offen sc1
    s_mov_b64 exec, -1
    s_barrier
L_w1a_dend:
    s_and_b32 s4, s2, 7
    s_lshr_b32 s5, s2, 3
    s_and_b32 s3, s4, 1
    s_lshr_b32 s7, s4, 1
    s_and_b32 s9, s5, 7
    s_lshl_b32 s8, s7, 2
    s_lshr_b32 s6, s5, 3
    s_add_u32 s8, s8, s6
    s_and_b32 s11, s10, 1
    s_lshr_b32 s12, s10, 1
    s_lshl_b32 s14, s11, 1
    s_add_u32 s14, s14, s3
    s_xor_b32 s15, s14, 1
    v_and_b32 v2, 31, v0
    v_lshrrev_b32 v3, 5, v0
    s_lshl_b32 s6, s14, 12
    s_lshl_b32 s7, s15, 12
    v_lshlrev_b32 v4, 4, v0
    v_add_u32 v8, s6, v4
    v_add_u32 v9, s7, v4
    s_mul_i32 s4, s12, 2048
    s_add_u32 s4, s4, 16384
    v_add_u32 v24, s4, v4
    v_mov_b32 v68, 0
    v_mov_b32 v69, 0
    v_mov_b32 v70, 0
    v_mov_b32 v71, 0
    v_mov_b32 v72, 0
    v_mov_b32 v73, 0
    v_mov_b32 v74, 0
    v_mov_b32 v75, 0
    v_mov_b32 v76, 0
    v_mov_b32 v77, 0
    v_mov_b32 v78, 0
    v_mov_b32 v79, 0
    v_mov_b32 v80, 0
    v_mov_b32 v81, 0
    v_mov_b32 v82, 0
    v_mov_b32 v83, 0
    v_mov_b32 v84, 0
    v_mov_b32 v85, 0
    v_mov_b32 v86, 0
    v_mov_b32 v87, 0
    v_mov_b32 v88, 0
    v_mov_b32 v89, 0
    v_mov_b32 v90, 0
    v_mov_b32 v91, 0
    v_mov_b32 v92, 0
    v_mov_b32 v93, 0
    v_mov_b32 v94, 0
    v_mov_b32 v95, 0
    v_mov_b32 v96, 0
    v_mov_b32 v97, 0
    v_mov_b32 v98, 0
    v_mov_b32 v99, 0
    v_mov_b32 v100, 0
    v_mov_b32 v101, 0
    v_mov_b32 v102, 0
    v_mov_b32 v103, 0
    v_mov_b32 v104, 0
    v_mov_b32 v105, 0
    v_mov_b32 v106, 0
    v_mov_b32 v107, 0
    v_mov_b32 v108, 0
    v_mov_b32 v109, 0
    v_mov_b32 v110, 0
    v_mov_b32 v111, 0
    v_mov_b32 v112, 0
    v_mov_b32 v113, 0
    v_mov_b32 v114, 0
    v_mov_b32 v115, 0
    v_mov_b32 v116, 0
    v_mov_b32 v117, 0
    v_mov_b32 v118, 0
    v_mov_b32 v119, 0
    v_mov_b32 v120, 0
    v_mov_b32 v121, 0
    v_mov_b32 v122, 0
    v_mov_b32 v123, 0
    v_mov_b32 v124, 0
    v_mov_b32 v125, 0
    v_mov_b32 v126, 0
    v_mov_b32 v127, 0
    v_mov_b32 v128, 0
    v_mov_b32 v129, 0
    v_mov_b32 v130, 0
    v_mov_b32 v131, 0
    s_waitcnt lgkmcnt(0)
    s_mov_b32 s13, 0
    s_mov_b32 s51, 27
    v_add_u32 v16, s13, v8
    v_add_u32 v17, s13, v9
    v_add_u32 v26, s13, v24
    s_add_u32 s13, s13, 32768
    s_cmp_eq_u32 s13, 163840
    s_cselect_b32 s13, 0, s13
    s_barrier
    ds_read_b128 v[36:39], v16 offset:0
    ds_read_b128 v[44:47], v26 offset:0
    ds_read_b128 v[40:43], v17 offset:0
    ds_read_b128 v[48:51], v26 offset:1024
    s_add_u32 s40, s36, 33554432
    s_addc_u32 s41, s37, 0
    s_mov_b32 s42, 4194304
    s_mov_b32 s43, 0x20000
    s_lshl_b32 s59, s9, 1
    s_add_u32 s59, s59, s12
    s_lshl_b32 s4, s8, 2
    s_add_u32 s58, s4, s14
    s_lshl_b32 s4, s58, 16
    s_lshl_b32 s5, s59, 7
    s_add_u32 s56, s4, s5
    s_lshl_b32 s6, s59, 12
    s_add_u32 s57, s4, s6
    v_lshlrev_b32 v164, 11, v2
    v_lshl_add_u32 v164, v3, 3, v164
    v_lshlrev_b32 v165, 4, v0
    buffer_load_dwordx4 v[132:135], v165, s[40:43], s57 offen offset:0 sc1
    buffer_load_dwordx4 v[136:139], v165, s[40:43], s57 offen offset:1024 sc1
    buffer_load_dwordx4 v[140:143], v165, s[40:43], s57 offen offset:2048 sc1
    buffer_load_dwordx4 v[144:147], v165, s[40:43], s57 offen offset:3072 sc1
    s_mov_b32 s44, s30
    s_mov_b32 s45, s31
    s_mov_b32 s46, 2048
    s_mov_b32 s47, 0x20000
    v_lshlrev_b32 v4, 3, v3
    buffer_load_dwordx2 v[148:149], v4, s[44:47], s5 offen offset:0
    buffer_load_dwordx2 v[150:151], v4, s[44:47], s5 offen offset:16
    buffer_load_dwordx2 v[152:153], v4, s[44:47], s5 offen offset:32
    buffer_load_dwordx2 v[154:155], v4, s[44:47], s5 offen offset:48
    buffer_load_dwordx2 v[156:157], v4, s[44:47], s5 offen offset:64
    buffer_load_dwordx2 v[158:159], v4, s[44:47], s5 offen offset:80
    buffer_load_dwordx2 v[160:161], v4, s[44:47], s5 offen offset:96
    buffer_load_dwordx2 v[162:163], v4, s[44:47], s5 offen offset:112
L_w2a_c_loop:
    s_waitcnt lgkmcnt(2)
    v_mfma_f32_32x32x16_bf16 v[68:83], v[44:47], v[36:39], v[68:83]
    ds_read_b128 v[52:55], v16 offset:1024
    ds_read_b128 v[60:63], v26 offset:4096
    s_waitcnt lgkmcnt(3)
    v_mfma_f32_32x32x16_bf16 v[84:99], v[44:47], v[40:43], v[84:99]
    ds_read_b128 v[56:59], v17 offset:1024
    ds_read_b128 v[64:67], v26 offset:5120
    s_waitcnt lgkmcnt(4)
    v_mfma_f32_32x32x16_bf16 v[100:115], v[48:51], v[36:39], v[100:115]
    v_mfma_f32_32x32x16_bf16 v[116:131], v[48:51], v[40:43], v[116:131]
    s_waitcnt lgkmcnt(2)
    v_mfma_f32_32x32x16_bf16 v[68:83], v[60:63], v[52:55], v[68:83]
    ds_read_b128 v[36:39], v16 offset:2048
    ds_read_b128 v[44:47], v26 offset:8192
    s_waitcnt lgkmcnt(3)
    v_mfma_f32_32x32x16_bf16 v[84:99], v[60:63], v[56:59], v[84:99]
    ds_read_b128 v[40:43], v17 offset:2048
    ds_read_b128 v[48:51], v26 offset:9216
    s_waitcnt lgkmcnt(4)
    v_mfma_f32_32x32x16_bf16 v[100:115], v[64:67], v[52:55], v[100:115]
    v_mfma_f32_32x32x16_bf16 v[116:131], v[64:67], v[56:59], v[116:131]
    s_waitcnt lgkmcnt(2)
    v_mfma_f32_32x32x16_bf16 v[68:83], v[44:47], v[36:39], v[68:83]
    ds_read_b128 v[52:55], v16 offset:3072
    ds_read_b128 v[60:63], v26 offset:12288
    s_waitcnt lgkmcnt(3)
    v_mfma_f32_32x32x16_bf16 v[84:99], v[44:47], v[40:43], v[84:99]
    ds_read_b128 v[56:59], v17 offset:3072
    ds_read_b128 v[64:67], v26 offset:13312
    s_waitcnt lgkmcnt(4)
    v_mfma_f32_32x32x16_bf16 v[100:115], v[48:51], v[36:39], v[100:115]
    v_mfma_f32_32x32x16_bf16 v[116:131], v[48:51], v[40:43], v[116:131]
    s_waitcnt lgkmcnt(0)
    v_add_u32 v16, s13, v8
    v_add_u32 v17, s13, v9
    v_add_u32 v26, s13, v24
    s_add_u32 s13, s13, 32768
    s_cmp_eq_u32 s13, 163840
    s_cselect_b32 s13, 0, s13
    s_barrier
    v_mfma_f32_32x32x16_bf16 v[68:83], v[60:63], v[52:55], v[68:83]
    ds_read_b128 v[36:39], v16 offset:0
    ds_read_b128 v[44:47], v26 offset:0
    v_mfma_f32_32x32x16_bf16 v[84:99], v[60:63], v[56:59], v[84:99]
    ds_read_b128 v[40:43], v17 offset:0
    ds_read_b128 v[48:51], v26 offset:1024
    v_mfma_f32_32x32x16_bf16 v[100:115], v[64:67], v[52:55], v[100:115]
    v_mfma_f32_32x32x16_bf16 v[116:131], v[64:67], v[56:59], v[116:131]
    s_sub_u32 s51, s51, 1
    s_cmp_lg_u32 s51, 0
    s_cbranch_scc1 L_w2a_c_loop
    s_waitcnt lgkmcnt(2)
    v_mfma_f32_32x32x16_bf16 v[68:83], v[44:47], v[36:39], v[68:83]
    ds_read_b128 v[52:55], v16 offset:1024
    ds_read_b128 v[60:63], v26 offset:4096
    s_waitcnt lgkmcnt(3)
    v_mfma_f32_32x32x16_bf16 v[84:99], v[44:47], v[40:43], v[84:99]
    ds_read_b128 v[56:59], v17 offset:1024
    ds_read_b128 v[64:67], v26 offset:5120
    s_waitcnt lgkmcnt(4)
    v_mfma_f32_32x32x16_bf16 v[100:115], v[48:51], v[36:39], v[100:115]
    v_mfma_f32_32x32x16_bf16 v[116:131], v[48:51], v[40:43], v[116:131]
    s_waitcnt lgkmcnt(2)
    v_mfma_f32_32x32x16_bf16 v[68:83], v[60:63], v[52:55], v[68:83]
    ds_read_b128 v[36:39], v16 offset:2048
    ds_read_b128 v[44:47], v26 offset:8192
    s_waitcnt lgkmcnt(3)
    v_mfma_f32_32x32x16_bf16 v[84:99], v[60:63], v[56:59], v[84:99]
    ds_read_b128 v[40:43], v17 offset:2048
    ds_read_b128 v[48:51], v26 offset:9216
    s_waitcnt lgkmcnt(4)
    v_mfma_f32_32x32x16_bf16 v[100:115], v[64:67], v[52:55], v[100:115]
    v_mfma_f32_32x32x16_bf16 v[116:131], v[64:67], v[56:59], v[116:131]
    s_waitcnt lgkmcnt(2)
    v_mfma_f32_32x32x16_bf16 v[68:83], v[44:47], v[36:39], v[68:83]
    ds_read_b128 v[52:55], v16 offset:3072
    ds_read_b128 v[60:63], v26 offset:12288
    s_waitcnt lgkmcnt(3)
    v_mfma_f32_32x32x16_bf16 v[84:99], v[44:47], v[40:43], v[84:99]
    ds_read_b128 v[56:59], v17 offset:3072
    ds_read_b128 v[64:67], v26 offset:13312
    s_waitcnt lgkmcnt(4)
    v_mfma_f32_32x32x16_bf16 v[100:115], v[48:51], v[36:39], v[100:115]
    v_mfma_f32_32x32x16_bf16 v[116:131], v[48:51], v[40:43], v[116:131]
    s_waitcnt lgkmcnt(2)
    v_mfma_f32_32x32x16_bf16 v[68:83], v[60:63], v[52:55], v[68:83]
    s_waitcnt lgkmcnt(1)
    v_mfma_f32_32x32x16_bf16 v[84:99], v[60:63], v[56:59], v[84:99]
    s_waitcnt lgkmcnt(0)
    v_mfma_f32_32x32x16_bf16 v[100:115], v[64:67], v[52:55], v[100:115]
    v_mfma_f32_32x32x16_bf16 v[116:131], v[64:67], v[56:59], v[116:131]
    s_waitcnt vmcnt(0)
    s_add_u32 s44, s36, 79691776
    s_addc_u32 s45, s37, 0
    s_mov_b32 s46, 8388608
    s_mov_b32 s47, 0x20000
    s_add_u32 s52, s36, 48234496
    s_addc_u32 s53, s37, 0
    s_mov_b32 s54, 1048576
    s_mov_b32 s55, 0x20000
    s_lshl_b32 s4, s8, 3
    s_add_u32 s4, s4, s9
    s_lshl_b32 s4, s4, 1
    s_add_u32 s4, s4, s3
    s_lshl_b32 s4, s4, 2
    s_add_u32 s4, s4, s10
    s_xor_b32 s5, s4, 4
    s_lshl_b32 s6, s5, 12
    v_cvt_pk_bf16_f32 v36, v84, v85
    v_cvt_pk_bf16_f32 v37, v86, v87
    v_cvt_pk_bf16_f32 v38, v88, v89
    v_cvt_pk_bf16_f32 v39, v90, v91
    v_cvt_pk_bf16_f32 v40, v92, v93
    v_cvt_pk_bf16_f32 v41, v94, v95
    v_cvt_pk_bf16_f32 v42, v96, v97
    v_cvt_pk_bf16_f32 v43, v98, v99
    buffer_store_dwordx4 v[36:39], v165, s[44:47], s6 offen offset:0 sc1
    buffer_store_dwordx4 v[40:43], v165, s[44:47], s6 offen offset:1024 sc1
    v_cvt_pk_bf16_f32 v44, v116, v117
    v_cvt_pk_bf16_f32 v45, v118, v119
    v_cvt_pk_bf16_f32 v46, v120, v121
    v_cvt_pk_bf16_f32 v47, v122, v123
    v_cvt_pk_bf16_f32 v48, v124, v125
    v_cvt_pk_bf16_f32 v49, v126, v127
    v_cvt_pk_bf16_f32 v50, v128, v129
    v_cvt_pk_bf16_f32 v51, v130, v131
    buffer_store_dwordx4 v[44:47], v165, s[44:47], s6 offen offset:2048 sc1
    buffer_store_dwordx4 v[48:51], v165, s[44:47], s6 offen offset:3072 sc1
    s_lshl_b32 s5, s5, 7
    s_add_u32 s5, s5, 0
    v_mov_b32 v4, 0
    v_mov_b32 v5, 1
    s_lshl_b32 s6, s4, 12
    s_lshl_b32 s4, s4, 7
    s_add_u32 s4, s4, 0
    v_lshlrev_b32 v6, 16, v132
    v_and_b32 v7, 0xffff0000, v132
    v_pk_add_f32 v[68:69], v[68:69], v[6:7]
    v_lshlrev_b32 v6, 16, v148
    v_and_b32 v7, 0xffff0000, v148
    v_pk_add_f32 v[68:69], v[68:69], v[6:7]
    v_lshlrev_b32 v6, 16, v133
    v_and_b32 v7, 0xffff0000, v133
    v_pk_add_f32 v[70:71], v[70:71], v[6:7]
    v_lshlrev_b32 v6, 16, v149
    v_and_b32 v7, 0xffff0000, v149
    v_pk_add_f32 v[70:71], v[70:71], v[6:7]
    v_lshlrev_b32 v6, 16, v134
    v_and_b32 v7, 0xffff0000, v134
    v_pk_add_f32 v[72:73], v[72:73], v[6:7]
    v_lshlrev_b32 v6, 16, v150
    v_and_b32 v7, 0xffff0000, v150
    v_pk_add_f32 v[72:73], v[72:73], v[6:7]
    v_lshlrev_b32 v6, 16, v135
    v_and_b32 v7, 0xffff0000, v135
    v_pk_add_f32 v[74:75], v[74:75], v[6:7]
    v_lshlrev_b32 v6, 16, v151
    v_and_b32 v7, 0xffff0000, v151
    v_pk_add_f32 v[74:75], v[74:75], v[6:7]
    v_lshlrev_b32 v6, 16, v136
    v_and_b32 v7, 0xffff0000, v136
    v_pk_add_f32 v[76:77], v[76:77], v[6:7]
    v_lshlrev_b32 v6, 16, v152
    v_and_b32 v7, 0xffff0000, v152
    v_pk_add_f32 v[76:77], v[76:77], v[6:7]
    v_lshlrev_b32 v6, 16, v137
    v_and_b32 v7, 0xffff0000, v137
    v_pk_add_f32 v[78:79], v[78:79], v[6:7]
    v_lshlrev_b32 v6, 16, v153
    v_and_b32 v7, 0xffff0000, v153
    v_pk_add_f32 v[78:79], v[78:79], v[6:7]
    v_lshlrev_b32 v6, 16, v138
    v_and_b32 v7, 0xffff0000, v138
    v_pk_add_f32 v[80:81], v[80:81], v[6:7]
    v_lshlrev_b32 v6, 16, v154
    v_and_b32 v7, 0xffff0000, v154
    v_pk_add_f32 v[80:81], v[80:81], v[6:7]
    v_lshlrev_b32 v6, 16, v139
    v_and_b32 v7, 0xffff0000, v139
    v_pk_add_f32 v[82:83], v[82:83], v[6:7]
    v_lshlrev_b32 v6, 16, v155
    v_and_b32 v7, 0xffff0000, v155
    v_pk_add_f32 v[82:83], v[82:83], v[6:7]
    v_lshlrev_b32 v6, 16, v140
    v_and_b32 v7, 0xffff0000, v140
    v_pk_add_f32 v[100:101], v[100:101], v[6:7]
    v_lshlrev_b32 v6, 16, v156
    v_and_b32 v7, 0xffff0000, v156
    v_pk_add_f32 v[100:101], v[100:101], v[6:7]
    v_lshlrev_b32 v6, 16, v141
    v_and_b32 v7, 0xffff0000, v141
    v_pk_add_f32 v[102:103], v[102:103], v[6:7]
    v_lshlrev_b32 v6, 16, v157
    v_and_b32 v7, 0xffff0000, v157
    v_pk_add_f32 v[102:103], v[102:103], v[6:7]
    v_lshlrev_b32 v6, 16, v142
    v_and_b32 v7, 0xffff0000, v142
    v_pk_add_f32 v[104:105], v[104:105], v[6:7]
    v_lshlrev_b32 v6, 16, v158
    v_and_b32 v7, 0xffff0000, v158
    v_pk_add_f32 v[104:105], v[104:105], v[6:7]
    v_lshlrev_b32 v6, 16, v143
    v_and_b32 v7, 0xffff0000, v143
    v_pk_add_f32 v[106:107], v[106:107], v[6:7]
    v_lshlrev_b32 v6, 16, v159
    v_and_b32 v7, 0xffff0000, v159
    v_pk_add_f32 v[106:107], v[106:107], v[6:7]
    v_lshlrev_b32 v6, 16, v144
    v_and_b32 v7, 0xffff0000, v144
    v_pk_add_f32 v[108:109], v[108:109], v[6:7]
    v_lshlrev_b32 v6, 16, v160
    v_and_b32 v7, 0xffff0000, v160
    v_pk_add_f32 v[108:109], v[108:109], v[6:7]
    v_lshlrev_b32 v6, 16, v145
    v_and_b32 v7, 0xffff0000, v145
    v_pk_add_f32 v[110:111], v[110:111], v[6:7]
    v_lshlrev_b32 v6, 16, v161
    v_and_b32 v7, 0xffff0000, v161
    v_pk_add_f32 v[110:111], v[110:111], v[6:7]
    v_lshlrev_b32 v6, 16, v146
    v_and_b32 v7, 0xffff0000, v146
    v_pk_add_f32 v[112:113], v[112:113], v[6:7]
    v_lshlrev_b32 v6, 16, v162
    v_and_b32 v7, 0xffff0000, v162
    v_pk_add_f32 v[112:113], v[112:113], v[6:7]
    v_lshlrev_b32 v6, 16, v147
    v_and_b32 v7, 0xffff0000, v147
    v_pk_add_f32 v[114:115], v[114:115], v[6:7]
    v_lshlrev_b32 v6, 16, v163
    v_and_b32 v7, 0xffff0000, v163
    v_pk_add_f32 v[114:115], v[114:115], v[6:7]
    s_waitcnt vmcnt(0)
    buffer_store_dword v5, v4, s[52:55], s5 offen sc1
    s_mov_b32 s60, 0x40000
L_w2a_poll:
    buffer_load_dword v5, v4, s[52:55], s4 offen sc1
    s_waitcnt vmcnt(0)
    v_readfirstlane_b32 s5, v5
    s_nop 0
    s_cmp_eq_u32 s5, 1
    s_cbranch_scc1 L_w2a_got
    s_sleep 1
    s_sub_u32 s60, s60, 1
    s_cmp_lg_u32 s60, 0
    s_cbranch_scc1 L_w2a_poll
L_w2a_got:
    buffer_load_dwordx4 v[36:39], v165, s[44:47], s6 offen offset:0 sc1
    buffer_load_dwordx4 v[40:43], v165, s[44:47], s6 offen offset:1024 sc1
    buffer_load_dwordx4 v[44:47], v165, s[44:47], s6 offen offset:2048 sc1
    buffer_load_dwordx4 v[48:51], v165, s[44:47], s6 offen offset:3072 sc1
    s_waitcnt vmcnt(3)
    v_lshlrev_b32 v6, 16, v36
    v_and_b32 v7, 0xffff0000, v36
    v_pk_add_f32 v[68:69], v[68:69], v[6:7]
    v_lshlrev_b32 v6, 16, v37
    v_and_b32 v7, 0xffff0000, v37
    v_pk_add_f32 v[70:71], v[70:71], v[6:7]
    v_lshlrev_b32 v6, 16, v38
    v_and_b32 v7, 0xffff0000, v38
    v_pk_add_f32 v[72:73], v[72:73], v[6:7]
    v_lshlrev_b32 v6, 16, v39
    v_and_b32 v7, 0xffff0000, v39
    v_pk_add_f32 v[74:75], v[74:75], v[6:7]
    s_waitcnt vmcnt(2)
    v_lshlrev_b32 v6, 16, v40
    v_and_b32 v7, 0xffff0000, v40
    v_pk_add_f32 v[76:77], v[76:77], v[6:7]
    v_lshlrev_b32 v6, 16, v41
    v_and_b32 v7, 0xffff0000, v41
    v_pk_add_f32 v[78:79], v[78:79], v[6:7]
    v_lshlrev_b32 v6, 16, v42
    v_and_b32 v7, 0xffff0000, v42
    v_pk_add_f32 v[80:81], v[80:81], v[6:7]
    v_lshlrev_b32 v6, 16, v43
    v_and_b32 v7, 0xffff0000, v43
    v_pk_add_f32 v[82:83], v[82:83], v[6:7]
    s_waitcnt vmcnt(1)
    v_lshlrev_b32 v6, 16, v44
    v_and_b32 v7, 0xffff0000, v44
    v_pk_add_f32 v[100:101], v[100:101], v[6:7]
    v_lshlrev_b32 v6, 16, v45
    v_and_b32 v7, 0xffff0000, v45
    v_pk_add_f32 v[102:103], v[102:103], v[6:7]
    v_lshlrev_b32 v6, 16, v46
    v_and_b32 v7, 0xffff0000, v46
    v_pk_add_f32 v[104:105], v[104:105], v[6:7]
    v_lshlrev_b32 v6, 16, v47
    v_and_b32 v7, 0xffff0000, v47
    v_pk_add_f32 v[106:107], v[106:107], v[6:7]
    s_waitcnt vmcnt(0)
    v_lshlrev_b32 v6, 16, v48
    v_and_b32 v7, 0xffff0000, v48
    v_pk_add_f32 v[108:109], v[108:109], v[6:7]
    v_lshlrev_b32 v6, 16, v49
    v_and_b32 v7, 0xffff0000, v49
    v_pk_add_f32 v[110:111], v[110:111], v[6:7]
    v_lshlrev_b32 v6, 16, v50
    v_and_b32 v7, 0xffff0000, v50
    v_pk_add_f32 v[112:113], v[112:113], v[6:7]
    v_lshlrev_b32 v6, 16, v51
    v_and_b32 v7, 0xffff0000, v51
    v_pk_add_f32 v[114:115], v[114:115], v[6:7]
    s_add_u32 s48, s36, 37748736
    s_addc_u32 s49, s37, 0
    s_mov_b32 s50, 4194304
    s_mov_b32 s51, 0x20000
    v_cvt_pk_bf16_f32 v36, v68, v69
    v_cvt_pk_bf16_f32 v37, v70, v71
    v_cvt_pk_bf16_f32 v38, v72, v73
    v_cvt_pk_bf16_f32 v39, v74, v75
    v_cvt_pk_bf16_f32 v40, v76, v77
    v_cvt_pk_bf16_f32 v41, v78, v79
    v_cvt_pk_bf16_f32 v42, v80, v81
    v_cvt_pk_bf16_f32 v43, v82, v83
    buffer_store_dwordx4 v[36:39], v165, s[48:51], s57 offen offset:0 sc1
    buffer_store_dwordx4 v[40:43], v165, s[48:51], s57 offen offset:1024 sc1
    v_cvt_pk_bf16_f32 v44, v100, v101
    v_cvt_pk_bf16_f32 v45, v102, v103
    v_cvt_pk_bf16_f32 v46, v104, v105
    v_cvt_pk_bf16_f32 v47, v106, v107
    v_cvt_pk_bf16_f32 v48, v108, v109
    v_cvt_pk_bf16_f32 v49, v110, v111
    v_cvt_pk_bf16_f32 v50, v112, v113
    v_cvt_pk_bf16_f32 v51, v114, v115
    buffer_store_dwordx4 v[44:47], v165, s[48:51], s57 offen offset:2048 sc1
    buffer_store_dwordx4 v[48:51], v165, s[48:51], s57 offen offset:3072 sc1
    v_pk_add_f32 v[132:133], v[68:69], v[100:101]
    v_pk_mul_f32 v[134:135], v[68:69], v[68:69]
    v_pk_fma_f32 v[134:135], v[100:101], v[100:101], v[134:135]
    v_pk_add_f32 v[132:133], v[132:133], v[70:71]
    v_pk_fma_f32 v[134:135], v[70:71], v[70:71], v[134:135]
    v_pk_add_f32 v[132:133], v[132:133], v[102:103]
    v_pk_fma_f32 v[134:135], v[102:103], v[102:103], v[134:135]
    v_pk_add_f32 v[132:133], v[132:133], v[72:73]
    v_pk_fma_f32 v[134:135], v[72:73], v[72:73], v[134:135]
    v_pk_add_f32 v[132:133], v[132:133], v[104:105]
    v_pk_fma_f32 v[134:135], v[104:105], v[104:105], v[134:135]
    v_pk_add_f32 v[132:133], v[132:133], v[74:75]
    v_pk_fma_f32 v[134:135], v[74:75], v[74:75], v[134:135]
    v_pk_add_f32 v[132:133], v[132:133], v[106:107]
    v_pk_fma_f32 v[134:135], v[106:107], v[106:107], v[134:135]
    v_pk_add_f32 v[132:133], v[132:133], v[76:77]
    v_pk_fma_f32 v[134:135], v[76:77], v[76:77], v[134:135]
    v_pk_add_f32 v[132:133], v[132:133], v[108:109]
    v_pk_fma_f32 v[134:135], v[108:109], v[108:109], v[134:135]
    v_pk_add_f32 v[132:133], v[132:133], v[78:79]
    v_pk_fma_f32 v[134:135], v[78:79], v[78:79], v[134:135]
    v_pk_add_f32 v[132:133], v[132:133], v[110:111]
    v_pk_fma_f32 v[134:135], v[110:111], v[110:111], v[134:135]
    v_pk_add_f32 v[132:133], v[132:133], v[80:81]
    v_pk_fma_f32 v[134:135], v[80:81], v[80:81], v[134:135]
    v_pk_add_f32 v[132:133], v[132:133], v[112:113]
    v_pk_fma_f32 v[134:135], v[112:113], v[112:113], v[134:135]
    v_pk_add_f32 v[132:133], v[132:133], v[82:83]
    v_pk_fma_f32 v[134:135], v[82:83], v[82:83], v[134:135]
    v_pk_add_f32 v[132:133], v[132:133], v[114:115]
    v_pk_fma_f32 v[134:135], v[114:115], v[114:115], v[134:135]
    s_add_u32 s40, s36, 47448064
    s_addc_u32 s41, s37, 0
    s_mov_b32 s42, 262144
    s_mov_b32 s43, 0x20000
    v_add_f32 v132, v132, v133
    v_add_f32 v133, v134, v135
    v_mov_b32 v134, v132
    v_mov_b32 v135, v133
    s_nop 0
    v_permlane32_swap_b32 v132, v134
    v_permlane32_swap_b32 v133, v135
    v_pk_add_f32 v[132:133], v[132:133], v[134:135]
    s_lshl_b32 s4, s59, 14
    s_lshl_b32 s5, s58, 8
    s_add_u32 s4, s4, s5
    v_lshlrev_b32 v4, 3, v2
    buffer_store_dwordx2 v[132:133], v4, s[40:43], s4 offen sc1
    s_add_u32 s52, s36, 48234496
    s_addc_u32 s53, s37, 0
    s_mov_b32 s54, 1048576
    s_mov_b32 s55, 0x20000
    s_lshl_b32 s4, s58, 11
    s_mov_b32 s5, s59
    v_and_b32 v4, 15, v0
    v_lshlrev_b32 v4, 7, v4
    s_lshl_b32 s5, s5, 2
    s_add_u32 s4, s4, s5
    s_add_u32 s4, s4, 393216
    v_mov_b32 v5, 1
    s_waitcnt vmcnt(0)
    s_mov_b64 exec, 0xffff
    buffer_store_dword v5, v4, s[52:55], s4 offen sc1
    s_mov_b64 exec, -1
    s_barrier
L_w2a_dend:
    s_and_b32 s4, s2, 7
    s_lshr_b32 s5, s2, 3
    s_and_b32 s6, s4, 3
    s_lshr_b32 s7, s4, 2
    s_mul_i32 s9, s6, 4
    s_and_b32 s6, s5, 3
    s_add_u32 s9, s9, s6
    s_mul_i32 s8, s7, 8
    s_lshr_b32 s6, s5, 2
    s_add_u32 s8, s8, s6
    s_and_b32 s11, s10, 1
    s_lshr_b32 s12, s10, 1
    s_lshl_b32 s14, s11, 1
    s_add_u32 s14, s14, s12
    s_xor_b32 s15, s14, 1
    v_and_b32 v2, 31, v0
    v_lshrrev_b32 v3, 5, v0
    s_lshl_b32 s6, s14, 12
    s_lshl_b32 s7, s15, 12
    v_lshlrev_b32 v4, 4, v0
    v_add_u32 v8, s6, v4
    v_add_u32 v9, s7, v4
    s_mul_i32 s4, s12, 1024
    s_add_u32 s4, s4, 16384
    v_add_u32 v24, s4, v4
    v_mov_b32 v76, 0
    v_mov_b32 v77, 0
    v_mov_b32 v78, 0
    v_mov_b32 v79, 0
    v_mov_b32 v80, 0
    v_mov_b32 v81, 0
    v_mov_b32 v82, 0
    v_mov_b32 v83, 0
    v_mov_b32 v84, 0
    v_mov_b32 v85, 0
    v_mov_b32 v86, 0
    v_mov_b32 v87, 0
    v_mov_b32 v88, 0
    v_mov_b32 v89, 0
    v_mov_b32 v90, 0
    v_mov_b32 v91, 0
    v_mov_b32 v92, 0
    v_mov_b32 v93, 0
    v_mov_b32 v94, 0
    v_mov_b32 v95, 0
    v_mov_b32 v96, 0
    v_mov_b32 v97, 0
    v_mov_b32 v98, 0
    v_mov_b32 v99, 0
    v_mov_b32 v100, 0
    v_mov_b32 v101, 0
    v_mov_b32 v102, 0
    v_mov_b32 v103, 0
    v_mov_b32 v104, 0
    v_mov_b32 v105, 0
    v_mov_b32 v106, 0
    v_mov_b32 v107, 0
    v_mov_b32 v108, 0
    v_mov_b32 v109, 0
    v_mov_b32 v110, 0
    v_mov_b32 v111, 0
    v_mov_b32 v112, 0
    v_mov_b32 v113, 0
    v_mov_b32 v114, 0
    v_mov_b32 v115, 0
    v_mov_b32 v116, 0
    v_mov_b32 v117, 0
    v_mov_b32 v118, 0
    v_mov_b32 v119, 0
    v_mov_b32 v120, 0
    v_mov_b32 v121, 0
    v_mov_b32 v122, 0
    v_mov_b32 v123, 0
    v_mov_b32 v124, 0
    v_mov_b32 v125, 0
    v_mov_b32 v126, 0
    v_mov_b32 v127, 0
    v_mov_b32 v128, 0
    v_mov_b32 v129, 0
    v_mov_b32 v130, 0
    v_mov_b32 v131, 0
    v_mov_b32 v132, 0
    v_mov_b32 v133, 0
    v_mov_b32 v134, 0
    v_mov_b32 v135, 0
    v_mov_b32 v136, 0
    v_mov_b32 v137, 0
    v_mov_b32 v138, 0
    v_mov_b32 v139, 0
    v_mov_b32 v140, 0
    v_mov_b32 v141, 0
    v_mov_b32 v142, 0
    v_mov_b32 v143, 0
    v_mov_b32 v144, 0
    v_mov_b32 v145, 0
    v_mov_b32 v146, 0
    v_mov_b32 v147, 0
    v_mov_b32 v148, 0
    v_mov_b32 v149, 0
    v_mov_b32 v150, 0
    v_mov_b32 v151, 0
    v_mov_b32 v152, 0
    v_mov_b32 v153, 0
    v_mov_b32 v154, 0
    v_mov_b32 v155, 0
    v_mov_b32 v156, 0
    v_mov_b32 v157, 0
    v_mov_b32 v158, 0
    v_mov_b32 v159, 0
    v_mov_b32 v160, 0
    v_mov_b32 v161, 0
    v_mov_b32 v162, 0
    v_mov_b32 v163, 0
    v_mov_b32 v164, 0
    v_mov_b32 v165, 0
    v_mov_b32 v166, 0
    v_mov_b32 v167, 0
    v_mov_b32 v168, 0
    v_mov_b32 v169, 0
    v_mov_b32 v170, 0
    v_mov_b32 v171, 0
    s_waitcnt lgkmcnt(0)
    s_add_u32 s4, s9, 0
    s_and_b32 s4, s4, 15
    s_lshl_b32 s4, s4, 1
    s_add_u32 s60, s4, s12
    s_lshl_b32 s4, s60, 7
    s_add_u32 s56, s4, 0
    s_add_u32 s4, s9, 0
    s_and_b32 s4, s4, 15
    s_lshl_b32 s4, s4, 1
    s_add_u32 s61, s4, s12
    s_lshl_b32 s4, s61, 7
    s_add_u32 s57, s4, 4096
    s_add_u32 s4, s9, 0
    s_and_b32 s4, s4, 15
    s_lshl_b32 s4, s4, 1
    s_add_u32 s62, s4, s12
    s_lshl_b32 s4, s62, 7
    s_add_u32 s58, s4, 8192
    s_add_u32 s44, s36, 46137344
    s_addc_u32 s45, s37, 0
    s_mov_b32 s46, 12288
    s_mov_b32 s47, 0x20000
    v_lshlrev_b32 v4, 2, v2
    buffer_load_dword v28, v4, s[44:47], s56 offen sc1
    buffer_load_dword v29, v4, s[44:47], s57 offen sc1
    buffer_load_dword v30, v4, s[44:47], s58 offen sc1
    s_mov_b32 s13, 0
    s_mov_b32 s51, 15
    v_add_u32 v16, s13, v8
    v_add_u32 v17, s13, v9
    v_add_u32 v26, s13, v24
    s_add_u32 s13, s13, 40960
    s_cmp_eq_u32 s13, 163840
    s_cselect_b32 s13, 0, s13
    s_barrier
    ds_read_b128 v[36:39], v16 offset:0
    ds_read_b128 v[44:47], v26 offset:0
    ds_read_b128 v[40:43], v17 offset:0
    ds_read_b128 v[48:51], v26 offset:2048
    ds_read_b128 v[52:55], v26 offset:4096
L_qkv2_c_loop:
    s_waitcnt lgkmcnt(3)
    v_mfma_f32_32x32x16_bf16 v[76:91], v[44:47], v[36:39], v[76:91]
    ds_read_b128 v[56:59], v16 offset:1024
    ds_read_b128 v[64:67], v26 offset:6144
    s_waitcnt lgkmcnt(4)
    v_mfma_f32_32x32x16_bf16 v[92:107], v[44:47], v[40:43], v[92:107]
    ds_read_b128 v[60:63], v17 offset:1024
    ds_read_b128 v[68:71], v26 offset:8192
    s_waitcnt lgkmcnt(5)
    v_mfma_f32_32x32x16_bf16 v[108:123], v[48:51], v[36:39], v[108:123]
    ds_read_b128 v[72:75], v26 offset:10240
    v_mfma_f32_32x32x16_bf16 v[124:139], v[48:51], v[40:43], v[124:139]
    s_waitcnt lgkmcnt(5)
    v_mfma_f32_32x32x16_bf16 v[140:155], v[36:39], v[52:55], v[140:155]
    v_mfma_f32_32x32x16_bf16 v[156:171], v[40:43], v[52:55], v[156:171]
    s_waitcnt lgkmcnt(3)
    v_mfma_f32_32x32x16_bf16 v[76:91], v[64:67], v[56:59], v[76:91]
    ds_read_b128 v[36:39], v16 offset:2048
    ds_read_b128 v[44:47], v26 offset:12288
    s_waitcnt lgkmcnt(4)
    v_mfma_f32_32x32x16_bf16 v[92:107], v[64:67], v[60:63], v[92:107]
    ds_read_b128 v[40:43], v17 offset:2048
    ds_read_b128 v[48:51], v26 offset:14336
    s_waitcnt lgkmcnt(5)
    v_mfma_f32_32x32x16_bf16 v[108:123], v[68:71], v[56:59], v[108:123]
    ds_read_b128 v[52:55], v26 offset:16384
    v_mfma_f32_32x32x16_bf16 v[124:139], v[68:71], v[60:63], v[124:139]
    s_waitcnt lgkmcnt(5)
    v_mfma_f32_32x32x16_bf16 v[140:155], v[56:59], v[72:75], v[140:155]
    v_mfma_f32_32x32x16_bf16 v[156:171], v[60:63], v[72:75], v[156:171]
    s_waitcnt lgkmcnt(3)
    v_mfma_f32_32x32x16_bf16 v[76:91], v[44:47], v[36:39], v[76:91]
    ds_read_b128 v[56:59], v16 offset:3072
    ds_read_b128 v[64:67], v26 offset:18432
    s_waitcnt lgkmcnt(4)
    v_mfma_f32_32x32x16_bf16 v[92:107], v[44:47], v[40:43], v[92:107]
    ds_read_b128 v[60:63], v17 offset:3072
    ds_read_b128 v[68:71], v26 offset:20480
    s_waitcnt lgkmcnt(5)
    v_mfma_f32_32x32x16_bf16 v[108:123], v[48:51], v[36:39], v[108:123]
    ds_read_b128 v[72:75], v26 offset:22528
    v_mfma_f32_32x32x16_bf16 v[124:139], v[48:51], v[40:43], v[124:139]
    s_waitcnt lgkmcnt(5)
    v_mfma_f32_32x32x16_bf16 v[140:155], v[36:39], v[52:55], v[140:155]
    v_mfma_f32_32x32x16_bf16 v[156:171], v[40:43], v[52:55], v[156:171]
    s_waitcnt lgkmcnt(0)
    v_add_u32 v16, s13, v8
    v_add_u32 v17, s13, v9
    v_add_u32 v26, s13, v24
    s_add_u32 s13, s13, 40960
    s_cmp_eq_u32 s13, 163840
    s_cselect_b32 s13, 0, s13
    s_barrier
    v_mfma_f32_32x32x16_bf16 v[76:91], v[64:67], v[56:59], v[76:91]
    ds_read_b128 v[36:39], v16 offset:0
    ds_read_b128 v[44:47], v26 offset:0
    v_mfma_f32_32x32x16_bf16 v[92:107], v[64:67], v[60:63], v[92:107]
    ds_read_b128 v[40:43], v17 offset:0
    ds_read_b128 v[48:51], v26 offset:2048
    v_mfma_f32_32x32x16_bf16 v[108:123], v[68:71], v[56:59], v[108:123]
    ds_read_b128 v[52:55], v26 offset:4096
    v_mfma_f32_32x32x16_bf16 v[124:139], v[68:71], v[60:63], v[124:139]
    v_mfma_f32_32x32x16_bf16 v[140:155], v[56:59], v[72:75], v[140:155]
    v_mfma_f32_32x32x16_bf16 v[156:171], v[60:63], v[72:75], v[156:171]
    s_sub_u32 s51, s51, 1
    s_cmp_lg_u32 s51, 0
    s_cbranch_scc1 L_qkv2_c_loop
    s_waitcnt lgkmcnt(3)
    v_mfma_f32_32x32x16_bf16 v[76:91], v[44:47], v[36:39], v[76:91]
    ds_read_b128 v[56:59], v16 offset:1024
    ds_read_b128 v[64:67], v26 offset:6144
    s_waitcnt lgkmcnt(4)
    v_mfma_f32_32x32x16_bf16 v[92:107], v[44:47], v[40:43], v[92:107]
    ds_read_b128 v[60:63], v17 offset:1024
    ds_read_b128 v[68:71], v26 offset:8192
    s_waitcnt lgkmcnt(5)
    v_mfma_f32_32x32x16_bf16 v[108:123], v[48:51], v[36:39], v[108:123]
    ds_read_b128 v[72:75], v26 offset:10240
    v_mfma_f32_32x32x16_bf16 v[124:139], v[48:51], v[40:43], v[124:139]
    s_waitcnt lgkmcnt(5)
    v_mfma_f32_32x32x16_bf16 v[140:155], v[36:39], v[52:55], v[140:155]
    v_mfma_f32_32x32x16_bf16 v[156:171], v[40:43], v[52:55], v[156:171]
    s_waitcnt lgkmcnt(3)
    v_mfma_f32_32x32x16_bf16 v[76:91], v[64:67], v[56:59], v[76:91]
    ds_read_b128 v[36:39], v16 offset:2048
    ds_read_b128 v[44:47], v26 offset:12288
    s_waitcnt lgkmcnt(4)
    v_mfma_f32_32x32x16_bf16 v[92:107], v[64:67], v[60:63], v[92:107]
    ds_read_b128 v[40:43], v17 offset:2048
    ds_read_b128 v[48:51], v26 offset:14336
    s_waitcnt lgkmcnt(5)
    v_mfma_f32_32x32x16_bf16 v[108:123], v[68:71], v[56:59], v[108:123]
    ds_read_b128 v[52:55], v26 offset:16384
    v_mfma_f32_32x32x16_bf16 v[124:139], v[68:71], v[60:63], v[124:139]
    s_waitcnt lgkmcnt(5)
    v_mfma_f32_32x32x16_bf16 v[140:155], v[56:59], v[72:75], v[140:155]
    v_mfma_f32_32x32x16_bf16 v[156:171], v[60:63], v[72:75], v[156:171]
    s_waitcnt lgkmcnt(3)
    v_mfma_f32_32x32x16_bf16 v[76:91], v[44:47], v[36:39], v[76:91]
    ds_read_b128 v[56:59], v16 offset:3072
    ds_read_b128 v[64:67], v26 offset:18432
    s_waitcnt lgkmcnt(4)
    v_mfma_f32_32x32x16_bf16 v[92:107], v[44:47], v[40:43], v[92:107]
    ds_read_b128 v[60:63], v17 offset:3072
    ds_read_b128 v[68:71], v26 offset:20480
    s_waitcnt lgkmcnt(5)
    v_mfma_f32_32x32x16_bf16 v[108:123], v[48:51], v[36:39], v[108:123]
    ds_read_b128 v[72:75], v26 offset:22528
    v_mfma_f32_32x32x16_bf16 v[124:139], v[48:51], v[40:43], v[124:139]
    s_waitcnt lgkmcnt(5)
    v_mfma_f32_32x32x16_bf16 v[140:155], v[36:39], v[52:55], v[140:155]
    v_mfma_f32_32x32x16_bf16 v[156:171], v[40:43], v[52:55], v[156:171]
    s_waitcnt lgkmcnt(3)
    v_mfma_f32_32x32x16_bf16 v[76:91], v[64:67], v[56:59], v[76:91]
    s_waitcnt lgkmcnt(2)
    v_mfma_f32_32x32x16_bf16 v[92:107], v[64:67], v[60:63], v[92:107]
    s_waitcnt lgkmcnt(1)
    v_mfma_f32_32x32x16_bf16 v[108:123], v[68:71], v[56:59], v[108:123]
    v_mfma_f32_32x32x16_bf16 v[124:139], v[68:71], v[60:63], v[124:139]
    s_waitcnt lgkmcnt(0)
    v_mfma_f32_32x32x16_bf16 v[140:155], v[56:59], v[72:75], v[140:155]
    v_mfma_f32_32x32x16_bf16 v[156:171], v[60:63], v[72:75], v[156:171]
    s_lshl_b32 s4, s10, 11
    s_add_u32 s4, s4, 99328
    v_lshlrev_b32 v4, 2, v2
    v_add_u32 v4, s4, v4
    v_lshlrev_b32 v5, 4, v3
    v_add_u32 v5, s4, v5
    s_waitcnt vmcnt(0)
    ds_write_b32 v4, v28 offset:0
    ds_write_b32 v4, v29 offset:128
    ds_write_b32 v4, v30 offset:256
    s_waitcnt lgkmcnt(0)
    s_barrier
    s_add_u32 s40, s36, 100663296
    s_addc_u32 s41, s37, 0
    s_mov_b32 s42, 12582912
    s_mov_b32 s43, 0x20000
    s_lshl_b32 s7, s14, 7
    s_add_u32 s7, s7, 98304
    s_lshl_b32 s5, s8, 2
    s_add_u32 s5, s5, s14
    s_lshl_b32 s4, s60, 6
    s_add_u32 s4, s4, s5
    s_lshl_b32 s14, s4, 11
    s_lshl_b32 s4, s61, 6
    s_add_u32 s4, s4, s5
    s_lshl_b32 s15, s4, 12
    s_add_u32 s15, s15, 4194304
    s_lshl_b32 s4, s62, 6
    s_add_u32 s4, s4, s5
    s_lshl_b32 s13, s4, 12
    s_add_u32 s13, s13, 4194304
    v_lshlrev_b32 v6, 4, v0
    v_lshlrev_b32 v10, 2, v2
    v_add_u32 v10, s7, v10
    v_xor_b32 v11, 128, v10
    v_lshlrev_b32 v8, 4, v3
    v_add_u32 v8, s7, v8
    v_xor_b32 v9, 128, v8
    ds_read_b128 v[172:175], v5 offset:0
    ds_read_b128 v[188:191], v5 offset:128
    ds_read_b128 v[176:179], v5 offset:32
    ds_read_b128 v[192:195], v5 offset:160
    ds_read_b128 v[180:183], v5 offset:64
    ds_read_b128 v[196:199], v5 offset:192
    ds_read_b128 v[184:187], v5 offset:96
    ds_read_b128 v[200:203], v5 offset:224
    ds_read_b32 v204, v10
    ds_read_b32 v205, v10 offset:512
    ds_read_b32 v206, v11
    ds_read_b32 v207, v11 offset:512
    s_waitcnt lgkmcnt(0)
    v_mul_f32 v208, 0x3e8293ee, v204
    v_mul_f32 v209, 0x3e8293ee, v205
    v_mul_f32 v210, 0x3e8293ee, v206
    v_mul_f32 v211, 0x3e8293ee, v207
    ds_read_b128 v[36:39], v8 offset:0
    ds_read_b128 v[52:55], v8 offset:512
    ds_read_b128 v[40:43], v8 offset:32
    ds_read_b128 v[56:59], v8 offset:544
    ds_read_b128 v[44:47], v8 offset:64
    ds_read_b128 v[60:63], v8 offset:576
    ds_read_b128 v[48:51], v8 offset:96
    ds_read_b128 v[64:67], v8 offset:608
    v_pk_mul_f32 v[212:213], v[172:173], v[208:209] op_sel:[0,1]
    v_pk_mul_f32 v[214:215], v[174:175], v[208:209] op_sel:[0,1]
    v_pk_mul_f32 v[216:217], v[176:177], v[208:209] op_sel:[0,1]
    v_pk_mul_f32 v[218:219], v[178:179], v[208:209] op_sel:[0,1]
    v_pk_mul_f32 v[220:221], v[180:181], v[208:209] op_sel:[0,1]
    v_pk_mul_f32 v[222:223], v[182:183], v[208:209] op_sel:[0,1]
    v_pk_mul_f32 v[224:225], v[184:185], v[208:209] op_sel:[0,1]
    v_pk_mul_f32 v[226:227], v[186:187], v[208:209] op_sel:[0,1]
    v_pk_fma_f32 v[212:213], v[76:77], v[208:209], v[212:213] op_sel_hi:[1,0,1]
    v_pk_fma_f32 v[214:215], v[78:79], v[208:209], v[214:215] op_sel_hi:[1,0,1]
    v_pk_fma_f32 v[216:217], v[80:81], v[208:209], v[216:217] op_sel_hi:[1,0,1]
    v_pk_fma_f32 v[218:219], v[82:83], v[208:209], v[218:219] op_sel_hi:[1,0,1]
    v_pk_fma_f32 v[220:221], v[84:85], v[208:209], v[220:221] op_sel_hi:[1,0,1]
    v_pk_fma_f32 v[222:223], v[86:87], v[208:209], v[222:223] op_sel_hi:[1,0,1]
    v_pk_fma_f32 v[224:225], v[88:89], v[208:209], v[224:225] op_sel_hi:[1,0,1]
    v_pk_fma_f32 v[226:227], v[90:91], v[208:209], v[226:227] op_sel_hi:[1,0,1]
    v_cvt_pk_bf16_f32 v76, v212, v213
    v_cvt_pk_bf16_f32 v77, v214, v215
    v_cvt_pk_bf16_f32 v78, v216, v217
    v_cvt_pk_bf16_f32 v79, v218, v219
    v_cvt_pk_bf16_f32 v80, v220, v221
    v_cvt_pk_bf16_f32 v81, v222, v223
    v_cvt_pk_bf16_f32 v82, v224, v225
    v_cvt_pk_bf16_f32 v83, v226, v227
    buffer_store_dwordx4 v[76:79], v6, s[40:43], s14 offen offset:0 sc1
    buffer_store_dwordx4 v[80:83], v6, s[40:43], s14 offen offset:1024 sc1
    v_pk_mul_f32 v[212:213], v[188:189], v[204:205] op_sel:[0,1]
    v_pk_mul_f32 v[214:215], v[190:191], v[204:205] op_sel:[0,1]
    v_pk_mul_f32 v[216:217], v[192:193], v[204:205] op_sel:[0,1]
    v_pk_mul_f32 v[218:219], v[194:195], v[204:205] op_sel:[0,1]
    v_pk_mul_f32 v[220:221], v[196:197], v[204:205] op_sel:[0,1]
    v_pk_mul_f32 v[222:223], v[198:199], v[204:205] op_sel:[0,1]
    v_pk_mul_f32 v[224:225], v[200:201], v[204:205] op_sel:[0,1]
    v_pk_mul_f32 v[226:227], v[202:203], v[204:205] op_sel:[0,1]
    v_pk_fma_f32 v[212:213], v[108:109], v[204:205], v[212:213] op_sel_hi:[1,0,1]
    v_pk_fma_f32 v[214:215], v[110:111], v[204:205], v[214:215] op_sel_hi:[1,0,1]
    v_pk_fma_f32 v[216:217], v[112:113], v[204:205], v[216:217] op_sel_hi:[1,0,1]
    v_pk_fma_f32 v[218:219], v[114:115], v[204:205], v[218:219] op_sel_hi:[1,0,1]
    v_pk_fma_f32 v[220:221], v[116:117], v[204:205], v[220:221] op_sel_hi:[1,0,1]
    v_pk_fma_f32 v[222:223], v[118:119], v[204:205], v[222:223] op_sel_hi:[1,0,1]
    v_pk_fma_f32 v[224:225], v[120:121], v[204:205], v[224:225] op_sel_hi:[1,0,1]
    v_pk_fma_f32 v[226:227], v[122:123], v[204:205], v[226:227] op_sel_hi:[1,0,1]
    v_cvt_pk_bf16_f32 v108, v212, v213
    v_cvt_pk_bf16_f32 v109, v214, v215
    v_cvt_pk_bf16_f32 v110, v216, v217
    v_cvt_pk_bf16_f32 v111, v218, v219
    v_cvt_pk_bf16_f32 v112, v220, v221
    v_cvt_pk_bf16_f32 v113, v222, v223
    v_cvt_pk_bf16_f32 v114, v224, v225
    v_cvt_pk_bf16_f32 v115, v226, v227
    buffer_store_dwordx4 v[108:111], v6, s[40:43], s15 offen offset:0 sc1
    buffer_store_dwordx4 v[112:115], v6, s[40:43], s15 offen offset:1024 sc1
    s_waitcnt lgkmcnt(0)
    v_pk_mul_f32 v[212:213], v[52:53], v[30:31] op_sel_hi:[1,0]
    v_pk_mul_f32 v[214:215], v[54:55], v[30:31] op_sel_hi:[1,0]
    v_pk_mul_f32 v[216:217], v[56:57], v[30:31] op_sel_hi:[1,0]
    v_pk_mul_f32 v[218:219], v[58:59], v[30:31] op_sel_hi:[1,0]
    v_pk_mul_f32 v[220:221], v[60:61], v[30:31] op_sel_hi:[1,0]
    v_pk_mul_f32 v[222:223], v[62:63], v[30:31] op_sel_hi:[1,0]
    v_pk_mul_f32 v[224:225], v[64:65], v[30:31] op_sel_hi:[1,0]
    v_pk_mul_f32 v[226:227], v[66:67], v[30:31] op_sel_hi:[1,0]
    v_pk_fma_f32 v[212:213], v[140:141], v[36:37], v[212:213]
    v_pk_fma_f32 v[214:215], v[142:143], v[38:39], v[214:215]
    v_pk_fma_f32 v[216:217], v[144:145], v[40:41], v[216:217]
    v_pk_fma_f32 v[218:219], v[146:147], v[42:43], v[218:219]
    v_pk_fma_f32 v[220:221], v[148:149], v[44:45], v[220:221]
    v_pk_fma_f32 v[222:223], v[150:151], v[46:47], v[222:223]
    v_pk_fma_f32 v[224:225], v[152:153], v[48:49], v[224:225]
    v_pk_fma_f32 v[226:227], v[154:155], v[50:51], v[226:227]
    v_cvt_pk_bf16_f32 v140, v212, v213
    v_cvt_pk_bf16_f32 v141, v214, v215
    v_cvt_pk_bf16_f32 v142, v216, v217
    v_cvt_pk_bf16_f32 v143, v218, v219
    v_cvt_pk_bf16_f32 v144, v220, v221
    v_cvt_pk_bf16_f32 v145, v222, v223
    v_cvt_pk_bf16_f32 v146, v224, v225
    v_cvt_pk_bf16_f32 v147, v226, v227
    buffer_store_dwordx4 v[140:143], v6, s[40:43], s13 offen offset:2048 sc1
    buffer_store_dwordx4 v[144:147], v6, s[40:43], s13 offen offset:3072 sc1
    s_xor_b32 s15, s15, 4096
    s_xor_b32 s13, s13, 4096
    s_xor_b32 s14, s14, 2048
    ds_read_b128 v[36:39], v9 offset:0
    ds_read_b128 v[52:55], v9 offset:512
    ds_read_b128 v[40:43], v9 offset:32
    ds_read_b128 v[56:59], v9 offset:544
    ds_read_b128 v[44:47], v9 offset:64
    ds_read_b128 v[60:63], v9 offset:576
    ds_read_b128 v[48:51], v9 offset:96
    ds_read_b128 v[64:67], v9 offset:608
    v_pk_mul_f32 v[212:213], v[172:173], v[210:211] op_sel:[0,1]
    v_pk_mul_f32 v[214:215], v[174:175], v[210:211] op_sel:[0,1]
    v_pk_mul_f32 v[216:217], v[176:177], v[210:211] op_sel:[0,1]
    v_pk_mul_f32 v[218:219], v[178:179], v[210:211] op_sel:[0,1]
    v_pk_mul_f32 v[220:221], v[180:181], v[210:211] op_sel:[0,1]
    v_pk_mul_f32 v[222:223], v[182:183], v[210:211] op_sel:[0,1]
    v_pk_mul_f32 v[224:225], v[184:185], v[210:211] op_sel:[0,1]
    v_pk_mul_f32 v[226:227], v[186:187], v[210:211] op_sel:[0,1]
    v_pk_fma_f32 v[212:213], v[92:93], v[210:211], v[212:213] op_sel_hi:[1,0,1]
    v_pk_fma_f32 v[214:215], v[94:95], v[210:211], v[214:215] op_sel_hi:[1,0,1]
    v_pk_fma_f32 v[216:217], v[96:97], v[210:211], v[216:217] op_sel_hi:[1,0,1]
    v_pk_fma_f32 v[218:219], v[98:99], v[210:211], v[218:219] op_sel_hi:[1,0,1]
    v_pk_fma_f32 v[220:221], v[100:101], v[210:211], v[220:221] op_sel_hi:[1,0,1]
    v_pk_fma_f32 v[222:223], v[102:103], v[210:211], v[222:223] op_sel_hi:[1,0,1]
    v_pk_fma_f32 v[224:225], v[104:105], v[210:211], v[224:225] op_sel_hi:[1,0,1]
    v_pk_fma_f32 v[226:227], v[106:107], v[210:211], v[226:227] op_sel_hi:[1,0,1]
    v_cvt_pk_bf16_f32 v92, v212, v213
    v_cvt_pk_bf16_f32 v93, v214, v215
    v_cvt_pk_bf16_f32 v94, v216, v217
    v_cvt_pk_bf16_f32 v95, v218, v219
    v_cvt_pk_bf16_f32 v96, v220, v221
    v_cvt_pk_bf16_f32 v97, v222, v223
    v_cvt_pk_bf16_f32 v98, v224, v225
    v_cvt_pk_bf16_f32 v99, v226, v227
    buffer_store_dwordx4 v[92:95], v6, s[40:43], s14 offen offset:0 sc1
    buffer_store_dwordx4 v[96:99], v6, s[40:43], s14 offen offset:1024 sc1
    v_pk_mul_f32 v[212:213], v[188:189], v[206:207] op_sel:[0,1]
    v_pk_mul_f32 v[214:215], v[190:191], v[206:207] op_sel:[0,1]
    v_pk_mul_f32 v[216:217], v[192:193], v[206:207] op_sel:[0,1]
    v_pk_mul_f32 v[218:219], v[194:195], v[206:207] op_sel:[0,1]
    v_pk_mul_f32 v[220:221], v[196:197], v[206:207] op_sel:[0,1]
    v_pk_mul_f32 v[222:223], v[198:199], v[206:207] op_sel:[0,1]
    v_pk_mul_f32 v[224:225], v[200:201], v[206:207] op_sel:[0,1]
    v_pk_mul_f32 v[226:227], v[202:203], v[206:207] op_sel:[0,1]
    v_pk_fma_f32 v[212:213], v[124:125], v[206:207], v[212:213] op_sel_hi:[1,0,1]
    v_pk_fma_f32 v[214:215], v[126:127], v[206:207], v[214:215] op_sel_hi:[1,0,1]
    v_pk_fma_f32 v[216:217], v[128:129], v[206:207], v[216:217] op_sel_hi:[1,0,1]
    v_pk_fma_f32 v[218:219], v[130:131], v[206:207], v[218:219] op_sel_hi:[1,0,1]
    v_pk_fma_f32 v[220:221], v[132:133], v[206:207], v[220:221] op_sel_hi:[1,0,1]
    v_pk_fma_f32 v[222:223], v[134:135], v[206:207], v[222:223] op_sel_hi:[1,0,1]
    v_pk_fma_f32 v[224:225], v[136:137], v[206:207], v[224:225] op_sel_hi:[1,0,1]
    v_pk_fma_f32 v[226:227], v[138:139], v[206:207], v[226:227] op_sel_hi:[1,0,1]
    v_cvt_pk_bf16_f32 v124, v212, v213
    v_cvt_pk_bf16_f32 v125, v214, v215
    v_cvt_pk_bf16_f32 v126, v216, v217
    v_cvt_pk_bf16_f32 v127, v218, v219
    v_cvt_pk_bf16_f32 v128, v220, v221
    v_cvt_pk_bf16_f32 v129, v222, v223
    v_cvt_pk_bf16_f32 v130, v224, v225
    v_cvt_pk_bf16_f32 v131, v226, v227
    buffer_store_dwordx4 v[124:127], v6, s[40:43], s15 offen offset:0 sc1
    buffer_store_dwordx4 v[128:131], v6, s[40:43], s15 offen offset:1024 sc1
    s_waitcnt lgkmcnt(0)
    v_pk_mul_f32 v[212:213], v[52:53], v[30:31] op_sel_hi:[1,0]
    v_pk_mul_f32 v[214:215], v[54:55], v[30:31] op_sel_hi:[1,0]
    v_pk_mul_f32 v[216:217], v[56:57], v[30:31] op_sel_hi:[1,0]
    v_pk_mul_f32 v[218:219], v[58:59], v[30:31] op_sel_hi:[1,0]
    v_pk_mul_f32 v[220:221], v[60:61], v[30:31] op_sel_hi:[1,0]
    v_pk_mul_f32 v[222:223], v[62:63], v[30:31] op_sel_hi:[1,0]
    v_pk_mul_f32 v[224:225], v[64:65], v[30:31] op_sel_hi:[1,0]
    v_pk_mul_f32 v[226:227], v[66:67], v[30:31] op_sel_hi:[1,0]
    v_pk_fma_f32 v[212:213], v[156:157], v[36:37], v[212:213]
    v_pk_fma_f32 v[214:215], v[158:159], v[38:39], v[214:215]
    v_pk_fma_f32 v[216:217], v[160:161], v[40:41], v[216:217]
    v_pk_fma_f32 v[218:219], v[162:163], v[42:43], v[218:219]
    v_pk_fma_f32 v[220:221], v[164:165], v[44:45], v[220:221]
    v_pk_fma_f32 v[222:223], v[166:167], v[46:47], v[222:223]
    v_pk_fma_f32 v[224:225], v[168:169], v[48:49], v[224:225]
    v_pk_fma_f32 v[226:227], v[170:171], v[50:51], v[226:227]
    v_cvt_pk_bf16_f32 v156, v212, v213
    v_cvt_pk_bf16_f32 v157, v214, v215
    v_cvt_pk_bf16_f32 v158, v216, v217
    v_cvt_pk_bf16_f32 v159, v218, v219
    v_cvt_pk_bf16_f32 v160, v220, v221
    v_cvt_pk_bf16_f32 v161, v222, v223
    v_cvt_pk_bf16_f32 v162, v224, v225
    v_cvt_pk_bf16_f32 v163, v226, v227
    buffer_store_dwordx4 v[156:159], v6, s[40:43], s13 offen offset:2048 sc1
    buffer_store_dwordx4 v[160:163], v6, s[40:43], s13 offen offset:3072 sc1
    s_add_u32 s52, s36, 48234496
    s_addc_u32 s53, s37, 0
    s_mov_b32 s54, 1048576
    s_mov_b32 s55, 0x20000
    s_lshl_b32 s4, s60, 10
    s_lshl_b32 s5, s8, 1
    s_add_u32 s5, s5, s11
    v_and_b32 v4, 7, v0
    v_lshlrev_b32 v4, 7, v4
    s_lshl_b32 s5, s5, 2
    s_add_u32 s4, s4, s5
    s_add_u32 s4, s4, 655360
    v_mov_b32 v5, 1
    s_waitcnt vmcnt(0)
    s_mov_b64 exec, 0xff
    buffer_store_dword v5, v4, s[52:55], s4 offen sc1
    s_mov_b64 exec, -1
    s_barrier
L_qkv2_dend:
L_rest_kernel_j1:
    s_mov_b32 s8, s94
    s_setprio 0
    s_and_b32 s4, s2, 7
    s_lshr_b32 s5, s2, 3
    s_lshr_b32 s6, s5, 3
    s_lshl_b32 s9, s4, 2
    s_add_u32 s9, s9, s6
    s_and_b32 s5, s5, 7
    s_waitcnt lgkmcnt(0)
    s_lshl_b32 s10, s5, 3
    s_and_b32 s4, s8, 3
    s_lshl_b32 s4, s4, 1
    s_add_u32 s10, s10, s4
    s_lshr_b32 s15, s8, 2
    s_add_u32 s44, s36, 104857600
    s_addc_u32 s45, s37, 0
    s_mov_b32 s46, 8388608
    s_mov_b32 s47, 0x20000
    s_add_u32 s46, s9, 1
    s_lshl_b32 s46, s46, 18
    v_lshlrev_b32 v2, 4, v0
    s_lshl_b32 s11, s9, 18
    s_lshl_b32 s5, s8, 12
    s_add_u32 s11, s11, s5
    s_mov_b32 s12, s5
    s_add_u32 s6, s5, 98304
    s_cmp_lg_u32 s8, 0
    s_cbranch_scc1 L_at6_w_got
    s_add_u32 s56, s36, 48234496
    s_addc_u32 s57, s37, 0
    s_mov_b32 s58, 1048576
    s_mov_b32 s59, 0x20000
    s_lshl_b32 s4, s9, 3
    s_lshr_b32 s7, s10, 3
    s_add_u32 s4, s4, s7
    s_lshl_b32 s4, s4, 7
    s_add_u32 s4, s4, 655360
    v_and_b32 v5, 31, v0
    v_lshlrev_b32 v5, 2, v5
    s_mov_b32 s60, 0x40000
L_at6_w_poll:
    buffer_load_dword v6, v5, s[56:59], s4 offen sc1
    s_waitcnt vmcnt(0)
    v_cmp_ne_u32 vcc, 1, v6
    s_nop 4
    s_cbranch_vccz L_at6_w_got
    s_sleep 4
    s_sub_u32 s60, s60, 1
    s_cmp_lg_u32 s60, 0
    s_cbranch_scc1 L_at6_w_poll
L_at6_w_got:
    s_barrier
    s_mov_b32 m0, s12
    s_nop 0
    buffer_load_dwordx4 v2, s[44:47], s11 offen offset:0 sc1 lds
    buffer_load_dwordx4 v2, s[44:47], s11 offen offset:1024 sc1 lds
    buffer_load_dwordx4 v2, s[44:47], s11 offen offset:2048 sc1 lds
    buffer_load_dwordx4 v2, s[44:47], s11 offen offset:3072 sc1 lds
    s_add_u32 s11, s11, 32768
    s_add_u32 s12, s12, 32768
    s_cmp_eq_u32 s12, s6
    s_cselect_b32 s12, s5, s12
    s_add_u32 s40, s36, 100663296
    s_addc_u32 s41, s37, 0
    s_mov_b32 s42, 4194304
    s_mov_b32 s43, 0x20000
    s_lshl_b32 s4, s9, 6
    s_add_u32 s4, s4, s10
    s_lshl_b32 s4, s4, 11
    buffer_load_dwordx4 v[8:11], v2, s[40:43], s4 offen sc1
    buffer_load_dwordx4 v[12:15], v2, s[40:43], s4 offen offset:1024 sc1
    buffer_load_dwordx4 v[16:19], v2, s[40:43], s4 offen offset:2048 sc1
    buffer_load_dwordx4 v[20:23], v2, s[40:43], s4 offen offset:3072 sc1
    s_mov_b32 m0, s12
    s_nop 0
    buffer_load_dwordx4 v2, s[44:47], s11 offen offset:0 sc1 lds
    buffer_load_dwordx4 v2, s[44:47], s11 offen offset:1024 sc1 lds
    buffer_load_dwordx4 v2, s[44:47], s11 offen offset:2048 sc1 lds
    buffer_load_dwordx4 v2, s[44:47], s11 offen offset:3072 sc1 lds
    s_add_u32 s11, s11, 32768
    s_add_u32 s12, s12, 32768
    s_cmp_eq_u32 s12, s6
    s_cselect_b32 s12, s5, s12
    v_lshrrev_b32 v5, 2, v0
    v_lshrrev_b32 v6, 4, v0
    v_xor_b32 v5, v5, v6
    v_and_b32 v5, 1, v5
    v_cmp_eq_u32 vcc, 0, v5
    v_mov_b32 v6, 0x3f803f80
    s_nop 0
    v_cndmask_b32 v40, 0, v6, vcc
    v_mov_b32 v41, v40
    v_mov_b32 v42, v40
    v_mov_b32 v43, v40
    s_lshl_b32 s4, s15, 14
    v_add_u32 v63, s4, v2
    v_mov_b32 v3, v63
    v_add_u32 v4, 32768, v63
    s_mov_b32 s14, 65536
    s_mov_b32 s13, 0
    v_mov_b32 v44, 0
    v_mov_b32 v45, 0
    v_mov_b32 v46, 0
    v_mov_b32 v47, 0
    v_mov_b32 v128, 0
    v_mov_b32 v129, 0
    v_mov_b32 v130, 0
    v_mov_b32 v131, 0
    v_mov_b32 v132, 0
    v_mov_b32 v133, 0
    v_mov_b32 v134, 0
    v_mov_b32 v135, 0
    v_mov_b32 v136, 0
    v_mov_b32 v137, 0
    v_mov_b32 v138, 0
    v_mov_b32 v139, 0
    v_mov_b32 v140, 0
    v_mov_b32 v141, 0
    v_mov_b32 v142, 0
    v_mov_b32 v143, 0
    v_mov_b32 v48, 0
    v_mov_b32 v49, 0
    v_mov_b32 v50, 0
    v_mov_b32 v51, 0
    v_mov_b32 v144, 0
    v_mov_b32 v145, 0
    v_mov_b32 v146, 0
    v_mov_b32 v147, 0
    v_mov_b32 v148, 0
    v_mov_b32 v149, 0
    v_mov_b32 v150, 0
    v_mov_b32 v151, 0
    v_mov_b32 v152, 0
    v_mov_b32 v153, 0
    v_mov_b32 v154, 0
    v_mov_b32 v155, 0
    v_mov_b32 v156, 0
    v_mov_b32 v157, 0
    v_mov_b32 v158, 0
    v_mov_b32 v159, 0
    v_mov_b32 v36, 0
    v_mov_b32 v56, 0
    v_mov_b32 v37, 0
    v_mov_b32 v57, 0
    v_mov_b32 v38, 0
    v_mov_b32 v58, 0
    v_mov_b32 v39, 0
    v_mov_b32 v59, 0
    s_waitcnt vmcnt(4)
    s_barrier
    ds_read_b128 v[24:27], v2 offset:0
    ds_read_b128 v[28:31], v2 offset:1024
    s_waitcnt lgkmcnt(0)
    v_mfma_f32_32x32x16_bf16 v[96:111], v[24:27], v[8:11], 0
    v_mfma_f32_32x32x16_bf16 v[96:111], v[28:31], v[12:15], v[96:111]
    v_mfma_f32_32x32x16_bf16 v[112:127], v[24:27], v[16:19], 0
    v_mfma_f32_32x32x16_bf16 v[112:127], v[28:31], v[20:23], v[112:127]
    ds_read_b128 v[24:27], v3 offset:0
    ds_read_b128 v[28:31], v3 offset:1024
    ds_read_b128 v[32:35], v3 offset:2048
    s_nop 6
    v_max3_f32 v5, v96, v97, v98
    v_max3_f32 v5, v5, v99, v100
    v_max3_f32 v5, v5, v101, v102
    v_max3_f32 v5, v5, v103, v104
    v_max3_f32 v5, v5, v105, v106
    v_max3_f32 v5, v5, v107, v108
    v_max3_f32 v5, v5, v109, v110
    v_max_f32 v5, v5, v111
    v_mov_b32 v6, v5
    s_nop 1
    v_permlane32_swap_b32 v5, v6
    v_max_f32 v5, v5, v6
    v_sub_f32 v64, 0, v5
    v_sub_f32 v65, 0, v5
    v_sub_f32 v66, 0, v5
    v_sub_f32 v67, 0, v5
    v_sub_f32 v68, 0, v5
    v_sub_f32 v69, 0, v5
    v_sub_f32 v70, 0, v5
    v_sub_f32 v71, 0, v5
    v_sub_f32 v72, 0, v5
    v_sub_f32 v73, 0, v5
    v_sub_f32 v74, 0, v5
    v_sub_f32 v75, 0, v5
    v_sub_f32 v76, 0, v5
    v_sub_f32 v77, 0, v5
    v_sub_f32 v78, 0, v5
    v_sub_f32 v79, 0, v5
    v_max3_f32 v5, v112, v113, v114
    v_max3_f32 v5, v5, v115, v116
    v_max3_f32 v5, v5, v117, v118
    v_max3_f32 v5, v5, v119, v120
    v_max3_f32 v5, v5, v121, v122
    v_max3_f32 v5, v5, v123, v124
    v_max3_f32 v5, v5, v125, v126
    v_max_f32 v5, v5, v127
    v_mov_b32 v6, v5
    s_nop 1
    v_permlane32_swap_b32 v5, v6
    v_max_f32 v5, v5, v6
    v_sub_f32 v80, 0, v5
    v_sub_f32 v81, 0, v5
    v_sub_f32 v82, 0, v5
    v_sub_f32 v83, 0, v5
    v_sub_f32 v84, 0, v5
    v_sub_f32 v85, 0, v5
    v_sub_f32 v86, 0, v5
    v_sub_f32 v87, 0, v5
    v_sub_f32 v88, 0, v5
    v_sub_f32 v89, 0, v5
    v_sub_f32 v90, 0, v5
    v_sub_f32 v91, 0, v5
    v_sub_f32 v92, 0, v5
    v_sub_f32 v93, 0, v5
    v_sub_f32 v94, 0, v5
    v_sub_f32 v95, 0, v5
    s_waitcnt lgkmcnt(1)
    v_mfma_f32_32x32x16_bf16 v[96:111], v[24:27], v[8:11], v[64:79]
    v_mfma_f32_32x32x16_bf16 v[96:111], v[28:31], v[12:15], v[96:111]
    s_nop 11
    v_exp_f32 v160, v96
    v_exp_f32 v161, v97
L_at6_loop:
    v_mfma_f32_32x32x16_bf16 v[144:159], v[36:39], v[56:59], v[144:159]
    ds_read_b128 v[36:39], v3 offset:3072
    v_exp_f32 v162, v98
    v_exp_f32 v163, v99
    v_exp_f32 v164, v100
    v_mfma_f32_16x16x32_bf16 v[48:51], v[40:43], v[56:59], v[48:51]
    v_exp_f32 v165, v101
    v_cvt_pk_bf16_f32 v52, v160, v161
    v_cvt_pk_bf16_f32 v53, v162, v163
    v_mfma_f32_32x32x16_bf16 v[112:127], v[24:27], v[16:19], v[80:95]
    v_exp_f32 v166, v102
    v_exp_f32 v167, v103
    v_exp_f32 v168, v104
    v_cvt_pk_bf16_f32 v54, v164, v165
    v_mfma_f32_32x32x16_bf16 v[112:127], v[28:31], v[20:23], v[112:127]
    ds_read_b128 v[24:27], v3 offset:4096
    ds_read_b128 v[28:31], v3 offset:5120
    v_cvt_pk_bf16_f32 v55, v166, v167
    v_exp_f32 v169, v105
    v_exp_f32 v170, v106
    v_exp_f32 v171, v107
    s_waitcnt lgkmcnt(3)
    v_mfma_f32_32x32x16_bf16 v[128:143], v[32:35], v[52:55], v[128:143]
    v_exp_f32 v172, v108
    v_exp_f32 v173, v109
    v_exp_f32 v174, v110
    v_cvt_pk_bf16_f32 v56, v168, v169
    v_mfma_f32_16x16x32_bf16 v[44:47], v[40:43], v[52:55], v[44:47]
    v_exp_f32 v175, v111
    v_cvt_pk_bf16_f32 v57, v170, v171
    v_cvt_pk_bf16_f32 v58, v172, v173
    v_cvt_pk_bf16_f32 v59, v174, v175
    v_exp_f32 v160, v112
    v_exp_f32 v161, v113
    s_waitcnt lgkmcnt(2)
    v_mfma_f32_32x32x16_bf16 v[128:143], v[36:39], v[56:59], v[128:143]
    v_exp_f32 v162, v114
    v_exp_f32 v163, v115
    v_exp_f32 v164, v116
    v_mfma_f32_16x16x32_bf16 v[44:47], v[40:43], v[56:59], v[44:47]
    v_exp_f32 v165, v117
    v_cvt_pk_bf16_f32 v52, v160, v161
    v_cvt_pk_bf16_f32 v53, v162, v163
    s_waitcnt lgkmcnt(0)
    v_mfma_f32_32x32x16_bf16 v[96:111], v[24:27], v[8:11], v[64:79]
    v_exp_f32 v166, v118
    v_exp_f32 v167, v119
    v_exp_f32 v168, v120
    v_cvt_pk_bf16_f32 v54, v164, v165
    v_mfma_f32_32x32x16_bf16 v[96:111], v[28:31], v[12:15], v[96:111]
    v_cvt_pk_bf16_f32 v55, v166, v167
    v_exp_f32 v169, v121
    v_exp_f32 v170, v122
    v_exp_f32 v171, v123
    v_mfma_f32_32x32x16_bf16 v[144:159], v[32:35], v[52:55], v[144:159]
    ds_read_b128 v[32:35], v3 offset:6144
    v_exp_f32 v172, v124
    v_exp_f32 v173, v125
    v_exp_f32 v174, v126
    v_cvt_pk_bf16_f32 v56, v168, v169
    v_mfma_f32_16x16x32_bf16 v[48:51], v[40:43], v[52:55], v[48:51]
    v_exp_f32 v175, v127
    v_cvt_pk_bf16_f32 v57, v170, v171
    v_cvt_pk_bf16_f32 v58, v172, v173
    v_cvt_pk_bf16_f32 v59, v174, v175
    v_exp_f32 v160, v96
    v_exp_f32 v161, v97
    v_mfma_f32_32x32x16_bf16 v[144:159], v[36:39], v[56:59], v[144:159]
    ds_read_b128 v[36:39], v3 offset:7168
    v_exp_f32 v162, v98
    v_exp_f32 v163, v99
    v_exp_f32 v164, v100
    v_mfma_f32_16x16x32_bf16 v[48:51], v[40:43], v[56:59], v[48:51]
    v_exp_f32 v165, v101
    v_cvt_pk_bf16_f32 v52, v160, v161
    v_cvt_pk_bf16_f32 v53, v162, v163
    v_mfma_f32_32x32x16_bf16 v[112:127], v[24:27], v[16:19], v[80:95]
    v_exp_f32 v166, v102
    v_exp_f32 v167, v103
    v_exp_f32 v168, v104
    v_cvt_pk_bf16_f32 v54, v164, v165
    v_mfma_f32_32x32x16_bf16 v[112:127], v[28:31], v[20:23], v[112:127]
    ds_read_b128 v[24:27], v3 offset:8192
    ds_read_b128 v[28:31], v3 offset:9216
    v_cvt_pk_bf16_f32 v55, v166, v167
    v_exp_f32 v169, v105
    v_exp_f32 v170, v106
    v_exp_f32 v171, v107
    s_waitcnt lgkmcnt(3)
    v_mfma_f32_32x32x16_bf16 v[128:143], v[32:35], v[52:55], v[128:143]
    v_exp_f32 v172, v108
    v_exp_f32 v173, v109
    v_exp_f32 v174, v110
    v_cvt_pk_bf16_f32 v56, v168, v169
    v_mfma_f32_16x16x32_bf16 v[44:47], v[40:43], v[52:55], v[44:47]
    v_exp_f32 v175, v111
    v_cvt_pk_bf16_f32 v57, v170, v171
    v_cvt_pk_bf16_f32 v58, v172, v173
    v_cvt_pk_bf16_f32 v59, v174, v175
    v_exp_f32 v160, v112
    v_exp_f32 v161, v113
    s_waitcnt lgkmcnt(2)
    v_mfma_f32_32x32x16_bf16 v[128:143], v[36:39], v[56:59], v[128:143]
    v_exp_f32 v162, v114
    v_exp_f32 v163, v115
    v_exp_f32 v164, v116
    v_mfma_f32_16x16x32_bf16 v[44:47], v[40:43], v[56:59], v[44:47]
    v_exp_f32 v165, v117
    v_cvt_pk_bf16_f32 v52, v160, v161
    v_cvt_pk_bf16_f32 v53, v162, v163
    s_waitcnt lgkmcnt(0)
    v_mfma_f32_32x32x16_bf16 v[96:111], v[24:27], v[8:11], v[64:79]
    v_exp_f32 v166, v118
    v_exp_f32 v167, v119
    v_exp_f32 v168, v120
    v_cvt_pk_bf16_f32 v54, v164, v165
    v_mfma_f32_32x32x16_bf16 v[96:111], v[28:31], v[12:15], v[96:111]
    v_cvt_pk_bf16_f32 v55, v166, v167
    v_exp_f32 v169, v121
    v_exp_f32 v170, v122
    v_exp_f32 v171, v123
    v_mfma_f32_32x32x16_bf16 v[144:159], v[32:35], v[52:55], v[144:159]
    ds_read_b128 v[32:35], v3 offset:10240
    v_exp_f32 v172, v124
    v_exp_f32 v173, v125
    v_exp_f32 v174, v126
    v_cvt_pk_bf16_f32 v56, v168, v169
    v_mfma_f32_16x16x32_bf16 v[48:51], v[40:43], v[52:55], v[48:51]
    v_exp_f32 v175, v127
    v_cvt_pk_bf16_f32 v57, v170, v171
    v_cvt_pk_bf16_f32 v58, v172, v173
    v_cvt_pk_bf16_f32 v59, v174, v175
    v_exp_f32 v160, v96
    v_exp_f32 v161, v97
    v_mfma_f32_32x32x16_bf16 v[144:159], v[36:39], v[56:59], v[144:159]
    ds_read_b128 v[36:39], v3 offset:11264
    v_exp_f32 v162, v98
    v_exp_f32 v163, v99
    v_exp_f32 v164, v100
    v_mfma_f32_16x16x32_bf16 v[48:51], v[40:43], v[56:59], v[48:51]
    v_exp_f32 v165, v101
    v_cvt_pk_bf16_f32 v52, v160, v161
    v_cvt_pk_bf16_f32 v53, v162, v163
    v_mfma_f32_32x32x16_bf16 v[112:127], v[24:27], v[16:19], v[80:95]
    v_exp_f32 v166, v102
    v_exp_f32 v167, v103
    v_exp_f32 v168, v104
    v_cvt_pk_bf16_f32 v54, v164, v165
    v_mfma_f32_32x32x16_bf16 v[112:127], v[28:31], v[20:23], v[112:127]
    ds_read_b128 v[24:27], v3 offset:12288
    ds_read_b128 v[28:31], v3 offset:13312
    v_cvt_pk_bf16_f32 v55, v166, v167
    v_exp_f32 v169, v105
    v_exp_f32 v170, v106
    v_exp_f32 v171, v107
    s_waitcnt lgkmcnt(3)
    v_mfma_f32_32x32x16_bf16 v[128:143], v[32:35], v[52:55], v[128:143]
    v_exp_f32 v172, v108
    v_exp_f32 v173, v109
    v_exp_f32 v174, v110
    v_cvt_pk_bf16_f32 v56, v168, v169
    v_mfma_f32_16x16x32_bf16 v[44:47], v[40:43], v[52:55], v[44:47]
    v_exp_f32 v175, v111
    v_cvt_pk_bf16_f32 v57, v170, v171
    v_cvt_pk_bf16_f32 v58, v172, v173
    v_cvt_pk_bf16_f32 v59, v174, v175
    v_exp_f32 v160, v112
    v_exp_f32 v161, v113
    s_waitcnt lgkmcnt(2)
    v_mfma_f32_32x32x16_bf16 v[128:143], v[36:39], v[56:59], v[128:143]
    v_exp_f32 v162, v114
    v_exp_f32 v163, v115
    v_exp_f32 v164, v116
    v_mfma_f32_16x16x32_bf16 v[44:47], v[40:43], v[56:59], v[44:47]
    v_exp_f32 v165, v117
    v_cvt_pk_bf16_f32 v52, v160, v161
    v_cvt_pk_bf16_f32 v53, v162, v163
    s_waitcnt lgkmcnt(0)
    v_mfma_f32_32x32x16_bf16 v[96:111], v[24:27], v[8:11], v[64:79]
    v_exp_f32 v166, v118
    v_exp_f32 v167, v119
    v_exp_f32 v168, v120
    v_cvt_pk_bf16_f32 v54, v164, v165
    v_mfma_f32_32x32x16_bf16 v[96:111], v[28:31], v[12:15], v[96:111]
    v_cvt_pk_bf16_f32 v55, v166, v167
    v_exp_f32 v169, v121
    v_exp_f32 v170, v122
    v_exp_f32 v171, v123
    v_mfma_f32_32x32x16_bf16 v[144:159], v[32:35], v[52:55], v[144:159]
    ds_read_b128 v[32:35], v3 offset:14336
    v_exp_f32 v172, v124
    v_exp_f32 v173, v125
    v_exp_f32 v174, v126
    v_cvt_pk_bf16_f32 v56, v168, v169
    v_mfma_f32_16x16x32_bf16 v[48:51], v[40:43], v[52:55], v[48:51]
    v_exp_f32 v175, v127
    v_cvt_pk_bf16_f32 v57, v170, v171
    v_cvt_pk_bf16_f32 v58, v172, v173
    v_cvt_pk_bf16_f32 v59, v174, v175
    v_exp_f32 v160, v96
    v_exp_f32 v161, v97
    v_mfma_f32_32x32x16_bf16 v[144:159], v[36:39], v[56:59], v[144:159]
    ds_read_b128 v[36:39], v3 offset:15360
    v_exp_f32 v162, v98
    v_exp_f32 v163, v99
    v_exp_f32 v164, v100
    v_mfma_f32_16x16x32_bf16 v[48:51], v[40:43], v[56:59], v[48:51]
    v_exp_f32 v165, v101
    v_cvt_pk_bf16_f32 v52, v160, v161
    v_cvt_pk_bf16_f32 v53, v162, v163
    v_mfma_f32_32x32x16_bf16 v[112:127], v[24:27], v[16:19], v[80:95]
    v_exp_f32 v166, v102
    v_exp_f32 v167, v103
    v_exp_f32 v168, v104
    v_cvt_pk_bf16_f32 v54, v164, v165
    v_mfma_f32_32x32x16_bf16 v[112:127], v[28:31], v[20:23], v[112:127]
    s_waitcnt vmcnt(0)
    s_barrier
    ds_read_b128 v[24:27], v4 offset:0
    ds_read_b128 v[28:31], v4 offset:1024
    s_mov_b32 m0, s12
    s_nop 0
    buffer_load_dwordx4 v2, s[44:47], s11 offen offset:0 sc1 lds
    v_cvt_pk_bf16_f32 v55, v166, v167
    v_exp_f32 v169, v105
    v_exp_f32 v170, v106
    v_exp_f32 v171, v107
    s_waitcnt lgkmcnt(3)
    v_mfma_f32_32x32x16_bf16 v[128:143], v[32:35], v[52:55], v[128:143]
    v_exp_f32 v172, v108
    v_exp_f32 v173, v109
    v_exp_f32 v174, v110
    v_cvt_pk_bf16_f32 v56, v168, v169
    v_mfma_f32_16x16x32_bf16 v[44:47], v[40:43], v[52:55], v[44:47]
    buffer_load_dwordx4 v2, s[44:47], s11 offen offset:1024 sc1 lds
    v_exp_f32 v175, v111
    v_cvt_pk_bf16_f32 v57, v170, v171
    v_cvt_pk_bf16_f32 v58, v172, v173
    v_cvt_pk_bf16_f32 v59, v174, v175
    v_exp_f32 v160, v112
    v_exp_f32 v161, v113
    s_waitcnt lgkmcnt(2)
    v_mfma_f32_32x32x16_bf16 v[128:143], v[36:39], v[56:59], v[128:143]
    v_exp_f32 v162, v114
    v_exp_f32 v163, v115
    v_exp_f32 v164, v116
    v_mfma_f32_16x16x32_bf16 v[44:47], v[40:43], v[56:59], v[44:47]
    buffer_load_dwordx4 v2, s[44:47], s11 offen offset:2048 sc1 lds
    v_exp_f32 v165, v117
    v_cvt_pk_bf16_f32 v52, v160, v161
    v_cvt_pk_bf16_f32 v53, v162, v163
    s_waitcnt lgkmcnt(0)
    v_mfma_f32_32x32x16_bf16 v[96:111], v[24:27], v[8:11], v[64:79]
    v_exp_f32 v166, v118
    v_exp_f32 v167, v119
    v_exp_f32 v168, v120
    v_cvt_pk_bf16_f32 v54, v164, v165
    v_mfma_f32_32x32x16_bf16 v[96:111], v[28:31], v[12:15], v[96:111]
    v_cvt_pk_bf16_f32 v55, v166, v167
    v_exp_f32 v169, v121
    v_exp_f32 v170, v122
    v_exp_f32 v171, v123
    v_mfma_f32_32x32x16_bf16 v[144:159], v[32:35], v[52:55], v[144:159]
    ds_read_b128 v[32:35], v4 offset:2048
    v_exp_f32 v172, v124
    v_exp_f32 v173, v125
    v_exp_f32 v174, v126
    v_cvt_pk_bf16_f32 v56, v168, v169
    v_mfma_f32_16x16x32_bf16 v[48:51], v[40:43], v[52:55], v[48:51]
    buffer_load_dwordx4 v2, s[44:47], s11 offen offset:3072 sc1 lds
    s_add_u32 s11, s11, 32768
    s_add_u32 s12, s12, 32768
    s_cmp_eq_u32 s12, s6
    s_cselect_b32 s12, s5, s12
    v_exp_f32 v175, v127
    v_cvt_pk_bf16_f32 v57, v170, v171
    v_cvt_pk_bf16_f32 v58, v172, v173
    v_cvt_pk_bf16_f32 v59, v174, v175
    v_exp_f32 v160, v96
    v_exp_f32 v161, v97
    v_mov_b32 v3, v4
    v_add_u32 v4, s14, v63
    s_add_u32 s14, s14, 32768
    s_cmp_eq_u32 s14, 98304
    s_cselect_b32 s14, 0, s14
    s_add_u32 s13, s13, 1
    s_cmp_lt_u32 s13, 8
    s_cbranch_scc1 L_at6_loop
    s_waitcnt vmcnt(0) lgkmcnt(0)
    v_mfma_f32_32x32x16_bf16 v[144:159], v[36:39], v[56:59], v[144:159]
    v_mfma_f32_16x16x32_bf16 v[48:51], v[40:43], v[56:59], v[48:51]
    s_add_u32 s4, s5, 98304
    v_add_u32 v5, s4, v2
    s_xor_b32 s4, s5, 16384
    s_add_u32 s4, s4, 98304
    v_add_u32 v6, s4, v2
    s_lshl_b32 s4, s8, 8
    s_add_u32 s4, s4, 131072
    v_lshl_add_u32 v60, v0, 2, s4
    v_xor_b32 v61, 1024, v60
    s_cmp_eq_u32 s15, 0
    s_cbranch_scc0 L_at6_kh1
    ds_write_b128 v5, v[144:147] offset:0
    ds_write_b128 v5, v[148:151] offset:1024
    ds_write_b128 v5, v[152:155] offset:2048
    ds_write_b128 v5, v[156:159] offset:3072
    ds_write_b32 v60, v48
    s_branch L_at6_khj
L_at6_kh1:
    ds_write_b128 v5, v[128:131] offset:0
    ds_write_b128 v5, v[132:135] offset:1024
    ds_write_b128 v5, v[136:139] offset:2048
    ds_write_b128 v5, v[140:143] offset:3072
    ds_write_b32 v60, v44
    s_waitcnt lgkmcnt(0)
    v_mov_b32 v128, v144
    v_mov_b32 v129, v145
    v_mov_b32 v130, v146
    v_mov_b32 v131, v147
    v_mov_b32 v132, v148
    v_mov_b32 v133, v149
    v_mov_b32 v134, v150
    v_mov_b32 v135, v151
    v_mov_b32 v136, v152
    v_mov_b32 v137, v153
    v_mov_b32 v138, v154
    v_mov_b32 v139, v155
    v_mov_b32 v140, v156
    v_mov_b32 v141, v157
    v_mov_b32 v142, v158
    v_mov_b32 v143, v159
    v_mov_b32 v8, v16
    v_mov_b32 v9, v17
    v_mov_b32 v10, v18
    v_mov_b32 v11, v19
    v_mov_b32 v12, v20
    v_mov_b32 v13, v21
    v_mov_b32 v14, v22
    v_mov_b32 v15, v23
    v_mov_b32 v44, v48
    v_mov_b32 v64, v80
    s_add_u32 s10, s10, 1
L_at6_khj:
    s_waitcnt lgkmcnt(0)
    s_barrier
    ds_read_b128 v[160:163], v6 offset:0
    ds_read_b128 v[164:167], v6 offset:1024
    ds_read_b128 v[168:171], v6 offset:2048
    ds_read_b128 v[172:175], v6 offset:3072
    ds_read_b32 v5, v61
    s_waitcnt lgkmcnt(0)
    v_add_f32 v128, v128, v160
    v_add_f32 v129, v129, v161
    v_add_f32 v130, v130, v162
    v_add_f32 v131, v131, v163
    v_add_f32 v132, v132, v164
    v_add_f32 v133, v133, v165
    v_add_f32 v134, v134, v166
    v_add_f32 v135, v135, v167
    v_add_f32 v136, v136, v168
    v_add_f32 v137, v137, v169
    v_add_f32 v138, v138, v170
    v_add_f32 v139, v139, v171
    v_add_f32 v140, v140, v172
    v_add_f32 v141, v141, v173
    v_add_f32 v142, v142, v174
    v_add_f32 v143, v143, v175
    v_add_f32 v44, v44, v5
    v_mov_b32 v5, v44
    v_max3_f32 v5, v5, abs(v128), abs(v129)
    v_max3_f32 v5, v5, abs(v130), abs(v131)
    v_max3_f32 v5, v5, abs(v132), abs(v133)
    v_max3_f32 v5, v5, abs(v134), abs(v135)
    v_max3_f32 v5, v5, abs(v136), abs(v137)
    v_max3_f32 v5, v5, abs(v138), abs(v139)
    v_max3_f32 v5, v5, abs(v140), abs(v141)
    v_max3_f32 v5, v5, abs(v142), abs(v143)
    v_mov_b32 v6, v44
    v_add_f32 v6, v6, v128
    v_add_f32 v6, v6, v129
    v_add_f32 v6, v6, v130
    v_add_f32 v6, v6, v131
    v_add_f32 v6, v6, v132
    v_add_f32 v6, v6, v133
    v_add_f32 v6, v6, v134
    v_add_f32 v6, v6, v135
    v_add_f32 v6, v6, v136
    v_add_f32 v6, v6, v137
    v_add_f32 v6, v6, v138
    v_add_f32 v6, v6, v139
    v_add_f32 v6, v6, v140
    v_add_f32 v6, v6, v141
    v_add_f32 v6, v6, v142
    v_add_f32 v6, v6, v143
    s_mov_b32 s4, 0x5d800000
    v_cmp_nle_f32 vcc, v5, s4
    v_cmp_u_f32 s[6:7], v6, v6
    s_nop 0
    s_or_b64 vcc, vcc, s[6:7]
    s_nop 1
    s_cbranch_vccz L_at6_fin
    v_sub_f32 v3, 0, v64
    v_mov_b32 v4, 0
    s_lshl_b32 s11, s9, 18
    s_mov_b32 s13, 0
    v_mov_b32 v128, 0
    v_mov_b32 v129, 0
    v_mov_b32 v130, 0
    v_mov_b32 v131, 0
    v_mov_b32 v132, 0
    v_mov_b32 v133, 0
    v_mov_b32 v134, 0
    v_mov_b32 v135, 0
    v_mov_b32 v136, 0
    v_mov_b32 v137, 0
    v_mov_b32 v138, 0
    v_mov_b32 v139, 0
    v_mov_b32 v140, 0
    v_mov_b32 v141, 0
    v_mov_b32 v142, 0
    v_mov_b32 v143, 0
L_at6_slow:
    buffer_load_dwordx4 v[24:27], v2, s[44:47], s11 offen sc1
    buffer_load_dwordx4 v[28:31], v2, s[44:47], s11 offen offset:1024 sc1
    buffer_load_dwordx4 v[32:35], v2, s[44:47], s11 offen offset:2048 sc1
    buffer_load_dwordx4 v[36:39], v2, s[44:47], s11 offen offset:3072 sc1
    s_waitcnt vmcnt(0)
    v_mfma_f32_32x32x16_bf16 v[112:127], v[24:27], v[8:11], 0
    v_mfma_f32_32x32x16_bf16 v[112:127], v[28:31], v[12:15], v[112:127]
    s_nop 11
    v_max3_f32 v5, v112, v113, v114
    v_max3_f32 v5, v5, v115, v116
    v_max3_f32 v5, v5, v117, v118
    v_max3_f32 v5, v5, v119, v120
    v_max3_f32 v5, v5, v121, v122
    v_max3_f32 v5, v5, v123, v124
    v_max3_f32 v5, v5, v125, v126
    v_max_f32 v5, v5, v127
    v_mov_b32 v6, v5
    s_nop 1
    v_permlane32_swap_b32 v5, v6
    v_max3_f32 v5, v5, v6, v3
    v_sub_f32 v7, v3, v5
    v_exp_f32 v7, v7
    v_mov_b32 v3, v5
    v_mul_f32 v4, v4, v7
    v_sub_f32 v160, v112, v3
    v_sub_f32 v161, v113, v3
    v_sub_f32 v162, v114, v3
    v_sub_f32 v163, v115, v3
    v_sub_f32 v164, v116, v3
    v_sub_f32 v165, v117, v3
    v_sub_f32 v166, v118, v3
    v_sub_f32 v167, v119, v3
    v_sub_f32 v168, v120, v3
    v_sub_f32 v169, v121, v3
    v_sub_f32 v170, v122, v3
    v_sub_f32 v171, v123, v3
    v_sub_f32 v172, v124, v3
    v_sub_f32 v173, v125, v3
    v_sub_f32 v174, v126, v3
    v_sub_f32 v175, v127, v3
    v_exp_f32 v160, v160
    v_exp_f32 v161, v161
    v_exp_f32 v162, v162
    v_exp_f32 v163, v163
    v_exp_f32 v164, v164
    v_exp_f32 v165, v165
    v_exp_f32 v166, v166
    v_exp_f32 v167, v167
    v_exp_f32 v168, v168
    v_exp_f32 v169, v169
    v_exp_f32 v170, v170
    v_exp_f32 v171, v171
    v_exp_f32 v172, v172
    v_exp_f32 v173, v173
    v_exp_f32 v174, v174
    v_exp_f32 v175, v175
    v_mul_f32 v128, v128, v7
    v_mul_f32 v129, v129, v7
    v_mul_f32 v130, v130, v7
    v_mul_f32 v131, v131, v7
    v_mul_f32 v132, v132, v7
    v_mul_f32 v133, v133, v7
    v_mul_f32 v134, v134, v7
    v_mul_f32 v135, v135, v7
    v_mul_f32 v136, v136, v7
    v_mul_f32 v137, v137, v7
    v_mul_f32 v138, v138, v7
    v_mul_f32 v139, v139, v7
    v_mul_f32 v140, v140, v7
    v_mul_f32 v141, v141, v7
    v_mul_f32 v142, v142, v7
    v_mul_f32 v143, v143, v7
    v_cvt_pk_bf16_f32 v52, v160, v161
    v_cvt_pk_bf16_f32 v53, v162, v163
    v_cvt_pk_bf16_f32 v54, v164, v165
    v_cvt_pk_bf16_f32 v55, v166, v167
    v_cvt_pk_bf16_f32 v56, v168, v169
    v_cvt_pk_bf16_f32 v57, v170, v171
    v_cvt_pk_bf16_f32 v58, v172, v173
    v_cvt_pk_bf16_f32 v59, v174, v175
    v_lshlrev_b32 v5, 16, v52
    v_and_b32 v6, 0xffff0000, v52
    v_add_f32 v4, v4, v5
    v_add_f32 v4, v4, v6
    v_lshlrev_b32 v5, 16, v53
    v_and_b32 v6, 0xffff0000, v53
    v_add_f32 v4, v4, v5
    v_add_f32 v4, v4, v6
    v_lshlrev_b32 v5, 16, v54
    v_and_b32 v6, 0xffff0000, v54
    v_add_f32 v4, v4, v5
    v_add_f32 v4, v4, v6
    v_lshlrev_b32 v5, 16, v55
    v_and_b32 v6, 0xffff0000, v55
    v_add_f32 v4, v4, v5
    v_add_f32 v4, v4, v6
    v_lshlrev_b32 v5, 16, v56
    v_and_b32 v6, 0xffff0000, v56
    v_add_f32 v4, v4, v5
    v_add_f32 v4, v4, v6
    v_lshlrev_b32 v5, 16, v57
    v_and_b32 v6, 0xffff0000, v57
    v_add_f32 v4, v4, v5
    v_add_f32 v4, v4, v6
    v_lshlrev_b32 v5, 16, v58
    v_and_b32 v6, 0xffff0000, v58
    v_add_f32 v4, v4, v5
    v_add_f32 v4, v4, v6
    v_lshlrev_b32 v5, 16, v59
    v_and_b32 v6, 0xffff0000, v59
    v_add_f32 v4, v4, v5
    v_add_f32 v4, v4, v6
    v_mfma_f32_32x32x16_bf16 v[128:143], v[32:35], v[52:55], v[128:143]
    v_mfma_f32_32x32x16_bf16 v[128:143], v[36:39], v[56:59], v[128:143]
    s_add_u32 s11, s11, 4096
    s_add_u32 s13, s13, 1
    s_cmp_lt_u32 s13, 64
    s_cbranch_scc1 L_at6_slow
    v_mov_b32 v5, v4
    s_nop 1
    v_permlane32_swap_b32 v4, v5
    v_add_f32 v44, v4, v5
L_at6_fin:
    s_add_u32 s48, s36, 113246208
    s_addc_u32 s49, s37, 0
    s_mov_b32 s50, 4194304
    s_mov_b32 s51, 0x20000
    v_rcp_f32 v5, v44
    s_lshl_b32 s4, s10, 16
    s_lshl_b32 s7, s9, 11
    s_add_u32 s4, s4, s7
    v_mul_f32 v160, v128, v5
    v_mul_f32 v161, v129, v5
    v_mul_f32 v162, v130, v5
    v_mul_f32 v163, v131, v5
    v_mul_f32 v164, v132, v5
    v_mul_f32 v165, v133, v5
    v_mul_f32 v166, v134, v5
    v_mul_f32 v167, v135, v5
    v_mul_f32 v168, v136, v5
    v_mul_f32 v169, v137, v5
    v_mul_f32 v170, v138, v5
    v_mul_f32 v171, v139, v5
    v_mul_f32 v172, v140, v5
    v_mul_f32 v173, v141, v5
    v_mul_f32 v174, v142, v5
    v_mul_f32 v175, v143, v5
    v_cvt_pk_bf16_f32 v52, v160, v161
    v_cvt_pk_bf16_f32 v53, v162, v163
    v_cvt_pk_bf16_f32 v54, v164, v165
    v_cvt_pk_bf16_f32 v55, v166, v167
    v_cvt_pk_bf16_f32 v56, v168, v169
    v_cvt_pk_bf16_f32 v57, v170, v171
    v_cvt_pk_bf16_f32 v58, v172, v173
    v_cvt_pk_bf16_f32 v59, v174, v175
    buffer_store_dwordx4 v[52:55], v2, s[48:51], s4 offen sc1
    buffer_store_dwordx4 v[56:59], v2, s[48:51], s4 offen offset:1024 sc1
    s_add_u32 s52, s36, 49283072
    s_addc_u32 s53, s37, 0
    s_mov_b32 s54, 1048576
    s_mov_b32 s55, 0x20000
    s_lshl_b32 s4, s10, 11
    s_lshl_b32 s5, s9, 2
    s_add_u32 s4, s4, s5
    s_add_u32 s4, s4, 524288
    v_and_b32 v7, 15, v0
    v_lshlrev_b32 v7, 7, v7
    v_mov_b32 v5, 0
    v_mov_b32 v6, 1
    s_waitcnt vmcnt(0)
    s_mov_b64 exec, 0xffff
    buffer_store_dword v6, v7, s[52:55], s4 offen sc1
    s_mov_b64 exec, -1
    s_barrier
L_at6_end:
    s_and_b32 s10, s94, 3
    s_cmp_lt_u32 s94, 4
    s_cbranch_scc1 L_rest_kernel_c3
    s_setprio 0
    s_and_b32 s4, s2, 7
    s_lshr_b32 s5, s2, 3
    s_and_b32 s6, s4, 1
    s_lshr_b32 s7, s4, 1
    s_mul_i32 s9, s6, 8
    s_and_b32 s6, s5, 7
    s_add_u32 s9, s9, s6
    s_mul_i32 s8, s7, 4
    s_lshr_b32 s6, s5, 3
    s_add_u32 s8, s8, s6
    s_lshl_b32 s4, s8, 2
    s_add_u32 s4, s4, s10
    s_mul_i32 s48, s4, 65536
    v_lshlrev_b32 v8, 4, v0
    s_mul_i32 s49, s9, 131072
    s_mul_i32 s6, s10, 2048
    s_add_u32 s49, s49, s6
    v_add_u32 v12, 4096, v8
    s_lshl_b32 s5, s10, 12
    s_add_u32 s6, s6, 16384
    s_mov_b32 s50, 0
    s_waitcnt lgkmcnt(0)
    s_add_u32 s40, s36, 113246208
    s_addc_u32 s41, s37, 0
    s_mov_b32 s42, 4194304
    s_mov_b32 s43, 0x20000
    s_add_u32 s44, s36, 60817408
    s_addc_u32 s45, s37, 0
    s_mov_b32 s46, 2097152
    s_mov_b32 s47, 0x20000
    s_add_u32 s56, s36, 49283072
    s_addc_u32 s57, s37, 0
    s_mov_b32 s58, 1048576
    s_mov_b32 s59, 0x20000
    s_add_u32 m0, s50, s6
    s_nop 0
    buffer_load_dwordx4 v8, s[44:47], s49 offen offset:0 sc1 lds
    buffer_load_dwordx4 v8, s[44:47], s49 offen offset:1024 sc1 lds
    s_add_u32 s49, s49, 8192
    s_add_u32 s50, s50, 24576
    s_cmp_eq_u32 s50, 147456
    s_cselect_b32 s50, 0, s50
    s_add_u32 m0, s50, s6
    s_nop 0
    buffer_load_dwordx4 v8, s[44:47], s49 offen offset:0 sc1 lds
    buffer_load_dwordx4 v8, s[44:47], s49 offen offset:1024 sc1 lds
    s_add_u32 s49, s49, 8192
    s_add_u32 s50, s50, 24576
    s_cmp_eq_u32 s50, 147456
    s_cselect_b32 s50, 0, s50
    s_add_u32 m0, s50, s6
    s_nop 0
    buffer_load_dwordx4 v8, s[44:47], s49 offen offset:0 sc1 lds
    buffer_load_dwordx4 v8, s[44:47], s49 offen offset:1024 sc1 lds
    s_add_u32 s49, s49, 8192
    s_add_u32 s50, s50, 24576
    s_cmp_eq_u32 s50, 147456
    s_cselect_b32 s50, 0, s50
    s_add_u32 m0, s50, s6
    s_nop 0
    buffer_load_dwordx4 v8, s[44:47], s49 offen offset:0 sc1 lds
    buffer_load_dwordx4 v8, s[44:47], s49 offen offset:1024 sc1 lds
    s_add_u32 s49, s49, 8192
    s_add_u32 s50, s50, 24576
    s_cmp_eq_u32 s50, 147456
    s_cselect_b32 s50, 0, s50
    s_mov_b32 s50, 0
    s_lshl_b32 s4, s8, 2
    s_add_u32 s4, s4, s10
    s_lshl_b32 s4, s4, 4
    s_add_u32 s4, s4, s9
    s_lshl_b32 s4, s4, 7
    s_add_u32 s4, s4, 524288
    v_and_b32 v20, 31, v0
    v_lshlrev_b32 v20, 2, v20
    s_mov_b32 s60, 0x40000
L_wo2_w_poll:
    buffer_load_dword v21, v20, s[56:59], s4 offen sc1
    s_waitcnt vmcnt(0)
    v_cmp_ne_u32 vcc, 1, v21
    s_nop 4
    s_cbranch_vccz L_wo2_w_got
    s_sleep 4
    s_sub_u32 s60, s60, 1
    s_cmp_lg_u32 s60, 0
    s_cbranch_scc1 L_wo2_w_poll
L_wo2_w_got:
    s_add_u32 m0, s50, s5
    s_nop 0
    buffer_load_dwordx4 v8, s[40:43], s48 offen offset:0 sc1 lds
    buffer_load_dwordx4 v8, s[40:43], s48 offen offset:1024 sc1 lds
    buffer_load_dwordx4 v8, s[40:43], s48 offen offset:2048 sc1 lds
    buffer_load_dwordx4 v8, s[40:43], s48 offen offset:3072 sc1 lds
    s_add_u32 s48, s48, 4096
    s_add_u32 s50, s50, 24576
    s_cmp_eq_u32 s50, 147456
    s_cselect_b32 s50, 0, s50
    s_add_u32 m0, s50, s5
    s_nop 0
    buffer_load_dwordx4 v8, s[40:43], s48 offen offset:0 sc1 lds
    buffer_load_dwordx4 v8, s[40:43], s48 offen offset:1024 sc1 lds
    buffer_load_dwordx4 v8, s[40:43], s48 offen offset:2048 sc1 lds
    buffer_load_dwordx4 v8, s[40:43], s48 offen offset:3072 sc1 lds
    s_add_u32 s48, s48, 4096
    s_add_u32 s50, s50, 24576
    s_cmp_eq_u32 s50, 147456
    s_cselect_b32 s50, 0, s50
    s_waitcnt vmcnt(4)
    s_barrier
    s_add_u32 m0, s50, s5
    s_nop 0
    buffer_load_dwordx4 v8, s[40:43], s48 offen offset:0 sc1 lds
    buffer_load_dwordx4 v8, s[40:43], s48 offen offset:1024 sc1 lds
    buffer_load_dwordx4 v8, s[40:43], s48 offen offset:2048 sc1 lds
    buffer_load_dwordx4 v8, s[40:43], s48 offen offset:3072 sc1 lds
    s_add_u32 s48, s48, 4096
    s_add_u32 s50, s50, 24576
    s_cmp_eq_u32 s50, 147456
    s_cselect_b32 s50, 0, s50
    s_add_u32 m0, s50, s5
    s_nop 0
    buffer_load_dwordx4 v8, s[40:43], s48 offen offset:0 sc1 lds
    buffer_load_dwordx4 v8, s[40:43], s48 offen offset:1024 sc1 lds
    buffer_load_dwordx4 v8, s[40:43], s48 offen offset:2048 sc1 lds
    buffer_load_dwordx4 v8, s[40:43], s48 offen offset:3072 sc1 lds
    s_add_u32 s48, s48, 4096
    s_add_u32 s50, s50, 24576
    s_cmp_eq_u32 s50, 147456
    s_cselect_b32 s50, 0, s50
    s_waitcnt vmcnt(8)
    s_barrier
    s_add_u32 m0, s50, s5
    s_nop 0
    buffer_load_dwordx4 v8, s[40:43], s48 offen offset:0 sc1 lds
    buffer_load_dwordx4 v8, s[40:43], s48 offen offset:1024 sc1 lds
    buffer_load_dwordx4 v8, s[40:43], s48 offen offset:2048 sc1 lds
    buffer_load_dwordx4 v8, s[40:43], s48 offen offset:3072 sc1 lds
    s_add_u32 m0, s50, s6
    s_nop 0
    buffer_load_dwordx4 v8, s[44:47], s49 offen offset:0 sc1 lds
    buffer_load_dwordx4 v8, s[44:47], s49 offen offset:1024 sc1 lds
    s_add_u32 s48, s48, 4096
    s_add_u32 s49, s49, 8192
    s_add_u32 s50, s50, 24576
    s_cmp_eq_u32 s50, 147456
    s_cselect_b32 s50, 0, s50
    s_add_u32 m0, s50, s5
    s_nop 0
    buffer_load_dwordx4 v8, s[40:43], s48 offen offset:0 sc1 lds
    buffer_load_dwordx4 v8, s[40:43], s48 offen offset:1024 sc1 lds
    buffer_load_dwordx4 v8, s[40:43], s48 offen offset:2048 sc1 lds
    buffer_load_dwordx4 v8, s[40:43], s48 offen offset:3072 sc1 lds
    s_add_u32 m0, s50, s6
    s_nop 0
    buffer_load_dwordx4 v8, s[44:47], s49 offen offset:0 sc1 lds
    buffer_load_dwordx4 v8, s[44:47], s49 offen offset:1024 sc1 lds
    s_add_u32 s48, s48, 4096
    s_add_u32 s49, s49, 8192
    s_add_u32 s50, s50, 24576
    s_cmp_eq_u32 s50, 147456
    s_cselect_b32 s50, 0, s50
    s_waitcnt vmcnt(16)
    s_barrier
    s_add_u32 m0, s50, s5
    s_nop 0
    buffer_load_dwordx4 v8, s[40:43], s48 offen offset:0 sc1 lds
    buffer_load_dwordx4 v8, s[40:43], s48 offen offset:1024 sc1 lds
    buffer_load_dwordx4 v8, s[40:43], s48 offen offset:2048 sc1 lds
    buffer_load_dwordx4 v8, s[40:43], s48 offen offset:3072 sc1 lds
    s_add_u32 m0, s50, s6
    s_nop 0
    buffer_load_dwordx4 v8, s[44:47], s49 offen offset:0 sc1 lds
    buffer_load_dwordx4 v8, s[44:47], s49 offen offset:1024 sc1 lds
    s_add_u32 s48, s48, 4096
    s_add_u32 s49, s49, 8192
    s_add_u32 s50, s50, 24576
    s_cmp_eq_u32 s50, 147456
    s_cselect_b32 s50, 0, s50
    s_add_u32 m0, s50, s5
    s_nop 0
    buffer_load_dwordx4 v8, s[40:43], s48 offen offset:0 sc1 lds
    buffer_load_dwordx4 v8, s[40:43], s48 offen offset:1024 sc1 lds
    buffer_load_dwordx4 v8, s[40:43], s48 offen offset:2048 sc1 lds
    buffer_load_dwordx4 v8, s[40:43], s48 offen offset:3072 sc1 lds
    s_add_u32 m0, s50, s6
    s_nop 0
    buffer_load_dwordx4 v8, s[44:47], s49 offen offset:0 sc1 lds
    buffer_load_dwordx4 v8, s[44:47], s49 offen offset:1024 sc1 lds
    s_add_u32 s48, s48, 4096
    s_add_u32 s49, s49, 8192
    s_add_u32 s50, s50, 24576
    s_cmp_eq_u32 s50, 147456
    s_cselect_b32 s50, 0, s50
    s_mov_b32 s51, 8
L_wo2_ld_loop:
    s_waitcnt vmcnt(24)
    s_barrier
    s_add_u32 m0, s50, s5
    s_nop 0
    buffer_load_dwordx4 v8, s[40:43], s48 offen offset:0 sc1 lds
    buffer_load_dwordx4 v8, s[40:43], s48 offen offset:1024 sc1 lds
    buffer_load_dwordx4 v8, s[40:43], s48 offen offset:2048 sc1 lds
    buffer_load_dwordx4 v8, s[40:43], s48 offen offset:3072 sc1 lds
    s_add_u32 m0, s50, s6
    s_nop 0
    buffer_load_dwordx4 v8, s[44:47], s49 offen offset:0 sc1 lds
    buffer_load_dwordx4 v8, s[44:47], s49 offen offset:1024 sc1 lds
    s_add_u32 s48, s48, 4096
    s_add_u32 s49, s49, 8192
    s_add_u32 s50, s50, 24576
    s_cmp_eq_u32 s50, 147456
    s_cselect_b32 s50, 0, s50
    s_sub_u32 s51, s51, 1
    s_cmp_lg_u32 s51, 0
    s_cbranch_scc1 L_wo2_ld_loop
    s_waitcnt vmcnt(24)
    s_barrier
    s_waitcnt vmcnt(18)
    s_barrier
    s_waitcnt vmcnt(12)
    s_barrier
    s_waitcnt vmcnt(6)
    s_barrier
    s_waitcnt vmcnt(0)
    s_barrier
    s_barrier
    s_setprio 0
    s_and_b32 s4, s2, 7
    s_lshr_b32 s5, s2, 3
    s_and_b32 s6, s4, 3
    s_lshr_b32 s7, s4, 2
    s_mul_i32 s9, s6, 4
    s_and_b32 s6, s5, 3
    s_add_u32 s9, s9, s6
    s_mul_i32 s8, s7, 8
    s_lshr_b32 s6, s5, 2
    s_add_u32 s8, s8, s6
    s_lshl_b32 s4, s8, 2
    s_add_u32 s4, s4, s10
    s_mul_i32 s48, s4, 65536
    v_lshlrev_b32 v8, 4, v0
    s_mul_i32 s49, s9, 458752
    s_mul_i32 s6, s10, 7168
    s_add_u32 s49, s49, s6
    v_add_u32 v12, 4096, v8
    s_lshl_b32 s5, s10, 12
    s_add_u32 s6, s6, 16384
    s_mov_b32 s50, 0
    s_waitcnt lgkmcnt(0)
    s_add_u32 s40, s36, 41943040
    s_addc_u32 s41, s37, 0
    s_mov_b32 s42, 4194304
    s_mov_b32 s43, 0x20000
    s_add_u32 s44, s36, 62914560
    s_addc_u32 s45, s37, 0
    s_mov_b32 s46, 7340032
    s_mov_b32 s47, 0x20000
    s_add_u32 s56, s36, 49283072
    s_addc_u32 s57, s37, 0
    s_mov_b32 s58, 1048576
    s_mov_b32 s59, 0x20000
    s_add_u32 m0, s50, s6
    s_nop 0
    buffer_load_dwordx4 v8, s[44:47], s49 offen offset:0 sc1 lds
    buffer_load_dwordx4 v8, s[44:47], s49 offen offset:1024 sc1 lds
    buffer_load_dwordx4 v8, s[44:47], s49 offen offset:2048 sc1 lds
    buffer_load_dwordx4 v8, s[44:47], s49 offen offset:3072 sc1 lds
    s_add_u32 m0, m0, 4096
    s_nop 0
    buffer_load_dwordx4 v12, s[44:47], s49 offen offset:0 sc1 lds
    buffer_load_dwordx4 v12, s[44:47], s49 offen offset:1024 sc1 lds
    buffer_load_dwordx4 v12, s[44:47], s49 offen offset:2048 sc1 lds
    s_add_u32 s49, s49, 28672
    s_add_u32 s50, s50, 45056
    s_cmp_eq_u32 s50, 135168
    s_cselect_b32 s50, 0, s50
    s_add_u32 m0, s50, s6
    s_nop 0
    buffer_load_dwordx4 v8, s[44:47], s49 offen offset:0 sc1 lds
    buffer_load_dwordx4 v8, s[44:47], s49 offen offset:1024 sc1 lds
    buffer_load_dwordx4 v8, s[44:47], s49 offen offset:2048 sc1 lds
    buffer_load_dwordx4 v8, s[44:47], s49 offen offset:3072 sc1 lds
    s_add_u32 m0, m0, 4096
    s_nop 0
    buffer_load_dwordx4 v12, s[44:47], s49 offen offset:0 sc1 lds
    buffer_load_dwordx4 v12, s[44:47], s49 offen offset:1024 sc1 lds
    buffer_load_dwordx4 v12, s[44:47], s49 offen offset:2048 sc1 lds
    s_add_u32 s49, s49, 28672
    s_add_u32 s50, s50, 45056
    s_cmp_eq_u32 s50, 135168
    s_cselect_b32 s50, 0, s50
    s_add_u32 m0, s50, s6
    s_nop 0
    buffer_load_dwordx4 v8, s[44:47], s49 offen offset:0 sc1 lds
    buffer_load_dwordx4 v8, s[44:47], s49 offen offset:1024 sc1 lds
    buffer_load_dwordx4 v8, s[44:47], s49 offen offset:2048 sc1 lds
    buffer_load_dwordx4 v8, s[44:47], s49 offen offset:3072 sc1 lds
    s_add_u32 m0, m0, 4096
    s_nop 0
    buffer_load_dwordx4 v12, s[44:47], s49 offen offset:0 sc1 lds
    buffer_load_dwordx4 v12, s[44:47], s49 offen offset:1024 sc1 lds
    buffer_load_dwordx4 v12, s[44:47], s49 offen offset:2048 sc1 lds
    s_add_u32 s49, s49, 28672
    s_add_u32 s50, s50, 45056
    s_cmp_eq_u32 s50, 135168
    s_cselect_b32 s50, 0, s50
    s_mov_b32 s50, 0
    s_lshl_b32 s4, s8, 2
    s_add_u32 s4, s4, s10
    s_lshl_b32 s4, s4, 4
    s_add_u32 s4, s4, s9
    s_lshl_b32 s4, s4, 7
    s_add_u32 s4, s4, 131072
    v_and_b32 v20, 15, v0
    v_lshlrev_b32 v20, 2, v20
    s_mov_b32 s60, 0x40000
L_w1b_w_poll:
    buffer_load_dword v21, v20, s[56:59], s4 offen sc1
    s_waitcnt vmcnt(0)
    v_cmp_ne_u32 vcc, 1, v21
    s_nop 4
    s_cbranch_vccz L_w1b_w_got
    s_sleep 4
    s_sub_u32 s60, s60, 1
    s_cmp_lg_u32 s60, 0
    s_cbranch_scc1 L_w1b_w_poll
L_w1b_w_got:
    s_add_u32 m0, s50, s5
    s_nop 0
    buffer_load_dwordx4 v8, s[40:43], s48 offen offset:0 sc1 lds
    buffer_load_dwordx4 v8, s[40:43], s48 offen offset:1024 sc1 lds
    buffer_load_dwordx4 v8, s[40:43], s48 offen offset:2048 sc1 lds
    buffer_load_dwordx4 v8, s[40:43], s48 offen offset:3072 sc1 lds
    s_add_u32 s48, s48, 4096
    s_add_u32 s50, s50, 45056
    s_cmp_eq_u32 s50, 135168
    s_cselect_b32 s50, 0, s50
    s_add_u32 m0, s50, s5
    s_nop 0
    buffer_load_dwordx4 v8, s[40:43], s48 offen offset:0 sc1 lds
    buffer_load_dwordx4 v8, s[40:43], s48 offen offset:1024 sc1 lds
    buffer_load_dwordx4 v8, s[40:43], s48 offen offset:2048 sc1 lds
    buffer_load_dwordx4 v8, s[40:43], s48 offen offset:3072 sc1 lds
    s_add_u32 s48, s48, 4096
    s_add_u32 s50, s50, 45056
    s_cmp_eq_u32 s50, 135168
    s_cselect_b32 s50, 0, s50
    s_add_u32 s60, s36, 46399488
    s_addc_u32 s61, s37, 0
    s_mov_b32 s62, 229376
    s_mov_b32 s63, 0x20000
    v_min_u32 v5, 55, v0
    v_lshlrev_b32 v5, 2, v5
    s_mul_i32 s4, s9, 896
    s_mul_i32 s7, s10, 224
    s_add_u32 s4, s4, s7
    buffer_load_dword v56, v5, s[60:63], s4 offen sc1
    s_add_u32 s4, s4, 14336
    buffer_load_dword v57, v5, s[60:63], s4 offen sc1
    s_add_u32 s4, s4, 14336
    buffer_load_dword v58, v5, s[60:63], s4 offen sc1
    s_add_u32 s4, s4, 14336
    buffer_load_dword v59, v5, s[60:63], s4 offen sc1
    s_add_u32 s4, s4, 14336
    buffer_load_dword v60, v5, s[60:63], s4 offen sc1
    s_add_u32 s4, s4, 14336
    buffer_load_dword v61, v5, s[60:63], s4 offen sc1
    s_add_u32 s4, s4, 14336
    buffer_load_dword v62, v5, s[60:63], s4 offen sc1
    s_add_u32 s4, s4, 14336
    buffer_load_dword v63, v5, s[60:63], s4 offen sc1
    s_add_u32 s4, s4, 14336
    buffer_load_dword v64, v5, s[60:63], s4 offen sc1
    s_add_u32 s4, s4, 14336
    buffer_load_dword v65, v5, s[60:63], s4 offen sc1
    s_add_u32 s4, s4, 14336
    buffer_load_dword v66, v5, s[60:63], s4 offen sc1
    s_add_u32 s4, s4, 14336
    buffer_load_dword v67, v5, s[60:63], s4 offen sc1
    s_add_u32 s4, s4, 14336
    buffer_load_dword v68, v5, s[60:63], s4 offen sc1
    s_add_u32 s4, s4, 14336
    buffer_load_dword v69, v5, s[60:63], s4 offen sc1
    s_add_u32 s4, s4, 14336
    buffer_load_dword v70, v5, s[60:63], s4 offen sc1
    s_add_u32 s4, s4, 14336
    buffer_load_dword v71, v5, s[60:63], s4 offen sc1
    s_waitcnt vmcnt(20)
    s_barrier
    s_add_u32 m0, s50, s5
    s_nop 0
    buffer_load_dwordx4 v8, s[40:43], s48 offen offset:0 sc1 lds
    buffer_load_dwordx4 v8, s[40:43], s48 offen offset:1024 sc1 lds
    buffer_load_dwordx4 v8, s[40:43], s48 offen offset:2048 sc1 lds
    buffer_load_dwordx4 v8, s[40:43], s48 offen offset:3072 sc1 lds
    s_add_u32 s48, s48, 4096
    s_add_u32 s50, s50, 45056
    s_cmp_eq_u32 s50, 135168
    s_cselect_b32 s50, 0, s50
    s_waitcnt vmcnt(4)
    s_barrier
    s_add_u32 m0, s50, s5
    s_nop 0
    buffer_load_dwordx4 v8, s[40:43], s48 offen offset:0 sc1 lds
    buffer_load_dwordx4 v8, s[40:43], s48 offen offset:1024 sc1 lds
    buffer_load_dwordx4 v8, s[40:43], s48 offen offset:2048 sc1 lds
    buffer_load_dwordx4 v8, s[40:43], s48 offen offset:3072 sc1 lds
    s_add_u32 m0, s50, s6
    s_nop 0
    buffer_load_dwordx4 v8, s[44:47], s49 offen offset:0 sc1 lds
    buffer_load_dwordx4 v8, s[44:47], s49 offen offset:1024 sc1 lds
    buffer_load_dwordx4 v8, s[44:47], s49 offen offset:2048 sc1 lds
    buffer_load_dwordx4 v8, s[44:47], s49 offen offset:3072 sc1 lds
    s_add_u32 m0, m0, 4096
    s_nop 0
    buffer_load_dwordx4 v12, s[44:47], s49 offen offset:0 sc1 lds
    buffer_load_dwordx4 v12, s[44:47], s49 offen offset:1024 sc1 lds
    buffer_load_dwordx4 v12, s[44:47], s49 offen offset:2048 sc1 lds
    s_add_u32 s48, s48, 4096
    s_add_u32 s49, s49, 28672
    s_add_u32 s50, s50, 45056
    s_cmp_eq_u32 s50, 135168
    s_cselect_b32 s50, 0, s50
    s_mov_b32 s51, 12
L_w1b_ld_loop:
    s_waitcnt vmcnt(11)
    s_barrier
    s_add_u32 m0, s50, s5
    s_nop 0
    buffer_load_dwordx4 v8, s[40:43], s48 offen offset:0 sc1 lds
    buffer_load_dwordx4 v8, s[40:43], s48 offen offset:1024 sc1 lds
    buffer_load_dwordx4 v8, s[40:43], s48 offen offset:2048 sc1 lds
    buffer_load_dwordx4 v8, s[40:43], s48 offen offset:3072 sc1 lds
    s_add_u32 m0, s50, s6
    s_nop 0
    buffer_load_dwordx4 v8, s[44:47], s49 offen offset:0 sc1 lds
    buffer_load_dwordx4 v8, s[44:47], s49 offen offset:1024 sc1 lds
    buffer_load_dwordx4 v8, s[44:47], s49 offen offset:2048 sc1 lds
    buffer_load_dwordx4 v8, s[44:47], s49 offen offset:3072 sc1 lds
    s_add_u32 m0, m0, 4096
    s_nop 0
    buffer_load_dwordx4 v12, s[44:47], s49 offen offset:0 sc1 lds
    buffer_load_dwordx4 v12, s[44:47], s49 offen offset:1024 sc1 lds
    buffer_load_dwordx4 v12, s[44:47], s49 offen offset:2048 sc1 lds
    s_add_u32 s48, s48, 4096
    s_add_u32 s49, s49, 28672
    s_add_u32 s50, s50, 45056
    s_cmp_eq_u32 s50, 135168
    s_cselect_b32 s50, 0, s50
    s_sub_u32 s51, s51, 1
    s_cmp_lg_u32 s51, 0
    s_cbranch_scc1 L_w1b_ld_loop
    s_add_u32 s40, s36, 47710208
    s_addc_u32 s41, s37, 0
    s_mov_b32 s42, 262144
    s_mov_b32 s43, 0x20000
    v_and_b32 v3, 31, v0
    v_lshlrev_b32 v3, 3, v3
    v_lshrrev_b32 v4, 5, v0
    v_lshl_add_u32 v3, v4, 17, v3
    s_lshl_b32 s4, s8, 10
    s_lshl_b32 s7, s10, 8
    s_add_u32 s4, s4, s7
    buffer_load_dwordx2 v[32:33], v3, s[40:43], s4 offen sc1
    s_add_u32 s4, s4, 16384
    buffer_load_dwordx2 v[34:35], v3, s[40:43], s4 offen sc1
    s_add_u32 s4, s4, 16384
    buffer_load_dwordx2 v[36:37], v3, s[40:43], s4 offen sc1
    s_add_u32 s4, s4, 16384
    buffer_load_dwordx2 v[38:39], v3, s[40:43], s4 offen sc1
    s_add_u32 s4, s4, 16384
    buffer_load_dwordx2 v[40:41], v3, s[40:43], s4 offen sc1
    s_add_u32 s4, s4, 16384
    buffer_load_dwordx2 v[42:43], v3, s[40:43], s4 offen sc1
    s_add_u32 s4, s4, 16384
    buffer_load_dwordx2 v[44:45], v3, s[40:43], s4 offen sc1
    s_add_u32 s4, s4, 16384
    buffer_load_dwordx2 v[46:47], v3, s[40:43], s4 offen sc1
    s_waitcnt vmcnt(19)
    s_barrier
    s_waitcnt vmcnt(8)
    s_barrier
    s_waitcnt vmcnt(0)
    v_add_f32 v32, v32, v40
    v_add_f32 v33, v33, v41
    v_add_f32 v34, v34, v42
    v_add_f32 v35, v35, v43
    v_add_f32 v36, v36, v44
    v_add_f32 v37, v37, v45
    v_add_f32 v38, v38, v46
    v_add_f32 v39, v39, v47
    v_add_f32 v32, v32, v36
    v_add_f32 v33, v33, v37
    v_add_f32 v34, v34, v38
    v_add_f32 v35, v35, v39
    v_add_f32 v32, v32, v34
    v_add_f32 v33, v33, v35
    v_mov_b32 v34, v32
    s_nop 1
    v_permlane32_swap_b32 v32, v34
    v_add_f32 v32, v32, v34
    v_mov_b32 v34, v33
    s_nop 1
    v_permlane32_swap_b32 v33, v34
    v_add_f32 v33, v33, v34
    v_and_b32 v3, 31, v0
    v_lshlrev_b32 v3, 2, v3
    s_lshl_b32 s4, s10, 7
    s_add_u32 s4, s4, 139264
    v_add_u32 v3, s4, v3
    v_mul_f32 v32, 0x3a800000, v32
    v_mul_f32 v33, 0x3a800000, v33
    v_fma_f32 v33, -v32, v32, v33
    v_max_f32 v33, 0, v33
    v_add_f32 v37, 0x3727c5ac, v33
    v_rsq_f32 v36, v37
    s_nop 0
    v_mul_f32 v37, v36, v36
    v_mul_f32 v37, v37, v33
    v_add_f32 v37, 0x3727c5ac, v37
    v_rsq_f32 v37, v37
    s_nop 0
    v_mul_f32 v36, v36, v37
    v_mul_f32 v32, v32, v36
    v_sub_f32 v32, 0, v32
    ds_write_b32 v3, v36 offset:0
    ds_write_b32 v3, v32 offset:512
    v_add_f32 v56, v56, v64
    v_add_f32 v57, v57, v65
    v_add_f32 v58, v58, v66
    v_add_f32 v59, v59, v67
    v_add_f32 v60, v60, v68
    v_add_f32 v61, v61, v69
    v_add_f32 v62, v62, v70
    v_add_f32 v63, v63, v71
    v_add_f32 v56, v56, v60
    v_add_f32 v57, v57, v61
    v_add_f32 v58, v58, v62
    v_add_f32 v59, v59, v63
    v_add_f32 v56, v56, v58
    v_add_f32 v57, v57, v59
    v_add_f32 v56, v56, v57
    s_mul_i32 s7, s10, 224
    s_add_u32 s7, s7, 148480
    v_add_u32 v5, s7, v5
    ds_write_b32 v5, v56
    s_waitcnt lgkmcnt(0)
    s_barrier
    s_barrier
    s_setprio 0
    s_and_b32 s4, s2, 7
    s_lshr_b32 s5, s2, 3
    s_and_b32 s3, s4, 1
    s_lshr_b32 s7, s4, 1
    s_and_b32 s9, s5, 7
    s_lshl_b32 s8, s7, 2
    s_lshr_b32 s6, s5, 3
    s_add_u32 s8, s8, s6
    s_lshl_b32 s4, s8, 2
    s_add_u32 s4, s4, s10
    s_mul_i32 s48, s4, 229376
    v_lshlrev_b32 v8, 4, v0
    s_mul_i32 s49, s9, 917504
    s_mul_i32 s6, s10, 4096
    s_add_u32 s49, s49, s6
    v_add_u32 v12, 4096, v8
    s_mul_i32 s4, s3, 114688
    s_add_u32 s48, s48, s4
    s_mul_i32 s4, s3, 458752
    s_add_u32 s49, s49, s4
    s_lshl_b32 s5, s10, 12
    s_add_u32 s6, s6, 16384
    s_mov_b32 s50, 0
    s_waitcnt lgkmcnt(0)
    s_add_u32 s40, s36, 117440512
    s_addc_u32 s41, s37, 0
    s_mov_b32 s42, 14680064
    s_mov_b32 s43, 0x20000
    s_add_u32 s44, s36, 71303168
    s_addc_u32 s45, s37, 0
    s_mov_b32 s46, 7340032
    s_mov_b32 s47, 0x20000
    s_add_u32 s56, s36, 49283072
    s_addc_u32 s57, s37, 0
    s_mov_b32 s58, 1048576
    s_mov_b32 s59, 0x20000
    s_add_u32 m0, s50, s6
    s_nop 0
    buffer_load_dwordx4 v8, s[44:47], s49 offen offset:0 sc1 lds
    buffer_load_dwordx4 v8, s[44:47], s49 offen offset:1024 sc1 lds
    buffer_load_dwordx4 v8, s[44:47], s49 offen offset:2048 sc1 lds
    buffer_load_dwordx4 v8, s[44:47], s49 offen offset:3072 sc1 lds
    s_add_u32 s49, s49, 16384
    s_add_u32 s50, s50, 32768
    s_cmp_eq_u32 s50, 163840
    s_cselect_b32 s50, 0, s50
    s_add_u32 m0, s50, s6
    s_nop 0
    buffer_load_dwordx4 v8, s[44:47], s49 offen offset:0 sc1 lds
    buffer_load_dwordx4 v8, s[44:47], s49 offen offset:1024 sc1 lds
    buffer_load_dwordx4 v8, s[44:47], s49 offen offset:2048 sc1 lds
    buffer_load_dwordx4 v8, s[44:47], s49 offen offset:3072 sc1 lds
    s_add_u32 s49, s49, 16384
    s_add_u32 s50, s50, 32768
    s_cmp_eq_u32 s50, 163840
    s_cselect_b32 s50, 0, s50
    s_add_u32 m0, s50, s6
    s_nop 0
    buffer_load_dwordx4 v8, s[44:47], s49 offen offset:0 sc1 lds
    buffer_load_dwordx4 v8, s[44:47], s49 offen offset:1024 sc1 lds
    buffer_load_dwordx4 v8, s[44:47], s49 offen offset:2048 sc1 lds
    buffer_load_dwordx4 v8, s[44:47], s49 offen offset:3072 sc1 lds
    s_add_u32 s49, s49, 16384
    s_add_u32 s50, s50, 32768
    s_cmp_eq_u32 s50, 163840
    s_cselect_b32 s50, 0, s50
    s_add_u32 m0, s50, s6
    s_nop 0
    buffer_load_dwordx4 v8, s[44:47], s49 offen offset:0 sc1 lds
    buffer_load_dwordx4 v8, s[44:47], s49 offen offset:1024 sc1 lds
    buffer_load_dwordx4 v8, s[44:47], s49 offen offset:2048 sc1 lds
    buffer_load_dwordx4 v8, s[44:47], s49 offen offset:3072 sc1 lds
    s_add_u32 s49, s49, 16384
    s_add_u32 s50, s50, 32768
    s_cmp_eq_u32 s50, 163840
    s_cselect_b32 s50, 0, s50
    s_mov_b32 s50, 0
    s_lshl_b32 s4, s8, 1
    s_add_u32 s4, s4, s3
    s_lshl_b32 s4, s4, 3
    s_add_u32 s4, s4, s9
    s_lshl_b32 s4, s4, 2
    s_add_u32 s4, s4, s10
    s_lshl_b32 s4, s4, 7
    s_add_u32 s4, s4, 262144
    v_and_b32 v20, 15, v0
    v_lshlrev_b32 v20, 2, v20
    s_mov_b32 s60, 0x40000
L_w2b_w_poll:
    buffer_load_dword v21, v20, s[56:59], s4 offen sc1
    s_waitcnt vmcnt(0)
    v_cmp_ne_u32 vcc, 1, v21
    s_nop 4
    s_cbranch_vccz L_w2b_w_got
    s_sleep 4
    s_sub_u32 s60, s60, 1
    s_cmp_lg_u32 s60, 0
    s_cbranch_scc1 L_w2b_w_poll
L_w2b_w_got:
    s_add_u32 m0, s50, s5
    s_nop 0
    buffer_load_dwordx4 v8, s[40:43], s48 offen offset:0 sc1 lds
    buffer_load_dwordx4 v8, s[40:43], s48 offen offset:1024 sc1 lds
    buffer_load_dwordx4 v8, s[40:43], s48 offen offset:2048 sc1 lds
    buffer_load_dwordx4 v8, s[40:43], s48 offen offset:3072 sc1 lds
    s_add_u32 s48, s48, 4096
    s_add_u32 s50, s50, 32768
    s_cmp_eq_u32 s50, 163840
    s_cselect_b32 s50, 0, s50
    s_add_u32 m0, s50, s5
    s_nop 0
    buffer_load_dwordx4 v8, s[40:43], s48 offen offset:0 sc1 lds
    buffer_load_dwordx4 v8, s[40:43], s48 offen offset:1024 sc1 lds
    buffer_load_dwordx4 v8, s[40:43], s48 offen offset:2048 sc1 lds
    buffer_load_dwordx4 v8, s[40:43], s48 offen offset:3072 sc1 lds
    s_add_u32 s48, s48, 4096
    s_add_u32 s50, s50, 32768
    s_cmp_eq_u32 s50, 163840
    s_cselect_b32 s50, 0, s50
    s_waitcnt vmcnt(4)
    s_barrier
    s_add_u32 m0, s50, s5
    s_nop 0
    buffer_load_dwordx4 v8, s[40:43], s48 offen offset:0 sc1 lds
    buffer_load_dwordx4 v8, s[40:43], s48 offen offset:1024 sc1 lds
    buffer_load_dwordx4 v8, s[40:43], s48 offen offset:2048 sc1 lds
    buffer_load_dwordx4 v8, s[40:43], s48 offen offset:3072 sc1 lds
    s_add_u32 s48, s48, 4096
    s_add_u32 s50, s50, 32768
    s_cmp_eq_u32 s50, 163840
    s_cselect_b32 s50, 0, s50
    s_add_u32 m0, s50, s5
    s_nop 0
    buffer_load_dwordx4 v8, s[40:43], s48 offen offset:0 sc1 lds
    buffer_load_dwordx4 v8, s[40:43], s48 offen offset:1024 sc1 lds
    buffer_load_dwordx4 v8, s[40:43], s48 offen offset:2048 sc1 lds
    buffer_load_dwordx4 v8, s[40:43], s48 offen offset:3072 sc1 lds
    s_add_u32 s48, s48, 4096
    s_add_u32 s50, s50, 32768
    s_cmp_eq_u32 s50, 163840
    s_cselect_b32 s50, 0, s50
    s_waitcnt vmcnt(8)
    s_barrier
    s_add_u32 m0, s50, s5
    s_nop 0
    buffer_load_dwordx4 v8, s[40:43], s48 offen offset:0 sc1 lds
    buffer_load_dwordx4 v8, s[40:43], s48 offen offset:1024 sc1 lds
    buffer_load_dwordx4 v8, s[40:43], s48 offen offset:2048 sc1 lds
    buffer_load_dwordx4 v8, s[40:43], s48 offen offset:3072 sc1 lds
    s_add_u32 m0, s50, s6
    s_nop 0
    buffer_load_dwordx4 v8, s[44:47], s49 offen offset:0 sc1 lds
    buffer_load_dwordx4 v8, s[44:47], s49 offen offset:1024 sc1 lds
    buffer_load_dwordx4 v8, s[44:47], s49 offen offset:2048 sc1 lds
    buffer_load_dwordx4 v8, s[44:47], s49 offen offset:3072 sc1 lds
    s_add_u32 s48, s48, 4096
    s_add_u32 s49, s49, 16384
    s_add_u32 s50, s50, 32768
    s_cmp_eq_u32 s50, 163840
    s_cselect_b32 s50, 0, s50
    s_add_u32 m0, s50, s5
    s_nop 0
    buffer_load_dwordx4 v8, s[40:43], s48 offen offset:0 sc1 lds
    buffer_load_dwordx4 v8, s[40:43], s48 offen offset:1024 sc1 lds
    buffer_load_dwordx4 v8, s[40:43], s48 offen offset:2048 sc1 lds
    buffer_load_dwordx4 v8, s[40:43], s48 offen offset:3072 sc1 lds
    s_add_u32 m0, s50, s6
    s_nop 0
    buffer_load_dwordx4 v8, s[44:47], s49 offen offset:0 sc1 lds
    buffer_load_dwordx4 v8, s[44:47], s49 offen offset:1024 sc1 lds
    buffer_load_dwordx4 v8, s[44:47], s49 offen offset:2048 sc1 lds
    buffer_load_dwordx4 v8, s[44:47], s49 offen offset:3072 sc1 lds
    s_add_u32 s48, s48, 4096
    s_add_u32 s49, s49, 16384
    s_add_u32 s50, s50, 32768
    s_cmp_eq_u32 s50, 163840
    s_cselect_b32 s50, 0, s50
    s_waitcnt vmcnt(20)
    s_barrier
    s_add_u32 m0, s50, s5
    s_nop 0
    buffer_load_dwordx4 v8, s[40:43], s48 offen offset:0 sc1 lds
    buffer_load_dwordx4 v8, s[40:43], s48 offen offset:1024 sc1 lds
    buffer_load_dwordx4 v8, s[40:43], s48 offen offset:2048 sc1 lds
    buffer_load_dwordx4 v8, s[40:43], s48 offen offset:3072 sc1 lds
    s_add_u32 m0, s50, s6
    s_nop 0
    buffer_load_dwordx4 v8, s[44:47], s49 offen offset:0 sc1 lds
    buffer_load_dwordx4 v8, s[44:47], s49 offen offset:1024 sc1 lds
    buffer_load_dwordx4 v8, s[44:47], s49 offen offset:2048 sc1 lds
    buffer_load_dwordx4 v8, s[44:47], s49 offen offset:3072 sc1 lds
    s_add_u32 s48, s48, 4096
    s_add_u32 s49, s49, 16384
    s_add_u32 s50, s50, 32768
    s_cmp_eq_u32 s50, 163840
    s_cselect_b32 s50, 0, s50
    s_mov_b32 s51, 21
L_w2b_ld_loop:
    s_waitcnt vmcnt(24)
    s_barrier
    s_add_u32 m0, s50, s5
    s_nop 0
    buffer_load_dwordx4 v8, s[40:43], s48 offen offset:0 sc1 lds
    buffer_load_dwordx4 v8, s[40:43], s48 offen offset:1024 sc1 lds
    buffer_load_dwordx4 v8, s[40:43], s48 offen offset:2048 sc1 lds
    buffer_load_dwordx4 v8, s[40:43], s48 offen offset:3072 sc1 lds
    s_add_u32 m0, s50, s6
    s_nop 0
    buffer_load_dwordx4 v8, s[44:47], s49 offen offset:0 sc1 lds
    buffer_load_dwordx4 v8, s[44:47], s49 offen offset:1024 sc1 lds
    buffer_load_dwordx4 v8, s[44:47], s49 offen offset:2048 sc1 lds
    buffer_load_dwordx4 v8, s[44:47], s49 offen offset:3072 sc1 lds
    s_add_u32 s48, s48, 4096
    s_add_u32 s49, s49, 16384
    s_add_u32 s50, s50, 32768
    s_cmp_eq_u32 s50, 163840
    s_cselect_b32 s50, 0, s50
    s_sub_u32 s51, s51, 1
    s_cmp_lg_u32 s51, 0
    s_cbranch_scc1 L_w2b_ld_loop
    s_waitcnt vmcnt(24)
    s_barrier
    s_waitcnt vmcnt(16)
    s_barrier
    s_waitcnt vmcnt(8)
    s_barrier
    s_waitcnt vmcnt(0)
    s_barrier
    s_branch L_rest_kernel_j3
L_rest_kernel_c3:
    s_and_b32 s4, s2, 7
    s_lshr_b32 s5, s2, 3
    s_and_b32 s6, s4, 1
    s_lshr_b32 s7, s4, 1
    s_mul_i32 s9, s6, 8
    s_and_b32 s6, s5, 7
    s_add_u32 s9, s9, s6
    s_mul_i32 s8, s7, 4
    s_lshr_b32 s6, s5, 3
    s_add_u32 s8, s8, s6
    s_and_b32 s11, s10, 1
    s_lshr_b32 s12, s10, 1
    s_mov_b32 s14, s10
    s_mov_b32 s15, s10
    v_and_b32 v2, 31, v0
    v_lshrrev_b32 v3, 5, v0
    s_lshl_b32 s6, s14, 12
    s_lshl_b32 s7, s15, 12
    v_lshlrev_b32 v4, 4, v0
    v_add_u32 v8, s6, v4
    v_add_u32 v9, s7, v4
    s_mov_b32 s4, 0
    s_add_u32 s4, s4, 16384
    v_add_u32 v24, s4, v4
    v_mov_b32 v60, 0
    v_mov_b32 v61, 0
    v_mov_b32 v62, 0
    v_mov_b32 v63, 0
    v_mov_b32 v64, 0
    v_mov_b32 v65, 0
    v_mov_b32 v66, 0
    v_mov_b32 v67, 0
    v_mov_b32 v68, 0
    v_mov_b32 v69, 0
    v_mov_b32 v70, 0
    v_mov_b32 v71, 0
    v_mov_b32 v72, 0
    v_mov_b32 v73, 0
    v_mov_b32 v74, 0
    v_mov_b32 v75, 0
    v_mov_b32 v76, 0
    v_mov_b32 v77, 0
    v_mov_b32 v78, 0
    v_mov_b32 v79, 0
    v_mov_b32 v80, 0
    v_mov_b32 v81, 0
    v_mov_b32 v82, 0
    v_mov_b32 v83, 0
    v_mov_b32 v84, 0
    v_mov_b32 v85, 0
    v_mov_b32 v86, 0
    v_mov_b32 v87, 0
    v_mov_b32 v88, 0
    v_mov_b32 v89, 0
    v_mov_b32 v90, 0
    v_mov_b32 v91, 0
    s_waitcnt lgkmcnt(0)
    s_mov_b32 s13, 0
    s_mov_b32 s51, 15
    v_add_u32 v16, s13, v8
    v_add_u32 v26, s13, v24
    s_add_u32 s13, s13, 24576
    s_cmp_eq_u32 s13, 147456
    s_cselect_b32 s13, 0, s13
    s_barrier
    ds_read_b128 v[36:39], v16 offset:0
    ds_read_b128 v[40:43], v26 offset:0
    ds_read_b128 v[44:47], v26 offset:1024
    s_add_u32 s40, s36, 37748736
    s_addc_u32 s41, s37, 0
    s_mov_b32 s42, 4194304
    s_mov_b32 s43, 0x20000
    s_mov_b32 s59, s9
    s_lshl_b32 s4, s8, 2
    s_add_u32 s58, s4, s14
    s_lshl_b32 s4, s58, 16
    s_lshl_b32 s5, s59, 7
    s_add_u32 s56, s4, s5
    s_lshl_b32 s6, s59, 12
    s_add_u32 s57, s4, s6
    v_lshlrev_b32 v124, 11, v2
    v_lshl_add_u32 v124, v3, 3, v124
    v_lshlrev_b32 v125, 4, v0
    buffer_load_dwordx4 v[92:95], v125, s[40:43], s57 offen offset:0 sc1
    buffer_load_dwordx4 v[96:99], v125, s[40:43], s57 offen offset:1024 sc1
    buffer_load_dwordx4 v[100:103], v125, s[40:43], s57 offen offset:2048 sc1
    buffer_load_dwordx4 v[104:107], v125, s[40:43], s57 offen offset:3072 sc1
L_wo2_c_loop:
    s_waitcnt lgkmcnt(1)
    v_mfma_f32_32x32x16_bf16 v[60:75], v[40:43], v[36:39], v[60:75]
    ds_read_b128 v[48:51], v16 offset:1024
    ds_read_b128 v[52:55], v26 offset:2048
    s_waitcnt lgkmcnt(2)
    v_mfma_f32_32x32x16_bf16 v[76:91], v[44:47], v[36:39], v[76:91]
    ds_read_b128 v[56:59], v26 offset:3072
    s_waitcnt lgkmcnt(1)
    v_mfma_f32_32x32x16_bf16 v[60:75], v[52:55], v[48:51], v[60:75]
    ds_read_b128 v[36:39], v16 offset:2048
    ds_read_b128 v[40:43], v26 offset:4096
    s_waitcnt lgkmcnt(2)
    v_mfma_f32_32x32x16_bf16 v[76:91], v[56:59], v[48:51], v[76:91]
    ds_read_b128 v[44:47], v26 offset:5120
    s_waitcnt lgkmcnt(1)
    v_mfma_f32_32x32x16_bf16 v[60:75], v[40:43], v[36:39], v[60:75]
    ds_read_b128 v[48:51], v16 offset:3072
    ds_read_b128 v[52:55], v26 offset:6144
    s_waitcnt lgkmcnt(2)
    v_mfma_f32_32x32x16_bf16 v[76:91], v[44:47], v[36:39], v[76:91]
    ds_read_b128 v[56:59], v26 offset:7168
    s_waitcnt lgkmcnt(0)
    v_add_u32 v16, s13, v8
    v_add_u32 v26, s13, v24
    s_add_u32 s13, s13, 24576
    s_cmp_eq_u32 s13, 147456
    s_cselect_b32 s13, 0, s13
    s_barrier
    v_mfma_f32_32x32x16_bf16 v[60:75], v[52:55], v[48:51], v[60:75]
    ds_read_b128 v[36:39], v16 offset:0
    ds_read_b128 v[40:43], v26 offset:0
    v_mfma_f32_32x32x16_bf16 v[76:91], v[56:59], v[48:51], v[76:91]
    ds_read_b128 v[44:47], v26 offset:1024
    s_sub_u32 s51, s51, 1
    s_cmp_lg_u32 s51, 0
    s_cbranch_scc1 L_wo2_c_loop
    s_waitcnt lgkmcnt(1)
    v_mfma_f32_32x32x16_bf16 v[60:75], v[40:43], v[36:39], v[60:75]
    ds_read_b128 v[48:51], v16 offset:1024
    ds_read_b128 v[52:55], v26 offset:2048
    s_waitcnt lgkmcnt(2)
    v_mfma_f32_32x32x16_bf16 v[76:91], v[44:47], v[36:39], v[76:91]
    ds_read_b128 v[56:59], v26 offset:3072
    s_waitcnt lgkmcnt(1)
    v_mfma_f32_32x32x16_bf16 v[60:75], v[52:55], v[48:51], v[60:75]
    ds_read_b128 v[36:39], v16 offset:2048
    ds_read_b128 v[40:43], v26 offset:4096
    s_waitcnt lgkmcnt(2)
    v_mfma_f32_32x32x16_bf16 v[76:91], v[56:59], v[48:51], v[76:91]
    ds_read_b128 v[44:47], v26 offset:5120
    s_waitcnt lgkmcnt(1)
    v_mfma_f32_32x32x16_bf16 v[60:75], v[40:43], v[36:39], v[60:75]
    ds_read_b128 v[48:51], v16 offset:3072
    ds_read_b128 v[52:55], v26 offset:6144
    s_waitcnt lgkmcnt(2)
    v_mfma_f32_32x32x16_bf16 v[76:91], v[44:47], v[36:39], v[76:91]
    ds_read_b128 v[56:59], v26 offset:7168
    s_waitcnt lgkmcnt(1)
    v_mfma_f32_32x32x16_bf16 v[60:75], v[52:55], v[48:51], v[60:75]
    s_waitcnt lgkmcnt(0)
    v_mfma_f32_32x32x16_bf16 v[76:91], v[56:59], v[48:51], v[76:91]
    s_waitcnt vmcnt(0)
    v_lshlrev_b32 v6, 16, v92
    v_and_b32 v7, 0xffff0000, v92
    s_nop 6
    v_pk_add_f32 v[60:61], v[60:61], v[6:7]
    v_lshlrev_b32 v6, 16, v93
    v_and_b32 v7, 0xffff0000, v93
    v_pk_add_f32 v[62:63], v[62:63], v[6:7]
    v_lshlrev_b32 v6, 16, v94
    v_and_b32 v7, 0xffff0000, v94
    v_pk_add_f32 v[64:65], v[64:65], v[6:7]
    v_lshlrev_b32 v6, 16, v95
    v_and_b32 v7, 0xffff0000, v95
    v_pk_add_f32 v[66:67], v[66:67], v[6:7]
    v_lshlrev_b32 v6, 16, v96
    v_and_b32 v7, 0xffff0000, v96
    v_pk_add_f32 v[68:69], v[68:69], v[6:7]
    v_lshlrev_b32 v6, 16, v97
    v_and_b32 v7, 0xffff0000, v97
    v_pk_add_f32 v[70:71], v[70:71], v[6:7]
    v_lshlrev_b32 v6, 16, v98
    v_and_b32 v7, 0xffff0000, v98
    v_pk_add_f32 v[72:73], v[72:73], v[6:7]
    v_lshlrev_b32 v6, 16, v99
    v_and_b32 v7, 0xffff0000, v99
    v_pk_add_f32 v[74:75], v[74:75], v[6:7]
    v_lshlrev_b32 v6, 16, v100
    v_and_b32 v7, 0xffff0000, v100
    v_pk_add_f32 v[76:77], v[76:77], v[6:7]
    v_lshlrev_b32 v6, 16, v101
    v_and_b32 v7, 0xffff0000, v101
    v_pk_add_f32 v[78:79], v[78:79], v[6:7]
    v_lshlrev_b32 v6, 16, v102
    v_and_b32 v7, 0xffff0000, v102
    v_pk_add_f32 v[80:81], v[80:81], v[6:7]
    v_lshlrev_b32 v6, 16, v103
    v_and_b32 v7, 0xffff0000, v103
    v_pk_add_f32 v[82:83], v[82:83], v[6:7]
    v_lshlrev_b32 v6, 16, v104
    v_and_b32 v7, 0xffff0000, v104
    v_pk_add_f32 v[84:85], v[84:85], v[6:7]
    v_lshlrev_b32 v6, 16, v105
    v_and_b32 v7, 0xffff0000, v105
    v_pk_add_f32 v[86:87], v[86:87], v[6:7]
    v_lshlrev_b32 v6, 16, v106
    v_and_b32 v7, 0xffff0000, v106
    v_pk_add_f32 v[88:89], v[88:89], v[6:7]
    v_lshlrev_b32 v6, 16, v107
    v_and_b32 v7, 0xffff0000, v107
    v_pk_add_f32 v[90:91], v[90:91], v[6:7]
    s_add_u32 s48, s36, 41943040
    s_addc_u32 s49, s37, 0
    s_mov_b32 s50, 4194304
    s_mov_b32 s51, 0x20000
    v_cvt_pk_bf16_f32 v36, v60, v61
    v_cvt_pk_bf16_f32 v37, v62, v63
    v_cvt_pk_bf16_f32 v38, v64, v65
    v_cvt_pk_bf16_f32 v39, v66, v67
    v_cvt_pk_bf16_f32 v40, v68, v69
    v_cvt_pk_bf16_f32 v41, v70, v71
    v_cvt_pk_bf16_f32 v42, v72, v73
    v_cvt_pk_bf16_f32 v43, v74, v75
    buffer_store_dwordx4 v[36:39], v125, s[48:51], s57 offen offset:0 sc1
    buffer_store_dwordx4 v[40:43], v125, s[48:51], s57 offen offset:1024 sc1
    v_cvt_pk_bf16_f32 v44, v76, v77
    v_cvt_pk_bf16_f32 v45, v78, v79
    v_cvt_pk_bf16_f32 v46, v80, v81
    v_cvt_pk_bf16_f32 v47, v82, v83
    v_cvt_pk_bf16_f32 v48, v84, v85
    v_cvt_pk_bf16_f32 v49, v86, v87
    v_cvt_pk_bf16_f32 v50, v88, v89
    v_cvt_pk_bf16_f32 v51, v90, v91
    buffer_store_dwordx4 v[44:47], v125, s[48:51], s57 offen offset:2048 sc1
    buffer_store_dwordx4 v[48:51], v125, s[48:51], s57 offen offset:3072 sc1
    v_pk_add_f32 v[92:93], v[60:61], v[76:77]
    v_pk_mul_f32 v[94:95], v[60:61], v[60:61]
    v_pk_fma_f32 v[94:95], v[76:77], v[76:77], v[94:95]
    v_pk_add_f32 v[92:93], v[92:93], v[62:63]
    v_pk_fma_f32 v[94:95], v[62:63], v[62:63], v[94:95]
    v_pk_add_f32 v[92:93], v[92:93], v[78:79]
    v_pk_fma_f32 v[94:95], v[78:79], v[78:79], v[94:95]
    v_pk_add_f32 v[92:93], v[92:93], v[64:65]
    v_pk_fma_f32 v[94:95], v[64:65], v[64:65], v[94:95]
    v_pk_add_f32 v[92:93], v[92:93], v[80:81]
    v_pk_fma_f32 v[94:95], v[80:81], v[80:81], v[94:95]
    v_pk_add_f32 v[92:93], v[92:93], v[66:67]
    v_pk_fma_f32 v[94:95], v[66:67], v[66:67], v[94:95]
    v_pk_add_f32 v[92:93], v[92:93], v[82:83]
    v_pk_fma_f32 v[94:95], v[82:83], v[82:83], v[94:95]
    v_pk_add_f32 v[92:93], v[92:93], v[68:69]
    v_pk_fma_f32 v[94:95], v[68:69], v[68:69], v[94:95]
    v_pk_add_f32 v[92:93], v[92:93], v[84:85]
    v_pk_fma_f32 v[94:95], v[84:85], v[84:85], v[94:95]
    v_pk_add_f32 v[92:93], v[92:93], v[70:71]
    v_pk_fma_f32 v[94:95], v[70:71], v[70:71], v[94:95]
    v_pk_add_f32 v[92:93], v[92:93], v[86:87]
    v_pk_fma_f32 v[94:95], v[86:87], v[86:87], v[94:95]
    v_pk_add_f32 v[92:93], v[92:93], v[72:73]
    v_pk_fma_f32 v[94:95], v[72:73], v[72:73], v[94:95]
    v_pk_add_f32 v[92:93], v[92:93], v[88:89]
    v_pk_fma_f32 v[94:95], v[88:89], v[88:89], v[94:95]
    v_pk_add_f32 v[92:93], v[92:93], v[74:75]
    v_pk_fma_f32 v[94:95], v[74:75], v[74:75], v[94:95]
    v_pk_add_f32 v[92:93], v[92:93], v[90:91]
    v_pk_fma_f32 v[94:95], v[90:91], v[90:91], v[94:95]
    s_add_u32 s40, s36, 47710208
    s_addc_u32 s41, s37, 0
    s_mov_b32 s42, 262144
    s_mov_b32 s43, 0x20000
    v_add_f32 v92, v92, v93
    v_add_f32 v93, v94, v95
    v_mov_b32 v94, v92
    v_mov_b32 v95, v93
    s_nop 0
    v_permlane32_swap_b32 v92, v94
    v_permlane32_swap_b32 v93, v95
    v_pk_add_f32 v[92:93], v[92:93], v[94:95]
    s_lshl_b32 s4, s59, 14
    s_lshl_b32 s5, s58, 8
    s_add_u32 s4, s4, s5
    v_lshlrev_b32 v4, 3, v2
    buffer_store_dwordx2 v[92:93], v4, s[40:43], s4 offen sc1
    s_add_u32 s52, s36, 49283072
    s_addc_u32 s53, s37, 0
    s_mov_b32 s54, 1048576
    s_mov_b32 s55, 0x20000
    s_lshl_b32 s4, s58, 11
    s_mov_b32 s5, s59
    v_and_b32 v4, 15, v0
    v_lshlrev_b32 v4, 7, v4
    s_lshl_b32 s5, s5, 2
    s_add_u32 s4, s4, s5
    s_add_u32 s4, s4, 131072
    v_mov_b32 v5, 1
    s_waitcnt vmcnt(0)
    s_mov_b64 exec, 0xffff
    buffer_store_dword v5, v4, s[52:55], s4 offen sc1
    s_mov_b64 exec, -1
    s_barrier
L_wo2_dend:
    s_and_b32 s4, s2, 7
    s_lshr_b32 s5, s2, 3
    s_and_b32 s6, s4, 3
    s_lshr_b32 s7, s4, 2
    s_mul_i32 s9, s6, 4
    s_and_b32 s6, s5, 3
    s_add_u32 s9, s9, s6
    s_mul_i32 s8, s7, 8
    s_lshr_b32 s6, s5, 2
    s_add_u32 s8, s8, s6
    s_and_b32 s11, s10, 1
    s_lshr_b32 s12, s10, 1
    s_lshl_b32 s14, s11, 1
    s_add_u32 s14, s14, s12
    s_xor_b32 s15, s14, 1
    v_and_b32 v2, 31, v0
    v_lshrrev_b32 v3, 5, v0
    s_lshl_b32 s6, s14, 12
    s_lshl_b32 s7, s15, 12
    v_lshlrev_b32 v4, 4, v0
    v_add_u32 v8, s6, v4
    v_add_u32 v9, s7, v4
    s_mul_i32 s4, s12, 3072
    v_add_u32 v25, 22528, v4
    s_add_u32 s4, s4, 16384
    v_add_u32 v24, s4, v4
    v_mov_b32 v84, 0
    v_mov_b32 v85, 0
    v_mov_b32 v86, 0
    v_mov_b32 v87, 0
    v_mov_b32 v88, 0
    v_mov_b32 v89, 0
    v_mov_b32 v90, 0
    v_mov_b32 v91, 0
    v_mov_b32 v92, 0
    v_mov_b32 v93, 0
    v_mov_b32 v94, 0
    v_mov_b32 v95, 0
    v_mov_b32 v96, 0
    v_mov_b32 v97, 0
    v_mov_b32 v98, 0
    v_mov_b32 v99, 0
    v_mov_b32 v100, 0
    v_mov_b32 v101, 0
    v_mov_b32 v102, 0
    v_mov_b32 v103, 0
    v_mov_b32 v104, 0
    v_mov_b32 v105, 0
    v_mov_b32 v106, 0
    v_mov_b32 v107, 0
    v_mov_b32 v108, 0
    v_mov_b32 v109, 0
    v_mov_b32 v110, 0
    v_mov_b32 v111, 0
    v_mov_b32 v112, 0
    v_mov_b32 v113, 0
    v_mov_b32 v114, 0
    v_mov_b32 v115, 0
    v_mov_b32 v116, 0
    v_mov_b32 v117, 0
    v_mov_b32 v118, 0
    v_mov_b32 v119, 0
    v_mov_b32 v120, 0
    v_mov_b32 v121, 0
    v_mov_b32 v122, 0
    v_mov_b32 v123, 0
    v_mov_b32 v124, 0
    v_mov_b32 v125, 0
    v_mov_b32 v126, 0
    v_mov_b32 v127, 0
    v_mov_b32 v128, 0
    v_mov_b32 v129, 0
    v_mov_b32 v130, 0
    v_mov_b32 v131, 0
    v_mov_b32 v132, 0
    v_mov_b32 v133, 0
    v_mov_b32 v134, 0
    v_mov_b32 v135, 0
    v_mov_b32 v136, 0
    v_mov_b32 v137, 0
    v_mov_b32 v138, 0
    v_mov_b32 v139, 0
    v_mov_b32 v140, 0
    v_mov_b32 v141, 0
    v_mov_b32 v142, 0
    v_mov_b32 v143, 0
    v_mov_b32 v144, 0
    v_mov_b32 v145, 0
    v_mov_b32 v146, 0
    v_mov_b32 v147, 0
    v_mov_b32 v148, 0
    v_mov_b32 v149, 0
    v_mov_b32 v150, 0
    v_mov_b32 v151, 0
    v_mov_b32 v152, 0
    v_mov_b32 v153, 0
    v_mov_b32 v154, 0
    v_mov_b32 v155, 0
    v_mov_b32 v156, 0
    v_mov_b32 v157, 0
    v_mov_b32 v158, 0
    v_mov_b32 v159, 0
    v_mov_b32 v160, 0
    v_mov_b32 v161, 0
    v_mov_b32 v162, 0
    v_mov_b32 v163, 0
    v_mov_b32 v164, 0
    v_mov_b32 v165, 0
    v_mov_b32 v166, 0
    v_mov_b32 v167, 0
    v_mov_b32 v168, 0
    v_mov_b32 v169, 0
    v_mov_b32 v170, 0
    v_mov_b32 v171, 0
    v_mov_b32 v172, 0
    v_mov_b32 v173, 0
    v_mov_b32 v174, 0
    v_mov_b32 v175, 0
    v_mov_b32 v176, 0
    v_mov_b32 v177, 0
    v_mov_b32 v178, 0
    v_mov_b32 v179, 0
    v_mov_b32 v180, 0
    v_mov_b32 v181, 0
    v_mov_b32 v182, 0
    v_mov_b32 v183, 0
    v_mov_b32 v184, 0
    v_mov_b32 v185, 0
    v_mov_b32 v186, 0
    v_mov_b32 v187, 0
    v_mov_b32 v188, 0
    v_mov_b32 v189, 0
    v_mov_b32 v190, 0
    v_mov_b32 v191, 0
    v_mov_b32 v192, 0
    v_mov_b32 v193, 0
    v_mov_b32 v194, 0
    v_mov_b32 v195, 0
    s_waitcnt lgkmcnt(0)
    s_mul_i32 s4, s9, 896
    s_mul_i32 s5, s12, 384
    s_add_u32 s56, s4, s5
    s_add_u32 s57, s56, 128
    s_add_u32 s58, s56, 256
    s_add_u32 s59, s4, 768
    s_mov_b32 s40, s26
    s_mov_b32 s41, s27
    s_mov_b32 s42, 7168
    s_mov_b32 s43, 0x20000
    s_lshr_b32 s5, s56, 1
    s_lshr_b32 s4, s59, 1
    v_lshlrev_b32 v4, 1, v2
    buffer_load_ushort v32, v4, s[40:43], s5 offen
    buffer_load_ushort v33, v4, s[40:43], s5 offen offset:64
    buffer_load_ushort v34, v4, s[40:43], s5 offen offset:128
    buffer_load_ushort v35, v4, s[40:43], s4 offen
    s_mov_b32 s13, 0
    s_mov_b32 s51, 15
    v_add_u32 v16, s13, v8
    v_add_u32 v17, s13, v9
    v_add_u32 v26, s13, v24
    v_add_u32 v27, s13, v25
    s_add_u32 s13, s13, 45056
    s_cmp_eq_u32 s13, 135168
    s_cselect_b32 s13, 0, s13
    s_barrier
    ds_read_b128 v[36:39], v16 offset:0
    ds_read_b128 v[44:47], v26 offset:0
    ds_read_b128 v[40:43], v17 offset:0
    ds_read_b128 v[48:51], v26 offset:1024
    ds_read_b128 v[52:55], v26 offset:2048
    ds_read_b128 v[56:59], v27 offset:0
L_w1b_c_loop:
    s_waitcnt lgkmcnt(4)
    v_mfma_f32_32x32x16_bf16 v[84:99], v[44:47], v[36:39], v[84:99]
    ds_read_b128 v[60:63], v16 offset:1024
    ds_read_b128 v[68:71], v26 offset:7168
    s_waitcnt lgkmcnt(5)
    v_mfma_f32_32x32x16_bf16 v[100:115], v[44:47], v[40:43], v[100:115]
    ds_read_b128 v[64:67], v17 offset:1024
    ds_read_b128 v[72:75], v26 offset:8192
    s_waitcnt lgkmcnt(6)
    v_mfma_f32_32x32x16_bf16 v[116:131], v[48:51], v[36:39], v[116:131]
    ds_read_b128 v[76:79], v26 offset:9216
    ds_read_b128 v[80:83], v27 offset:7168
    v_mfma_f32_32x32x16_bf16 v[132:147], v[48:51], v[40:43], v[132:147]
    s_waitcnt lgkmcnt(7)
    v_mfma_f32_32x32x16_bf16 v[148:163], v[52:55], v[36:39], v[148:163]
    v_mfma_f32_32x32x16_bf16 v[164:179], v[52:55], v[40:43], v[164:179]
    s_waitcnt lgkmcnt(6)
    v_mfma_f32_32x32x16_bf16 v[180:195], v[56:59], v[36:39], v[180:195]
    s_waitcnt lgkmcnt(4)
    v_mfma_f32_32x32x16_bf16 v[84:99], v[68:71], v[60:63], v[84:99]
    ds_read_b128 v[36:39], v16 offset:2048
    ds_read_b128 v[44:47], v26 offset:14336
    s_waitcnt lgkmcnt(5)
    v_mfma_f32_32x32x16_bf16 v[100:115], v[68:71], v[64:67], v[100:115]
    ds_read_b128 v[40:43], v17 offset:2048
    ds_read_b128 v[48:51], v26 offset:15360
    s_waitcnt lgkmcnt(6)
    v_mfma_f32_32x32x16_bf16 v[116:131], v[72:75], v[60:63], v[116:131]
    ds_read_b128 v[52:55], v26 offset:16384
    ds_read_b128 v[56:59], v27 offset:14336
    v_mfma_f32_32x32x16_bf16 v[132:147], v[72:75], v[64:67], v[132:147]
    s_waitcnt lgkmcnt(7)
    v_mfma_f32_32x32x16_bf16 v[148:163], v[76:79], v[60:63], v[148:163]
    v_mfma_f32_32x32x16_bf16 v[164:179], v[76:79], v[64:67], v[164:179]
    s_waitcnt lgkmcnt(6)
    v_mfma_f32_32x32x16_bf16 v[180:195], v[80:83], v[60:63], v[180:195]
    s_waitcnt lgkmcnt(4)
    v_mfma_f32_32x32x16_bf16 v[84:99], v[44:47], v[36:39], v[84:99]
    ds_read_b128 v[60:63], v16 offset:3072
    ds_read_b128 v[68:71], v26 offset:21504
    s_waitcnt lgkmcnt(5)
    v_mfma_f32_32x32x16_bf16 v[100:115], v[44:47], v[40:43], v[100:115]
    ds_read_b128 v[64:67], v17 offset:3072
    ds_read_b128 v[72:75], v26 offset:22528
    s_waitcnt lgkmcnt(6)
    v_mfma_f32_32x32x16_bf16 v[116:131], v[48:51], v[36:39], v[116:131]
    ds_read_b128 v[76:79], v26 offset:23552
    ds_read_b128 v[80:83], v27 offset:21504
    v_mfma_f32_32x32x16_bf16 v[132:147], v[48:51], v[40:43], v[132:147]
    s_waitcnt lgkmcnt(7)
    v_mfma_f32_32x32x16_bf16 v[148:163], v[52:55], v[36:39], v[148:163]
    v_mfma_f32_32x32x16_bf16 v[164:179], v[52:55], v[40:43], v[164:179]
    s_waitcnt lgkmcnt(6)
    v_mfma_f32_32x32x16_bf16 v[180:195], v[56:59], v[36:39], v[180:195]
    s_waitcnt lgkmcnt(0)
    v_add_u32 v16, s13, v8
    v_add_u32 v17, s13, v9
    v_add_u32 v26, s13, v24
    v_add_u32 v27, s13, v25
    s_add_u32 s13, s13, 45056
    s_cmp_eq_u32 s13, 135168
    s_cselect_b32 s13, 0, s13
    s_barrier
    v_mfma_f32_32x32x16_bf16 v[84:99], v[68:71], v[60:63], v[84:99]
    ds_read_b128 v[36:39], v16 offset:0
    ds_read_b128 v[44:47], v26 offset:0
    v_mfma_f32_32x32x16_bf16 v[100:115], v[68:71], v[64:67], v[100:115]
    ds_read_b128 v[40:43], v17 offset:0
    ds_read_b128 v[48:51], v26 offset:1024
    v_mfma_f32_32x32x16_bf16 v[116:131], v[72:75], v[60:63], v[116:131]
    ds_read_b128 v[52:55], v26 offset:2048
    ds_read_b128 v[56:59], v27 offset:0
    v_mfma_f32_32x32x16_bf16 v[132:147], v[72:75], v[64:67], v[132:147]
    v_mfma_f32_32x32x16_bf16 v[148:163], v[76:79], v[60:63], v[148:163]
    v_mfma_f32_32x32x16_bf16 v[164:179], v[76:79], v[64:67], v[164:179]
    v_mfma_f32_32x32x16_bf16 v[180:195], v[80:83], v[60:63], v[180:195]
    s_sub_u32 s51, s51, 1
    s_cmp_lg_u32 s51, 0
    s_cbranch_scc1 L_w1b_c_loop
    s_waitcnt lgkmcnt(4)
    v_mfma_f32_32x32x16_bf16 v[84:99], v[44:47], v[36:39], v[84:99]
    ds_read_b128 v[60:63], v16 offset:1024
    ds_read_b128 v[68:71], v26 offset:7168
    s_waitcnt lgkmcnt(5)
    v_mfma_f32_32x32x16_bf16 v[100:115], v[44:47], v[40:43], v[100:115]
    ds_read_b128 v[64:67], v17 offset:1024
    ds_read_b128 v[72:75], v26 offset:8192
    s_waitcnt lgkmcnt(6)
    v_mfma_f32_32x32x16_bf16 v[116:131], v[48:51], v[36:39], v[116:131]
    ds_read_b128 v[76:79], v26 offset:9216
    ds_read_b128 v[80:83], v27 offset:7168
    v_mfma_f32_32x32x16_bf16 v[132:147], v[48:51], v[40:43], v[132:147]
    s_waitcnt lgkmcnt(7)
    v_mfma_f32_32x32x16_bf16 v[148:163], v[52:55], v[36:39], v[148:163]
    v_mfma_f32_32x32x16_bf16 v[164:179], v[52:55], v[40:43], v[164:179]
    s_waitcnt lgkmcnt(6)
    v_mfma_f32_32x32x16_bf16 v[180:195], v[56:59], v[36:39], v[180:195]
    s_waitcnt lgkmcnt(4)
    v_mfma_f32_32x32x16_bf16 v[84:99], v[68:71], v[60:63], v[84:99]
    ds_read_b128 v[36:39], v16 offset:2048
    ds_read_b128 v[44:47], v26 offset:14336
    s_waitcnt lgkmcnt(5)
    v_mfma_f32_32x32x16_bf16 v[100:115], v[68:71], v[64:67], v[100:115]
    ds_read_b128 v[40:43], v17 offset:2048
    ds_read_b128 v[48:51], v26 offset:15360
    s_waitcnt lgkmcnt(6)
    v_mfma_f32_32x32x16_bf16 v[116:131], v[72:75], v[60:63], v[116:131]
    ds_read_b128 v[52:55], v26 offset:16384
    ds_read_b128 v[56:59], v27 offset:14336
    v_mfma_f32_32x32x16_bf16 v[132:147], v[72:75], v[64:67], v[132:147]
    s_waitcnt lgkmcnt(7)
    v_mfma_f32_32x32x16_bf16 v[148:163], v[76:79], v[60:63], v[148:163]
    v_mfma_f32_32x32x16_bf16 v[164:179], v[76:79], v[64:67], v[164:179]
    s_waitcnt lgkmcnt(6)
    v_mfma_f32_32x32x16_bf16 v[180:195], v[80:83], v[60:63], v[180:195]
    s_waitcnt lgkmcnt(4)
    v_mfma_f32_32x32x16_bf16 v[84:99], v[44:47], v[36:39], v[84:99]
    ds_read_b128 v[60:63], v16 offset:3072
    ds_read_b128 v[68:71], v26 offset:21504
    s_waitcnt lgkmcnt(5)
    v_mfma_f32_32x32x16_bf16 v[100:115], v[44:47], v[40:43], v[100:115]
    ds_read_b128 v[64:67], v17 offset:3072
    ds_read_b128 v[72:75], v26 offset:22528
    s_waitcnt lgkmcnt(6)
    v_mfma_f32_32x32x16_bf16 v[116:131], v[48:51], v[36:39], v[116:131]
    ds_read_b128 v[76:79], v26 offset:23552
    ds_read_b128 v[80:83], v27 offset:21504
    v_mfma_f32_32x32x16_bf16 v[132:147], v[48:51], v[40:43], v[132:147]
    s_waitcnt lgkmcnt(7)
    v_mfma_f32_32x32x16_bf16 v[148:163], v[52:55], v[36:39], v[148:163]
    v_mfma_f32_32x32x16_bf16 v[164:179], v[52:55], v[40:43], v[164:179]
    s_waitcnt lgkmcnt(6)
    v_mfma_f32_32x32x16_bf16 v[180:195], v[56:59], v[36:39], v[180:195]
    s_waitcnt lgkmcnt(4)
    v_mfma_f32_32x32x16_bf16 v[84:99], v[68:71], v[60:63], v[84:99]
    s_waitcnt lgkmcnt(3)
    v_mfma_f32_32x32x16_bf16 v[100:115], v[68:71], v[64:67], v[100:115]
    s_waitcnt lgkmcnt(2)
    v_mfma_f32_32x32x16_bf16 v[116:131], v[72:75], v[60:63], v[116:131]
    v_mfma_f32_32x32x16_bf16 v[132:147], v[72:75], v[64:67], v[132:147]
    s_waitcnt lgkmcnt(1)
    v_mfma_f32_32x32x16_bf16 v[148:163], v[76:79], v[60:63], v[148:163]
    v_mfma_f32_32x32x16_bf16 v[164:179], v[76:79], v[64:67], v[164:179]
    s_waitcnt lgkmcnt(0)
    v_mfma_f32_32x32x16_bf16 v[180:195], v[80:83], v[60:63], v[180:195]
    s_lshl_b32 s4, s10, 11
    s_add_u32 s4, s4, 140288
    v_lshlrev_b32 v4, 2, v2
    v_add_u32 v4, s4, v4
    v_lshlrev_b32 v5, 4, v3
    v_add_u32 v5, s4, v5
    s_waitcnt vmcnt(0)
    v_lshlrev_b32 v32, 16, v32
    v_mul_f32 v32, 0x3eeff558, v32
    ds_write_b32 v4, v32 offset:512
    v_lshlrev_b32 v33, 16, v33
    v_mul_f32 v33, 0x3eeff558, v33
    ds_write_b32 v4, v33 offset:640
    v_lshlrev_b32 v34, 16, v34
    v_mul_f32 v34, 0x3eeff558, v34
    ds_write_b32 v4, v34 offset:768
    v_lshlrev_b32 v35, 16, v35
    v_mul_f32 v35, 0x3eeff558, v35
    ds_write_b32 v4, v35 offset:896
    s_mul_i32 s4, s12, 384
    s_add_u32 s4, s4, 148480
    v_lshlrev_b32 v28, 4, v3
    v_add_u32 v29, 149248, v28
    v_add_u32 v28, s4, v28
    s_waitcnt lgkmcnt(0)
    s_barrier
    s_add_u32 s40, s36, 117440512
    s_addc_u32 s41, s37, 0
    s_mov_b32 s42, 14680064
    s_mov_b32 s43, 0x20000
    v_mov_b32 v10, v8
    v_mov_b32 v11, v9
    s_lshl_b32 s4, s14, 7
    s_add_u32 s4, s4, 139264
    s_lshl_b32 s5, s15, 7
    s_add_u32 s5, s5, 139264
    v_lshlrev_b32 v7, 2, v2
    v_add_u32 v8, s4, v7
    v_add_u32 v9, s5, v7
    s_lshl_b32 s4, s8, 2
    s_add_u32 s6, s4, s14
    s_add_u32 s7, s4, s15
    s_mul_i32 s6, s6, 229376
    s_mul_i32 s7, s7, 229376
    s_mul_i32 s4, s9, 14336
    s_add_u32 s6, s6, s4
    s_add_u32 s7, s7, s4
    s_add_u32 s13, s6, 12288
    s_mul_i32 s4, s12, 6144
    s_add_u32 s14, s6, s4
    s_add_u32 s15, s7, s4
    v_lshlrev_b32 v6, 4, v0
    ds_read_b32 v196, v8
    ds_read_b32 v197, v8 offset:512
    ds_read_b32 v198, v9
    ds_read_b32 v199, v9 offset:512
    v_mov_b32 v200, 0x409d30fc
    v_mov_b32 v202, 0x3eeff558
    v_mov_b32 v201, 0x409d30fc
    v_mov_b32 v203, 0x3eeff558
    s_waitcnt lgkmcnt(0)
    v_mul_f32 v196, 0x3eeff558, v196
    v_mul_f32 v197, 0x3eeff558, v197
    v_mul_f32 v198, 0x3eeff558, v198
    v_mul_f32 v199, 0x3eeff558, v199
    ds_read_b128 v[36:39], v28 offset:0
    ds_read_b128 v[52:55], v5 offset:512
    ds_read_b128 v[40:43], v28 offset:32
    ds_read_b128 v[56:59], v5 offset:544
    ds_read_b128 v[44:47], v28 offset:64
    ds_read_b128 v[60:63], v5 offset:576
    ds_read_b128 v[48:51], v28 offset:96
    ds_read_b128 v[64:67], v5 offset:608
    s_waitcnt lgkmcnt(0)
    v_pk_fma_f32 v[208:209], v[36:37], v[196:197], v[52:53] op_sel:[0,1,0]
    v_pk_fma_f32 v[210:211], v[38:39], v[196:197], v[54:55] op_sel:[0,1,0]
    v_pk_fma_f32 v[212:213], v[40:41], v[196:197], v[56:57] op_sel:[0,1,0]
    v_pk_fma_f32 v[214:215], v[42:43], v[196:197], v[58:59] op_sel:[0,1,0]
    v_pk_fma_f32 v[216:217], v[44:45], v[196:197], v[60:61] op_sel:[0,1,0]
    v_pk_fma_f32 v[218:219], v[46:47], v[196:197], v[62:63] op_sel:[0,1,0]
    v_pk_fma_f32 v[220:221], v[48:49], v[196:197], v[64:65] op_sel:[0,1,0]
    v_pk_fma_f32 v[222:223], v[50:51], v[196:197], v[66:67] op_sel:[0,1,0]
    v_pk_fma_f32 v[84:85], v[84:85], v[196:197], v[208:209] op_sel_hi:[1,0,1]
    v_pk_fma_f32 v[86:87], v[86:87], v[196:197], v[210:211] op_sel_hi:[1,0,1]
    v_pk_fma_f32 v[88:89], v[88:89], v[196:197], v[212:213] op_sel_hi:[1,0,1]
    v_pk_fma_f32 v[90:91], v[90:91], v[196:197], v[214:215] op_sel_hi:[1,0,1]
    v_pk_fma_f32 v[92:93], v[92:93], v[196:197], v[216:217] op_sel_hi:[1,0,1]
    v_pk_fma_f32 v[94:95], v[94:95], v[196:197], v[218:219] op_sel_hi:[1,0,1]
    v_pk_fma_f32 v[96:97], v[96:97], v[196:197], v[220:221] op_sel_hi:[1,0,1]
    v_pk_fma_f32 v[98:99], v[98:99], v[196:197], v[222:223] op_sel_hi:[1,0,1]
    v_pk_fma_f32 v[208:209], v[84:85], v[84:85], v[200:201]
    v_pk_fma_f32 v[210:211], v[86:87], v[86:87], v[200:201]
    v_pk_fma_f32 v[212:213], v[88:89], v[88:89], v[200:201]
    v_pk_fma_f32 v[214:215], v[90:91], v[90:91], v[200:201]
    v_pk_fma_f32 v[216:217], v[92:93], v[92:93], v[200:201]
    v_pk_fma_f32 v[218:219], v[94:95], v[94:95], v[200:201]
    v_pk_fma_f32 v[220:221], v[96:97], v[96:97], v[200:201]
    v_pk_fma_f32 v[222:223], v[98:99], v[98:99], v[200:201]
    v_pk_mul_f32 v[208:209], v[208:209], v[84:85]
    v_pk_mul_f32 v[210:211], v[210:211], v[86:87]
    v_pk_mul_f32 v[212:213], v[212:213], v[88:89]
    v_pk_mul_f32 v[214:215], v[214:215], v[90:91]
    v_pk_mul_f32 v[216:217], v[216:217], v[92:93]
    v_pk_mul_f32 v[218:219], v[218:219], v[94:95]
    v_pk_mul_f32 v[220:221], v[220:221], v[96:97]
    v_pk_mul_f32 v[222:223], v[222:223], v[98:99]
    v_exp_f32_e64 v208, -v208
    v_exp_f32_e64 v209, -v209
    v_exp_f32_e64 v210, -v210
    v_exp_f32_e64 v211, -v211
    v_exp_f32_e64 v212, -v212
    v_exp_f32_e64 v213, -v213
    v_exp_f32_e64 v214, -v214
    v_exp_f32_e64 v215, -v215
    v_exp_f32_e64 v216, -v216
    v_exp_f32_e64 v217, -v217
    v_exp_f32_e64 v218, -v218
    v_exp_f32_e64 v219, -v219
    v_exp_f32_e64 v220, -v220
    v_exp_f32_e64 v221, -v221
    v_exp_f32_e64 v222, -v222
    v_exp_f32_e64 v223, -v223
    v_pk_fma_f32 v[208:209], v[208:209], v[202:203], v[202:203]
    v_pk_fma_f32 v[210:211], v[210:211], v[202:203], v[202:203]
    v_pk_fma_f32 v[212:213], v[212:213], v[202:203], v[202:203]
    v_pk_fma_f32 v[214:215], v[214:215], v[202:203], v[202:203]
    v_pk_fma_f32 v[216:217], v[216:217], v[202:203], v[202:203]
    v_pk_fma_f32 v[218:219], v[218:219], v[202:203], v[202:203]
    v_pk_fma_f32 v[220:221], v[220:221], v[202:203], v[202:203]
    v_pk_fma_f32 v[222:223], v[222:223], v[202:203], v[202:203]
    v_rcp_f32 v208, v208
    v_rcp_f32 v209, v209
    v_rcp_f32 v210, v210
    v_rcp_f32 v211, v211
    v_rcp_f32 v212, v212
    v_rcp_f32 v213, v213
    v_rcp_f32 v214, v214
    v_rcp_f32 v215, v215
    v_rcp_f32 v216, v216
    v_rcp_f32 v217, v217
    v_rcp_f32 v218, v218
    v_rcp_f32 v219, v219
    v_rcp_f32 v220, v220
    v_rcp_f32 v221, v221
    v_rcp_f32 v222, v222
    v_rcp_f32 v223, v223
    v_pk_mul_f32 v[208:209], v[84:85], v[208:209]
    v_pk_mul_f32 v[210:211], v[86:87], v[210:211]
    v_pk_mul_f32 v[212:213], v[88:89], v[212:213]
    v_pk_mul_f32 v[214:215], v[90:91], v[214:215]
    v_pk_mul_f32 v[216:217], v[92:93], v[216:217]
    v_pk_mul_f32 v[218:219], v[94:95], v[218:219]
    v_pk_mul_f32 v[220:221], v[96:97], v[220:221]
    v_pk_mul_f32 v[222:223], v[98:99], v[222:223]
    v_cvt_pk_bf16_f32 v84, v208, v209
    v_cvt_pk_bf16_f32 v85, v210, v211
    v_cvt_pk_bf16_f32 v86, v212, v213
    v_cvt_pk_bf16_f32 v87, v214, v215
    v_cvt_pk_bf16_f32 v88, v216, v217
    v_cvt_pk_bf16_f32 v89, v218, v219
    v_cvt_pk_bf16_f32 v90, v220, v221
    v_cvt_pk_bf16_f32 v91, v222, v223
    buffer_store_dwordx4 v[84:87], v6, s[40:43], s14 offen offset:0 sc1
    buffer_store_dwordx4 v[88:91], v6, s[40:43], s14 offen offset:1024 sc1
    v_pk_fma_f32 v[208:209], v[36:37], v[198:199], v[52:53] op_sel:[0,1,0]
    v_pk_fma_f32 v[210:211], v[38:39], v[198:199], v[54:55] op_sel:[0,1,0]
    v_pk_fma_f32 v[212:213], v[40:41], v[198:199], v[56:57] op_sel:[0,1,0]
    v_pk_fma_f32 v[214:215], v[42:43], v[198:199], v[58:59] op_sel:[0,1,0]
    v_pk_fma_f32 v[216:217], v[44:45], v[198:199], v[60:61] op_sel:[0,1,0]
    v_pk_fma_f32 v[218:219], v[46:47], v[198:199], v[62:63] op_sel:[0,1,0]
    v_pk_fma_f32 v[220:221], v[48:49], v[198:199], v[64:65] op_sel:[0,1,0]
    v_pk_fma_f32 v[222:223], v[50:51], v[198:199], v[66:67] op_sel:[0,1,0]
    v_pk_fma_f32 v[100:101], v[100:101], v[198:199], v[208:209] op_sel_hi:[1,0,1]
    v_pk_fma_f32 v[102:103], v[102:103], v[198:199], v[210:211] op_sel_hi:[1,0,1]
    v_pk_fma_f32 v[104:105], v[104:105], v[198:199], v[212:213] op_sel_hi:[1,0,1]
    v_pk_fma_f32 v[106:107], v[106:107], v[198:199], v[214:215] op_sel_hi:[1,0,1]
    v_pk_fma_f32 v[108:109], v[108:109], v[198:199], v[216:217] op_sel_hi:[1,0,1]
    v_pk_fma_f32 v[110:111], v[110:111], v[198:199], v[218:219] op_sel_hi:[1,0,1]
    v_pk_fma_f32 v[112:113], v[112:113], v[198:199], v[220:221] op_sel_hi:[1,0,1]
    v_pk_fma_f32 v[114:115], v[114:115], v[198:199], v[222:223] op_sel_hi:[1,0,1]
    v_pk_fma_f32 v[208:209], v[100:101], v[100:101], v[200:201]
    v_pk_fma_f32 v[210:211], v[102:103], v[102:103], v[200:201]
    v_pk_fma_f32 v[212:213], v[104:105], v[104:105], v[200:201]
    v_pk_fma_f32 v[214:215], v[106:107], v[106:107], v[200:201]
    v_pk_fma_f32 v[216:217], v[108:109], v[108:109], v[200:201]
    v_pk_fma_f32 v[218:219], v[110:111], v[110:111], v[200:201]
    v_pk_fma_f32 v[220:221], v[112:113], v[112:113], v[200:201]
    v_pk_fma_f32 v[222:223], v[114:115], v[114:115], v[200:201]
    v_pk_mul_f32 v[208:209], v[208:209], v[100:101]
    v_pk_mul_f32 v[210:211], v[210:211], v[102:103]
    v_pk_mul_f32 v[212:213], v[212:213], v[104:105]
    v_pk_mul_f32 v[214:215], v[214:215], v[106:107]
    v_pk_mul_f32 v[216:217], v[216:217], v[108:109]
    v_pk_mul_f32 v[218:219], v[218:219], v[110:111]
    v_pk_mul_f32 v[220:221], v[220:221], v[112:113]
    v_pk_mul_f32 v[222:223], v[222:223], v[114:115]
    v_exp_f32_e64 v208, -v208
    v_exp_f32_e64 v209, -v209
    v_exp_f32_e64 v210, -v210
    v_exp_f32_e64 v211, -v211
    v_exp_f32_e64 v212, -v212
    v_exp_f32_e64 v213, -v213
    v_exp_f32_e64 v214, -v214
    v_exp_f32_e64 v215, -v215
    v_exp_f32_e64 v216, -v216
    v_exp_f32_e64 v217, -v217
    v_exp_f32_e64 v218, -v218
    v_exp_f32_e64 v219, -v219
    v_exp_f32_e64 v220, -v220
    v_exp_f32_e64 v221, -v221
    v_exp_f32_e64 v222, -v222
    v_exp_f32_e64 v223, -v223
    v_pk_fma_f32 v[208:209], v[208:209], v[202:203], v[202:203]
    v_pk_fma_f32 v[210:211], v[210:211], v[202:203], v[202:203]
    v_pk_fma_f32 v[212:213], v[212:213], v[202:203], v[202:203]
    v_pk_fma_f32 v[214:215], v[214:215], v[202:203], v[202:203]
    v_pk_fma_f32 v[216:217], v[216:217], v[202:203], v[202:203]
    v_pk_fma_f32 v[218:219], v[218:219], v[202:203], v[202:203]
    v_pk_fma_f32 v[220:221], v[220:221], v[202:203], v[202:203]
    v_pk_fma_f32 v[222:223], v[222:223], v[202:203], v[202:203]
    v_rcp_f32 v208, v208
    v_rcp_f32 v209, v209
    v_rcp_f32 v210, v210
    v_rcp_f32 v211, v211
    v_rcp_f32 v212, v212
    v_rcp_f32 v213, v213
    v_rcp_f32 v214, v214
    v_rcp_f32 v215, v215
    v_rcp_f32 v216, v216
    v_rcp_f32 v217, v217
    v_rcp_f32 v218, v218
    v_rcp_f32 v219, v219
    v_rcp_f32 v220, v220
    v_rcp_f32 v221, v221
    v_rcp_f32 v222, v222
    v_rcp_f32 v223, v223
    v_pk_mul_f32 v[208:209], v[100:101], v[208:209]
    v_pk_mul_f32 v[210:211], v[102:103], v[210:211]
    v_pk_mul_f32 v[212:213], v[104:105], v[212:213]
    v_pk_mul_f32 v[214:215], v[106:107], v[214:215]
    v_pk_mul_f32 v[216:217], v[108:109], v[216:217]
    v_pk_mul_f32 v[218:219], v[110:111], v[218:219]
    v_pk_mul_f32 v[220:221], v[112:113], v[220:221]
    v_pk_mul_f32 v[222:223], v[114:115], v[222:223]
    v_cvt_pk_bf16_f32 v100, v208, v209
    v_cvt_pk_bf16_f32 v101, v210, v211
    v_cvt_pk_bf16_f32 v102, v212, v213
    v_cvt_pk_bf16_f32 v103, v214, v215
    v_cvt_pk_bf16_f32 v104, v216, v217
    v_cvt_pk_bf16_f32 v105, v218, v219
    v_cvt_pk_bf16_f32 v106, v220, v221
    v_cvt_pk_bf16_f32 v107, v222, v223
    buffer_store_dwordx4 v[100:103], v6, s[40:43], s15 offen offset:0 sc1
    buffer_store_dwordx4 v[104:107], v6, s[40:43], s15 offen offset:1024 sc1
    ds_read_b128 v[36:39], v28 offset:128
    ds_read_b128 v[52:55], v5 offset:640
    ds_read_b128 v[40:43], v28 offset:160
    ds_read_b128 v[56:59], v5 offset:672
    ds_read_b128 v[44:47], v28 offset:192
    ds_read_b128 v[60:63], v5 offset:704
    ds_read_b128 v[48:51], v28 offset:224
    ds_read_b128 v[64:67], v5 offset:736
    s_waitcnt lgkmcnt(0)
    v_pk_fma_f32 v[208:209], v[36:37], v[196:197], v[52:53] op_sel:[0,1,0]
    v_pk_fma_f32 v[210:211], v[38:39], v[196:197], v[54:55] op_sel:[0,1,0]
    v_pk_fma_f32 v[212:213], v[40:41], v[196:197], v[56:57] op_sel:[0,1,0]
    v_pk_fma_f32 v[214:215], v[42:43], v[196:197], v[58:59] op_sel:[0,1,0]
    v_pk_fma_f32 v[216:217], v[44:45], v[196:197], v[60:61] op_sel:[0,1,0]
    v_pk_fma_f32 v[218:219], v[46:47], v[196:197], v[62:63] op_sel:[0,1,0]
    v_pk_fma_f32 v[220:221], v[48:49], v[196:197], v[64:65] op_sel:[0,1,0]
    v_pk_fma_f32 v[222:223], v[50:51], v[196:197], v[66:67] op_sel:[0,1,0]
    v_pk_fma_f32 v[116:117], v[116:117], v[196:197], v[208:209] op_sel_hi:[1,0,1]
    v_pk_fma_f32 v[118:119], v[118:119], v[196:197], v[210:211] op_sel_hi:[1,0,1]
    v_pk_fma_f32 v[120:121], v[120:121], v[196:197], v[212:213] op_sel_hi:[1,0,1]
    v_pk_fma_f32 v[122:123], v[122:123], v[196:197], v[214:215] op_sel_hi:[1,0,1]
    v_pk_fma_f32 v[124:125], v[124:125], v[196:197], v[216:217] op_sel_hi:[1,0,1]
    v_pk_fma_f32 v[126:127], v[126:127], v[196:197], v[218:219] op_sel_hi:[1,0,1]
    v_pk_fma_f32 v[128:129], v[128:129], v[196:197], v[220:221] op_sel_hi:[1,0,1]
    v_pk_fma_f32 v[130:131], v[130:131], v[196:197], v[222:223] op_sel_hi:[1,0,1]
    v_pk_fma_f32 v[208:209], v[116:117], v[116:117], v[200:201]
    v_pk_fma_f32 v[210:211], v[118:119], v[118:119], v[200:201]
    v_pk_fma_f32 v[212:213], v[120:121], v[120:121], v[200:201]
    v_pk_fma_f32 v[214:215], v[122:123], v[122:123], v[200:201]
    v_pk_fma_f32 v[216:217], v[124:125], v[124:125], v[200:201]
    v_pk_fma_f32 v[218:219], v[126:127], v[126:127], v[200:201]
    v_pk_fma_f32 v[220:221], v[128:129], v[128:129], v[200:201]
    v_pk_fma_f32 v[222:223], v[130:131], v[130:131], v[200:201]
    v_pk_mul_f32 v[208:209], v[208:209], v[116:117]
    v_pk_mul_f32 v[210:211], v[210:211], v[118:119]
    v_pk_mul_f32 v[212:213], v[212:213], v[120:121]
    v_pk_mul_f32 v[214:215], v[214:215], v[122:123]
    v_pk_mul_f32 v[216:217], v[216:217], v[124:125]
    v_pk_mul_f32 v[218:219], v[218:219], v[126:127]
    v_pk_mul_f32 v[220:221], v[220:221], v[128:129]
    v_pk_mul_f32 v[222:223], v[222:223], v[130:131]
    v_exp_f32_e64 v208, -v208
    v_exp_f32_e64 v209, -v209
    v_exp_f32_e64 v210, -v210
    v_exp_f32_e64 v211, -v211
    v_exp_f32_e64 v212, -v212
    v_exp_f32_e64 v213, -v213
    v_exp_f32_e64 v214, -v214
    v_exp_f32_e64 v215, -v215
    v_exp_f32_e64 v216, -v216
    v_exp_f32_e64 v217, -v217
    v_exp_f32_e64 v218, -v218
    v_exp_f32_e64 v219, -v219
    v_exp_f32_e64 v220, -v220
    v_exp_f32_e64 v221, -v221
    v_exp_f32_e64 v222, -v222
    v_exp_f32_e64 v223, -v223
    v_pk_fma_f32 v[208:209], v[208:209], v[202:203], v[202:203]
    v_pk_fma_f32 v[210:211], v[210:211], v[202:203], v[202:203]
    v_pk_fma_f32 v[212:213], v[212:213], v[202:203], v[202:203]
    v_pk_fma_f32 v[214:215], v[214:215], v[202:203], v[202:203]
    v_pk_fma_f32 v[216:217], v[216:217], v[202:203], v[202:203]
    v_pk_fma_f32 v[218:219], v[218:219], v[202:203], v[202:203]
    v_pk_fma_f32 v[220:221], v[220:221], v[202:203], v[202:203]
    v_pk_fma_f32 v[222:223], v[222:223], v[202:203], v[202:203]
    v_rcp_f32 v208, v208
    v_rcp_f32 v209, v209
    v_rcp_f32 v210, v210
    v_rcp_f32 v211, v211
    v_rcp_f32 v212, v212
    v_rcp_f32 v213, v213
    v_rcp_f32 v214, v214
    v_rcp_f32 v215, v215
    v_rcp_f32 v216, v216
    v_rcp_f32 v217, v217
    v_rcp_f32 v218, v218
    v_rcp_f32 v219, v219
    v_rcp_f32 v220, v220
    v_rcp_f32 v221, v221
    v_rcp_f32 v222, v222
    v_rcp_f32 v223, v223
    v_pk_mul_f32 v[208:209], v[116:117], v[208:209]
    v_pk_mul_f32 v[210:211], v[118:119], v[210:211]
    v_pk_mul_f32 v[212:213], v[120:121], v[212:213]
    v_pk_mul_f32 v[214:215], v[122:123], v[214:215]
    v_pk_mul_f32 v[216:217], v[124:125], v[216:217]
    v_pk_mul_f32 v[218:219], v[126:127], v[218:219]
    v_pk_mul_f32 v[220:221], v[128:129], v[220:221]
    v_pk_mul_f32 v[222:223], v[130:131], v[222:223]
    v_cvt_pk_bf16_f32 v116, v208, v209
    v_cvt_pk_bf16_f32 v117, v210, v211
    v_cvt_pk_bf16_f32 v118, v212, v213
    v_cvt_pk_bf16_f32 v119, v214, v215
    v_cvt_pk_bf16_f32 v120, v216, v217
    v_cvt_pk_bf16_f32 v121, v218, v219
    v_cvt_pk_bf16_f32 v122, v220, v221
    v_cvt_pk_bf16_f32 v123, v222, v223
    buffer_store_dwordx4 v[116:119], v6, s[40:43], s14 offen offset:2048 sc1
    buffer_store_dwordx4 v[120:123], v6, s[40:43], s14 offen offset:3072 sc1
    v_pk_fma_f32 v[208:209], v[36:37], v[198:199], v[52:53] op_sel:[0,1,0]
    v_pk_fma_f32 v[210:211], v[38:39], v[198:199], v[54:55] op_sel:[0,1,0]
    v_pk_fma_f32 v[212:213], v[40:41], v[198:199], v[56:57] op_sel:[0,1,0]
    v_pk_fma_f32 v[214:215], v[42:43], v[198:199], v[58:59] op_sel:[0,1,0]
    v_pk_fma_f32 v[216:217], v[44:45], v[198:199], v[60:61] op_sel:[0,1,0]
    v_pk_fma_f32 v[218:219], v[46:47], v[198:199], v[62:63] op_sel:[0,1,0]
    v_pk_fma_f32 v[220:221], v[48:49], v[198:199], v[64:65] op_sel:[0,1,0]
    v_pk_fma_f32 v[222:223], v[50:51], v[198:199], v[66:67] op_sel:[0,1,0]
    v_pk_fma_f32 v[132:133], v[132:133], v[198:199], v[208:209] op_sel_hi:[1,0,1]
    v_pk_fma_f32 v[134:135], v[134:135], v[198:199], v[210:211] op_sel_hi:[1,0,1]
    v_pk_fma_f32 v[136:137], v[136:137], v[198:199], v[212:213] op_sel_hi:[1,0,1]
    v_pk_fma_f32 v[138:139], v[138:139], v[198:199], v[214:215] op_sel_hi:[1,0,1]
    v_pk_fma_f32 v[140:141], v[140:141], v[198:199], v[216:217] op_sel_hi:[1,0,1]
    v_pk_fma_f32 v[142:143], v[142:143], v[198:199], v[218:219] op_sel_hi:[1,0,1]
    v_pk_fma_f32 v[144:145], v[144:145], v[198:199], v[220:221] op_sel_hi:[1,0,1]
    v_pk_fma_f32 v[146:147], v[146:147], v[198:199], v[222:223] op_sel_hi:[1,0,1]
    v_pk_fma_f32 v[208:209], v[132:133], v[132:133], v[200:201]
    v_pk_fma_f32 v[210:211], v[134:135], v[134:135], v[200:201]
    v_pk_fma_f32 v[212:213], v[136:137], v[136:137], v[200:201]
    v_pk_fma_f32 v[214:215], v[138:139], v[138:139], v[200:201]
    v_pk_fma_f32 v[216:217], v[140:141], v[140:141], v[200:201]
    v_pk_fma_f32 v[218:219], v[142:143], v[142:143], v[200:201]
    v_pk_fma_f32 v[220:221], v[144:145], v[144:145], v[200:201]
    v_pk_fma_f32 v[222:223], v[146:147], v[146:147], v[200:201]
    v_pk_mul_f32 v[208:209], v[208:209], v[132:133]
    v_pk_mul_f32 v[210:211], v[210:211], v[134:135]
    v_pk_mul_f32 v[212:213], v[212:213], v[136:137]
    v_pk_mul_f32 v[214:215], v[214:215], v[138:139]
    v_pk_mul_f32 v[216:217], v[216:217], v[140:141]
    v_pk_mul_f32 v[218:219], v[218:219], v[142:143]
    v_pk_mul_f32 v[220:221], v[220:221], v[144:145]
    v_pk_mul_f32 v[222:223], v[222:223], v[146:147]
    v_exp_f32_e64 v208, -v208
    v_exp_f32_e64 v209, -v209
    v_exp_f32_e64 v210, -v210
    v_exp_f32_e64 v211, -v211
    v_exp_f32_e64 v212, -v212
    v_exp_f32_e64 v213, -v213
    v_exp_f32_e64 v214, -v214
    v_exp_f32_e64 v215, -v215
    v_exp_f32_e64 v216, -v216
    v_exp_f32_e64 v217, -v217
    v_exp_f32_e64 v218, -v218
    v_exp_f32_e64 v219, -v219
    v_exp_f32_e64 v220, -v220
    v_exp_f32_e64 v221, -v221
    v_exp_f32_e64 v222, -v222
    v_exp_f32_e64 v223, -v223
    v_pk_fma_f32 v[208:209], v[208:209], v[202:203], v[202:203]
    v_pk_fma_f32 v[210:211], v[210:211], v[202:203], v[202:203]
    v_pk_fma_f32 v[212:213], v[212:213], v[202:203], v[202:203]
    v_pk_fma_f32 v[214:215], v[214:215], v[202:203], v[202:203]
    v_pk_fma_f32 v[216:217], v[216:217], v[202:203], v[202:203]
    v_pk_fma_f32 v[218:219], v[218:219], v[202:203], v[202:203]
    v_pk_fma_f32 v[220:221], v[220:221], v[202:203], v[202:203]
    v_pk_fma_f32 v[222:223], v[222:223], v[202:203], v[202:203]
    v_rcp_f32 v208, v208
    v_rcp_f32 v209, v209
    v_rcp_f32 v210, v210
    v_rcp_f32 v211, v211
    v_rcp_f32 v212, v212
    v_rcp_f32 v213, v213
    v_rcp_f32 v214, v214
    v_rcp_f32 v215, v215
    v_rcp_f32 v216, v216
    v_rcp_f32 v217, v217
    v_rcp_f32 v218, v218
    v_rcp_f32 v219, v219
    v_rcp_f32 v220, v220
    v_rcp_f32 v221, v221
    v_rcp_f32 v222, v222
    v_rcp_f32 v223, v223
    v_pk_mul_f32 v[208:209], v[132:133], v[208:209]
    v_pk_mul_f32 v[210:211], v[134:135], v[210:211]
    v_pk_mul_f32 v[212:213], v[136:137], v[212:213]
    v_pk_mul_f32 v[214:215], v[138:139], v[214:215]
    v_pk_mul_f32 v[216:217], v[140:141], v[216:217]
    v_pk_mul_f32 v[218:219], v[142:143], v[218:219]
    v_pk_mul_f32 v[220:221], v[144:145], v[220:221]
    v_pk_mul_f32 v[222:223], v[146:147], v[222:223]
    v_cvt_pk_bf16_f32 v132, v208, v209
    v_cvt_pk_bf16_f32 v133, v210, v211
    v_cvt_pk_bf16_f32 v134, v212, v213
    v_cvt_pk_bf16_f32 v135, v214, v215
    v_cvt_pk_bf16_f32 v136, v216, v217
    v_cvt_pk_bf16_f32 v137, v218, v219
    v_cvt_pk_bf16_f32 v138, v220, v221
    v_cvt_pk_bf16_f32 v139, v222, v223
    buffer_store_dwordx4 v[132:135], v6, s[40:43], s15 offen offset:2048 sc1
    buffer_store_dwordx4 v[136:139], v6, s[40:43], s15 offen offset:3072 sc1
    ds_read_b128 v[36:39], v28 offset:256
    ds_read_b128 v[52:55], v5 offset:768
    ds_read_b128 v[40:43], v28 offset:288
    ds_read_b128 v[56:59], v5 offset:800
    ds_read_b128 v[44:47], v28 offset:320
    ds_read_b128 v[60:63], v5 offset:832
    ds_read_b128 v[48:51], v28 offset:352
    ds_read_b128 v[64:67], v5 offset:864
    s_waitcnt lgkmcnt(0)
    v_pk_fma_f32 v[208:209], v[36:37], v[196:197], v[52:53] op_sel:[0,1,0]
    v_pk_fma_f32 v[210:211], v[38:39], v[196:197], v[54:55] op_sel:[0,1,0]
    v_pk_fma_f32 v[212:213], v[40:41], v[196:197], v[56:57] op_sel:[0,1,0]
    v_pk_fma_f32 v[214:215], v[42:43], v[196:197], v[58:59] op_sel:[0,1,0]
    v_pk_fma_f32 v[216:217], v[44:45], v[196:197], v[60:61] op_sel:[0,1,0]
    v_pk_fma_f32 v[218:219], v[46:47], v[196:197], v[62:63] op_sel:[0,1,0]
    v_pk_fma_f32 v[220:221], v[48:49], v[196:197], v[64:65] op_sel:[0,1,0]
    v_pk_fma_f32 v[222:223], v[50:51], v[196:197], v[66:67] op_sel:[0,1,0]
    v_pk_fma_f32 v[148:149], v[148:149], v[196:197], v[208:209] op_sel_hi:[1,0,1]
    v_pk_fma_f32 v[150:151], v[150:151], v[196:197], v[210:211] op_sel_hi:[1,0,1]
    v_pk_fma_f32 v[152:153], v[152:153], v[196:197], v[212:213] op_sel_hi:[1,0,1]
    v_pk_fma_f32 v[154:155], v[154:155], v[196:197], v[214:215] op_sel_hi:[1,0,1]
    v_pk_fma_f32 v[156:157], v[156:157], v[196:197], v[216:217] op_sel_hi:[1,0,1]
    v_pk_fma_f32 v[158:159], v[158:159], v[196:197], v[218:219] op_sel_hi:[1,0,1]
    v_pk_fma_f32 v[160:161], v[160:161], v[196:197], v[220:221] op_sel_hi:[1,0,1]
    v_pk_fma_f32 v[162:163], v[162:163], v[196:197], v[222:223] op_sel_hi:[1,0,1]
    v_pk_fma_f32 v[208:209], v[148:149], v[148:149], v[200:201]
    v_pk_fma_f32 v[210:211], v[150:151], v[150:151], v[200:201]
    v_pk_fma_f32 v[212:213], v[152:153], v[152:153], v[200:201]
    v_pk_fma_f32 v[214:215], v[154:155], v[154:155], v[200:201]
    v_pk_fma_f32 v[216:217], v[156:157], v[156:157], v[200:201]
    v_pk_fma_f32 v[218:219], v[158:159], v[158:159], v[200:201]
    v_pk_fma_f32 v[220:221], v[160:161], v[160:161], v[200:201]
    v_pk_fma_f32 v[222:223], v[162:163], v[162:163], v[200:201]
    v_pk_mul_f32 v[208:209], v[208:209], v[148:149]
    v_pk_mul_f32 v[210:211], v[210:211], v[150:151]
    v_pk_mul_f32 v[212:213], v[212:213], v[152:153]
    v_pk_mul_f32 v[214:215], v[214:215], v[154:155]
    v_pk_mul_f32 v[216:217], v[216:217], v[156:157]
    v_pk_mul_f32 v[218:219], v[218:219], v[158:159]
    v_pk_mul_f32 v[220:221], v[220:221], v[160:161]
    v_pk_mul_f32 v[222:223], v[222:223], v[162:163]
    v_exp_f32_e64 v208, -v208
    v_exp_f32_e64 v209, -v209
    v_exp_f32_e64 v210, -v210
    v_exp_f32_e64 v211, -v211
    v_exp_f32_e64 v212, -v212
    v_exp_f32_e64 v213, -v213
    v_exp_f32_e64 v214, -v214
    v_exp_f32_e64 v215, -v215
    v_exp_f32_e64 v216, -v216
    v_exp_f32_e64 v217, -v217
    v_exp_f32_e64 v218, -v218
    v_exp_f32_e64 v219, -v219
    v_exp_f32_e64 v220, -v220
    v_exp_f32_e64 v221, -v221
    v_exp_f32_e64 v222, -v222
    v_exp_f32_e64 v223, -v223
    v_pk_fma_f32 v[208:209], v[208:209], v[202:203], v[202:203]
    v_pk_fma_f32 v[210:211], v[210:211], v[202:203], v[202:203]
    v_pk_fma_f32 v[212:213], v[212:213], v[202:203], v[202:203]
    v_pk_fma_f32 v[214:215], v[214:215], v[202:203], v[202:203]
    v_pk_fma_f32 v[216:217], v[216:217], v[202:203], v[202:203]
    v_pk_fma_f32 v[218:219], v[218:219], v[202:203], v[202:203]
    v_pk_fma_f32 v[220:221], v[220:221], v[202:203], v[202:203]
    v_pk_fma_f32 v[222:223], v[222:223], v[202:203], v[202:203]
    v_rcp_f32 v208, v208
    v_rcp_f32 v209, v209
    v_rcp_f32 v210, v210
    v_rcp_f32 v211, v211
    v_rcp_f32 v212, v212
    v_rcp_f32 v213, v213
    v_rcp_f32 v214, v214
    v_rcp_f32 v215, v215
    v_rcp_f32 v216, v216
    v_rcp_f32 v217, v217
    v_rcp_f32 v218, v218
    v_rcp_f32 v219, v219
    v_rcp_f32 v220, v220
    v_rcp_f32 v221, v221
    v_rcp_f32 v222, v222
    v_rcp_f32 v223, v223
    v_pk_mul_f32 v[208:209], v[148:149], v[208:209]
    v_pk_mul_f32 v[210:211], v[150:151], v[210:211]
    v_pk_mul_f32 v[212:213], v[152:153], v[212:213]
    v_pk_mul_f32 v[214:215], v[154:155], v[214:215]
    v_pk_mul_f32 v[216:217], v[156:157], v[216:217]
    v_pk_mul_f32 v[218:219], v[158:159], v[218:219]
    v_pk_mul_f32 v[220:221], v[160:161], v[220:221]
    v_pk_mul_f32 v[222:223], v[162:163], v[222:223]
    v_cvt_pk_bf16_f32 v148, v208, v209
    v_cvt_pk_bf16_f32 v149, v210, v211
    v_cvt_pk_bf16_f32 v150, v212, v213
    v_cvt_pk_bf16_f32 v151, v214, v215
    v_cvt_pk_bf16_f32 v152, v216, v217
    v_cvt_pk_bf16_f32 v153, v218, v219
    v_cvt_pk_bf16_f32 v154, v220, v221
    v_cvt_pk_bf16_f32 v155, v222, v223
    s_add_u32 s6, s14, 4096
    buffer_store_dwordx4 v[148:151], v6, s[40:43], s6 offen offset:0 sc1
    buffer_store_dwordx4 v[152:155], v6, s[40:43], s6 offen offset:1024 sc1
    v_pk_fma_f32 v[208:209], v[36:37], v[198:199], v[52:53] op_sel:[0,1,0]
    v_pk_fma_f32 v[210:211], v[38:39], v[198:199], v[54:55] op_sel:[0,1,0]
    v_pk_fma_f32 v[212:213], v[40:41], v[198:199], v[56:57] op_sel:[0,1,0]
    v_pk_fma_f32 v[214:215], v[42:43], v[198:199], v[58:59] op_sel:[0,1,0]
    v_pk_fma_f32 v[216:217], v[44:45], v[198:199], v[60:61] op_sel:[0,1,0]
    v_pk_fma_f32 v[218:219], v[46:47], v[198:199], v[62:63] op_sel:[0,1,0]
    v_pk_fma_f32 v[220:221], v[48:49], v[198:199], v[64:65] op_sel:[0,1,0]
    v_pk_fma_f32 v[222:223], v[50:51], v[198:199], v[66:67] op_sel:[0,1,0]
    v_pk_fma_f32 v[164:165], v[164:165], v[198:199], v[208:209] op_sel_hi:[1,0,1]
    v_pk_fma_f32 v[166:167], v[166:167], v[198:199], v[210:211] op_sel_hi:[1,0,1]
    v_pk_fma_f32 v[168:169], v[168:169], v[198:199], v[212:213] op_sel_hi:[1,0,1]
    v_pk_fma_f32 v[170:171], v[170:171], v[198:199], v[214:215] op_sel_hi:[1,0,1]
    v_pk_fma_f32 v[172:173], v[172:173], v[198:199], v[216:217] op_sel_hi:[1,0,1]
    v_pk_fma_f32 v[174:175], v[174:175], v[198:199], v[218:219] op_sel_hi:[1,0,1]
    v_pk_fma_f32 v[176:177], v[176:177], v[198:199], v[220:221] op_sel_hi:[1,0,1]
    v_pk_fma_f32 v[178:179], v[178:179], v[198:199], v[222:223] op_sel_hi:[1,0,1]
    v_pk_fma_f32 v[208:209], v[164:165], v[164:165], v[200:201]
    v_pk_fma_f32 v[210:211], v[166:167], v[166:167], v[200:201]
    v_pk_fma_f32 v[212:213], v[168:169], v[168:169], v[200:201]
    v_pk_fma_f32 v[214:215], v[170:171], v[170:171], v[200:201]
    v_pk_fma_f32 v[216:217], v[172:173], v[172:173], v[200:201]
    v_pk_fma_f32 v[218:219], v[174:175], v[174:175], v[200:201]
    v_pk_fma_f32 v[220:221], v[176:177], v[176:177], v[200:201]
    v_pk_fma_f32 v[222:223], v[178:179], v[178:179], v[200:201]
    v_pk_mul_f32 v[208:209], v[208:209], v[164:165]
    v_pk_mul_f32 v[210:211], v[210:211], v[166:167]
    v_pk_mul_f32 v[212:213], v[212:213], v[168:169]
    v_pk_mul_f32 v[214:215], v[214:215], v[170:171]
    v_pk_mul_f32 v[216:217], v[216:217], v[172:173]
    v_pk_mul_f32 v[218:219], v[218:219], v[174:175]
    v_pk_mul_f32 v[220:221], v[220:221], v[176:177]
    v_pk_mul_f32 v[222:223], v[222:223], v[178:179]
    v_exp_f32_e64 v208, -v208
    v_exp_f32_e64 v209, -v209
    v_exp_f32_e64 v210, -v210
    v_exp_f32_e64 v211, -v211
    v_exp_f32_e64 v212, -v212
    v_exp_f32_e64 v213, -v213
    v_exp_f32_e64 v214, -v214
    v_exp_f32_e64 v215, -v215
    v_exp_f32_e64 v216, -v216
    v_exp_f32_e64 v217, -v217
    v_exp_f32_e64 v218, -v218
    v_exp_f32_e64 v219, -v219
    v_exp_f32_e64 v220, -v220
    v_exp_f32_e64 v221, -v221
    v_exp_f32_e64 v222, -v222
    v_exp_f32_e64 v223, -v223
    v_pk_fma_f32 v[208:209], v[208:209], v[202:203], v[202:203]
    v_pk_fma_f32 v[210:211], v[210:211], v[202:203], v[202:203]
    v_pk_fma_f32 v[212:213], v[212:213], v[202:203], v[202:203]
    v_pk_fma_f32 v[214:215], v[214:215], v[202:203], v[202:203]
    v_pk_fma_f32 v[216:217], v[216:217], v[202:203], v[202:203]
    v_pk_fma_f32 v[218:219], v[218:219], v[202:203], v[202:203]
    v_pk_fma_f32 v[220:221], v[220:221], v[202:203], v[202:203]
    v_pk_fma_f32 v[222:223], v[222:223], v[202:203], v[202:203]
    v_rcp_f32 v208, v208
    v_rcp_f32 v209, v209
    v_rcp_f32 v210, v210
    v_rcp_f32 v211, v211
    v_rcp_f32 v212, v212
    v_rcp_f32 v213, v213
    v_rcp_f32 v214, v214
    v_rcp_f32 v215, v215
    v_rcp_f32 v216, v216
    v_rcp_f32 v217, v217
    v_rcp_f32 v218, v218
    v_rcp_f32 v219, v219
    v_rcp_f32 v220, v220
    v_rcp_f32 v221, v221
    v_rcp_f32 v222, v222
    v_rcp_f32 v223, v223
    v_pk_mul_f32 v[208:209], v[164:165], v[208:209]
    v_pk_mul_f32 v[210:211], v[166:167], v[210:211]
    v_pk_mul_f32 v[212:213], v[168:169], v[212:213]
    v_pk_mul_f32 v[214:215], v[170:171], v[214:215]
    v_pk_mul_f32 v[216:217], v[172:173], v[216:217]
    v_pk_mul_f32 v[218:219], v[174:175], v[218:219]
    v_pk_mul_f32 v[220:221], v[176:177], v[220:221]
    v_pk_mul_f32 v[222:223], v[178:179], v[222:223]
    v_cvt_pk_bf16_f32 v164, v208, v209
    v_cvt_pk_bf16_f32 v165, v210, v211
    v_cvt_pk_bf16_f32 v166, v212, v213
    v_cvt_pk_bf16_f32 v167, v214, v215
    v_cvt_pk_bf16_f32 v168, v216, v217
    v_cvt_pk_bf16_f32 v169, v218, v219
    v_cvt_pk_bf16_f32 v170, v220, v221
    v_cvt_pk_bf16_f32 v171, v222, v223
    s_add_u32 s6, s15, 4096
    buffer_store_dwordx4 v[164:167], v6, s[40:43], s6 offen offset:0 sc1
    buffer_store_dwordx4 v[168:171], v6, s[40:43], s6 offen offset:1024 sc1
    ds_read_b128 v[36:39], v29 offset:0
    ds_read_b128 v[52:55], v5 offset:896
    ds_read_b128 v[40:43], v29 offset:32
    ds_read_b128 v[56:59], v5 offset:928
    ds_read_b128 v[44:47], v29 offset:64
    ds_read_b128 v[60:63], v5 offset:960
    ds_read_b128 v[48:51], v29 offset:96
    ds_read_b128 v[64:67], v5 offset:992
    s_waitcnt lgkmcnt(0)
    v_pk_fma_f32 v[208:209], v[36:37], v[196:197], v[52:53] op_sel:[0,1,0]
    v_pk_fma_f32 v[210:211], v[38:39], v[196:197], v[54:55] op_sel:[0,1,0]
    v_pk_fma_f32 v[212:213], v[40:41], v[196:197], v[56:57] op_sel:[0,1,0]
    v_pk_fma_f32 v[214:215], v[42:43], v[196:197], v[58:59] op_sel:[0,1,0]
    v_pk_fma_f32 v[216:217], v[44:45], v[196:197], v[60:61] op_sel:[0,1,0]
    v_pk_fma_f32 v[218:219], v[46:47], v[196:197], v[62:63] op_sel:[0,1,0]
    v_pk_fma_f32 v[220:221], v[48:49], v[196:197], v[64:65] op_sel:[0,1,0]
    v_pk_fma_f32 v[222:223], v[50:51], v[196:197], v[66:67] op_sel:[0,1,0]
    v_pk_fma_f32 v[180:181], v[180:181], v[196:197], v[208:209] op_sel_hi:[1,0,1]
    v_pk_fma_f32 v[182:183], v[182:183], v[196:197], v[210:211] op_sel_hi:[1,0,1]
    v_pk_fma_f32 v[184:185], v[184:185], v[196:197], v[212:213] op_sel_hi:[1,0,1]
    v_pk_fma_f32 v[186:187], v[186:187], v[196:197], v[214:215] op_sel_hi:[1,0,1]
    v_pk_fma_f32 v[188:189], v[188:189], v[196:197], v[216:217] op_sel_hi:[1,0,1]
    v_pk_fma_f32 v[190:191], v[190:191], v[196:197], v[218:219] op_sel_hi:[1,0,1]
    v_pk_fma_f32 v[192:193], v[192:193], v[196:197], v[220:221] op_sel_hi:[1,0,1]
    v_pk_fma_f32 v[194:195], v[194:195], v[196:197], v[222:223] op_sel_hi:[1,0,1]
    v_pk_fma_f32 v[208:209], v[180:181], v[180:181], v[200:201]
    v_pk_fma_f32 v[210:211], v[182:183], v[182:183], v[200:201]
    v_pk_fma_f32 v[212:213], v[184:185], v[184:185], v[200:201]
    v_pk_fma_f32 v[214:215], v[186:187], v[186:187], v[200:201]
    v_pk_fma_f32 v[216:217], v[188:189], v[188:189], v[200:201]
    v_pk_fma_f32 v[218:219], v[190:191], v[190:191], v[200:201]
    v_pk_fma_f32 v[220:221], v[192:193], v[192:193], v[200:201]
    v_pk_fma_f32 v[222:223], v[194:195], v[194:195], v[200:201]
    v_pk_mul_f32 v[208:209], v[208:209], v[180:181]
    v_pk_mul_f32 v[210:211], v[210:211], v[182:183]
    v_pk_mul_f32 v[212:213], v[212:213], v[184:185]
    v_pk_mul_f32 v[214:215], v[214:215], v[186:187]
    v_pk_mul_f32 v[216:217], v[216:217], v[188:189]
    v_pk_mul_f32 v[218:219], v[218:219], v[190:191]
    v_pk_mul_f32 v[220:221], v[220:221], v[192:193]
    v_pk_mul_f32 v[222:223], v[222:223], v[194:195]
    v_exp_f32_e64 v208, -v208
    v_exp_f32_e64 v209, -v209
    v_exp_f32_e64 v210, -v210
    v_exp_f32_e64 v211, -v211
    v_exp_f32_e64 v212, -v212
    v_exp_f32_e64 v213, -v213
    v_exp_f32_e64 v214, -v214
    v_exp_f32_e64 v215, -v215
    v_exp_f32_e64 v216, -v216
    v_exp_f32_e64 v217, -v217
    v_exp_f32_e64 v218, -v218
    v_exp_f32_e64 v219, -v219
    v_exp_f32_e64 v220, -v220
    v_exp_f32_e64 v221, -v221
    v_exp_f32_e64 v222, -v222
    v_exp_f32_e64 v223, -v223
    v_pk_fma_f32 v[208:209], v[208:209], v[202:203], v[202:203]
    v_pk_fma_f32 v[210:211], v[210:211], v[202:203], v[202:203]
    v_pk_fma_f32 v[212:213], v[212:213], v[202:203], v[202:203]
    v_pk_fma_f32 v[214:215], v[214:215], v[202:203], v[202:203]
    v_pk_fma_f32 v[216:217], v[216:217], v[202:203], v[202:203]
    v_pk_fma_f32 v[218:219], v[218:219], v[202:203], v[202:203]
    v_pk_fma_f32 v[220:221], v[220:221], v[202:203], v[202:203]
    v_pk_fma_f32 v[222:223], v[222:223], v[202:203], v[202:203]
    v_rcp_f32 v208, v208
    v_rcp_f32 v209, v209
    v_rcp_f32 v210, v210
    v_rcp_f32 v211, v211
    v_rcp_f32 v212, v212
    v_rcp_f32 v213, v213
    v_rcp_f32 v214, v214
    v_rcp_f32 v215, v215
    v_rcp_f32 v216, v216
    v_rcp_f32 v217, v217
    v_rcp_f32 v218, v218
    v_rcp_f32 v219, v219
    v_rcp_f32 v220, v220
    v_rcp_f32 v221, v221
    v_rcp_f32 v222, v222
    v_rcp_f32 v223, v223
    v_pk_mul_f32 v[208:209], v[180:181], v[208:209]
    v_pk_mul_f32 v[210:211], v[182:183], v[210:211]
    v_pk_mul_f32 v[212:213], v[184:185], v[212:213]
    v_pk_mul_f32 v[214:215], v[186:187], v[214:215]
    v_pk_mul_f32 v[216:217], v[188:189], v[216:217]
    v_pk_mul_f32 v[218:219], v[190:191], v[218:219]
    v_pk_mul_f32 v[220:221], v[192:193], v[220:221]
    v_pk_mul_f32 v[222:223], v[194:195], v[222:223]
    v_cvt_pk_bf16_f32 v180, v208, v209
    v_cvt_pk_bf16_f32 v181, v210, v211
    v_cvt_pk_bf16_f32 v182, v212, v213
    v_cvt_pk_bf16_f32 v183, v214, v215
    v_cvt_pk_bf16_f32 v184, v216, v217
    v_cvt_pk_bf16_f32 v185, v218, v219
    v_cvt_pk_bf16_f32 v186, v220, v221
    v_cvt_pk_bf16_f32 v187, v222, v223
    buffer_store_dwordx4 v[180:183], v6, s[40:43], s13 offen offset:0 sc1
    buffer_store_dwordx4 v[184:187], v6, s[40:43], s13 offen offset:1024 sc1
    s_add_u32 s52, s36, 49283072
    s_addc_u32 s53, s37, 0
    s_mov_b32 s54, 1048576
    s_mov_b32 s55, 0x20000
    s_lshl_b32 s4, s8, 1
    s_lshr_b32 s5, s9, 3
    s_add_u32 s4, s4, s5
    s_lshl_b32 s4, s4, 4
    s_add_u32 s4, s4, s11
    s_lshl_b32 s4, s4, 8
    s_and_b32 s5, s9, 7
    s_lshl_b32 s5, s5, 1
    s_add_u32 s5, s5, s12
    v_bfe_u32 v4, v0, 1, 3
    v_lshlrev_b32 v4, 9, v4
    v_and_b32 v5, 1, v0
    v_lshl_add_u32 v4, v5, 7, v4
    s_lshl_b32 s5, s5, 2
    s_add_u32 s4, s4, s5
    s_add_u32 s4, s4, 262144
    v_mov_b32 v5, 1
    s_waitcnt vmcnt(0)
    s_mov_b64 exec, 0xffff
    buffer_store_dword v5, v4, s[52:55], s4 offen sc1
    s_mov_b64 exec, -1
    s_barrier
L_w1b_dend:
    s_and_b32 s4, s2, 7
    s_lshr_b32 s5, s2, 3
    s_and_b32 s3, s4, 1
    s_lshr_b32 s7, s4, 1
    s_and_b32 s9, s5, 7
    s_lshl_b32 s8, s7, 2
    s_lshr_b32 s6, s5, 3
    s_add_u32 s8, s8, s6
    s_and_b32 s11, s10, 1
    s_lshr_b32 s12, s10, 1
    s_lshl_b32 s14, s11, 1
    s_add_u32 s14, s14, s3
    s_xor_b32 s15, s14, 1
    v_and_b32 v2, 31, v0
    v_lshrrev_b32 v3, 5, v0
    s_lshl_b32 s6, s14, 12
    s_lshl_b32 s7, s15, 12
    v_lshlrev_b32 v4, 4, v0
    v_add_u32 v8, s6, v4
    v_add_u32 v9, s7, v4
    s_mul_i32 s4, s12, 2048
    s_add_u32 s4, s4, 16384
    v_add_u32 v24, s4, v4
    v_mov_b32 v68, 0
    v_mov_b32 v69, 0
    v_mov_b32 v70, 0
    v_mov_b32 v71, 0
    v_mov_b32 v72, 0
    v_mov_b32 v73, 0
    v_mov_b32 v74, 0
    v_mov_b32 v75, 0
    v_mov_b32 v76, 0
    v_mov_b32 v77, 0
    v_mov_b32 v78, 0
    v_mov_b32 v79, 0
    v_mov_b32 v80, 0
    v_mov_b32 v81, 0
    v_mov_b32 v82, 0
    v_mov_b32 v83, 0
    v_mov_b32 v84, 0
    v_mov_b32 v85, 0
    v_mov_b32 v86, 0
    v_mov_b32 v87, 0
    v_mov_b32 v88, 0
    v_mov_b32 v89, 0
    v_mov_b32 v90, 0
    v_mov_b32 v91, 0
    v_mov_b32 v92, 0
    v_mov_b32 v93, 0
    v_mov_b32 v94, 0
    v_mov_b32 v95, 0
    v_mov_b32 v96, 0
    v_mov_b32 v97, 0
    v_mov_b32 v98, 0
    v_mov_b32 v99, 0
    v_mov_b32 v100, 0
    v_mov_b32 v101, 0
    v_mov_b32 v102, 0
    v_mov_b32 v103, 0
    v_mov_b32 v104, 0
    v_mov_b32 v105, 0
    v_mov_b32 v106, 0
    v_mov_b32 v107, 0
    v_mov_b32 v108, 0
    v_mov_b32 v109, 0
    v_mov_b32 v110, 0
    v_mov_b32 v111, 0
    v_mov_b32 v112, 0
    v_mov_b32 v113, 0
    v_mov_b32 v114, 0
    v_mov_b32 v115, 0
    v_mov_b32 v116, 0
    v_mov_b32 v117, 0
    v_mov_b32 v118, 0
    v_mov_b32 v119, 0
    v_mov_b32 v120, 0
    v_mov_b32 v121, 0
    v_mov_b32 v122, 0
    v_mov_b32 v123, 0
    v_mov_b32 v124, 0
    v_mov_b32 v125, 0
    v_mov_b32 v126, 0
    v_mov_b32 v127, 0
    v_mov_b32 v128, 0
    v_mov_b32 v129, 0
    v_mov_b32 v130, 0
    v_mov_b32 v131, 0
    s_waitcnt lgkmcnt(0)
    s_mov_b32 s13, 0
    s_mov_b32 s51, 27
    v_add_u32 v16, s13, v8
    v_add_u32 v17, s13, v9
    v_add_u32 v26, s13, v24
    s_add_u32 s13, s13, 32768
    s_cmp_eq_u32 s13, 163840
    s_cselect_b32 s13, 0, s13
    s_barrier
    ds_read_b128 v[36:39], v16 offset:0
    ds_read_b128 v[44:47], v26 offset:0
    ds_read_b128 v[40:43], v17 offset:0
    ds_read_b128 v[48:51], v26 offset:1024
    s_add_u32 s40, s36, 41943040
    s_addc_u32 s41, s37, 0
    s_mov_b32 s42, 4194304
    s_mov_b32 s43, 0x20000
    s_lshl_b32 s59, s9, 1
    s_add_u32 s59, s59, s12
    s_lshl_b32 s4, s8, 2
    s_add_u32 s58, s4, s14
    s_lshl_b32 s4, s58, 16
    s_lshl_b32 s5, s59, 7
    s_add_u32 s56, s4, s5
    s_lshl_b32 s6, s59, 12
    s_add_u32 s57, s4, s6
    v_lshlrev_b32 v164, 11, v2
    v_lshl_add_u32 v164, v3, 3, v164
    v_lshlrev_b32 v165, 4, v0
    buffer_load_dwordx4 v[132:135], v165, s[40:43], s57 offen offset:0 sc1
    buffer_load_dwordx4 v[136:139], v165, s[40:43], s57 offen offset:1024 sc1
    buffer_load_dwordx4 v[140:143], v165, s[40:43], s57 offen offset:2048 sc1
    buffer_load_dwordx4 v[144:147], v165, s[40:43], s57 offen offset:3072 sc1
    s_mov_b32 s44, s30
    s_mov_b32 s45, s31
    s_mov_b32 s46, 2048
    s_mov_b32 s47, 0x20000
    v_lshlrev_b32 v4, 3, v3
    buffer_load_dwordx2 v[148:149], v4, s[44:47], s5 offen offset:0
    buffer_load_dwordx2 v[150:151], v4, s[44:47], s5 offen offset:16
    buffer_load_dwordx2 v[152:153], v4, s[44:47], s5 offen offset:32
    buffer_load_dwordx2 v[154:155], v4, s[44:47], s5 offen offset:48
    buffer_load_dwordx2 v[156:157], v4, s[44:47], s5 offen offset:64
    buffer_load_dwordx2 v[158:159], v4, s[44:47], s5 offen offset:80
    buffer_load_dwordx2 v[160:161], v4, s[44:47], s5 offen offset:96
    buffer_load_dwordx2 v[162:163], v4, s[44:47], s5 offen offset:112
L_w2b_c_loop:
    s_waitcnt lgkmcnt(2)
    v_mfma_f32_32x32x16_bf16 v[68:83], v[44:47], v[36:39], v[68:83]
    ds_read_b128 v[52:55], v16 offset:1024
    ds_read_b128 v[60:63], v26 offset:4096
    s_waitcnt lgkmcnt(3)
    v_mfma_f32_32x32x16_bf16 v[84:99], v[44:47], v[40:43], v[84:99]
    ds_read_b128 v[56:59], v17 offset:1024
    ds_read_b128 v[64:67], v26 offset:5120
    s_waitcnt lgkmcnt(4)
    v_mfma_f32_32x32x16_bf16 v[100:115], v[48:51], v[36:39], v[100:115]
    v_mfma_f32_32x32x16_bf16 v[116:131], v[48:51], v[40:43], v[116:131]
    s_waitcnt lgkmcnt(2)
    v_mfma_f32_32x32x16_bf16 v[68:83], v[60:63], v[52:55], v[68:83]
    ds_read_b128 v[36:39], v16 offset:2048
    ds_read_b128 v[44:47], v26 offset:8192
    s_waitcnt lgkmcnt(3)
    v_mfma_f32_32x32x16_bf16 v[84:99], v[60:63], v[56:59], v[84:99]
    ds_read_b128 v[40:43], v17 offset:2048
    ds_read_b128 v[48:51], v26 offset:9216
    s_waitcnt lgkmcnt(4)
    v_mfma_f32_32x32x16_bf16 v[100:115], v[64:67], v[52:55], v[100:115]
    v_mfma_f32_32x32x16_bf16 v[116:131], v[64:67], v[56:59], v[116:131]
    s_waitcnt lgkmcnt(2)
    v_mfma_f32_32x32x16_bf16 v[68:83], v[44:47], v[36:39], v[68:83]
    ds_read_b128 v[52:55], v16 offset:3072
    ds_read_b128 v[60:63], v26 offset:12288
    s_waitcnt lgkmcnt(3)
    v_mfma_f32_32x32x16_bf16 v[84:99], v[44:47], v[40:43], v[84:99]
    ds_read_b128 v[56:59], v17 offset:3072
    ds_read_b128 v[64:67], v26 offset:13312
    s_waitcnt lgkmcnt(4)
    v_mfma_f32_32x32x16_bf16 v[100:115], v[48:51], v[36:39], v[100:115]
    v_mfma_f32_32x32x16_bf16 v[116:131], v[48:51], v[40:43], v[116:131]
    s_waitcnt lgkmcnt(0)
    v_add_u32 v16, s13, v8
    v_add_u32 v17, s13, v9
    v_add_u32 v26, s13, v24
    s_add_u32 s13, s13, 32768
    s_cmp_eq_u32 s13, 163840
    s_cselect_b32 s13, 0, s13
    s_barrier
    v_mfma_f32_32x32x16_bf16 v[68:83], v[60:63], v[52:55], v[68:83]
    ds_read_b128 v[36:39], v16 offset:0
    ds_read_b128 v[44:47], v26 offset:0
    v_mfma_f32_32x32x16_bf16 v[84:99], v[60:63], v[56:59], v[84:99]
    ds_read_b128 v[40:43], v17 offset:0
    ds_read_b128 v[48:51], v26 offset:1024
    v_mfma_f32_32x32x16_bf16 v[100:115], v[64:67], v[52:55], v[100:115]
    v_mfma_f32_32x32x16_bf16 v[116:131], v[64:67], v[56:59], v[116:131]
    s_sub_u32 s51, s51, 1
    s_cmp_lg_u32 s51, 0
    s_cbranch_scc1 L_w2b_c_loop
    s_waitcnt lgkmcnt(2)
    v_mfma_f32_32x32x16_bf16 v[68:83], v[44:47], v[36:39], v[68:83]
    ds_read_b128 v[52:55], v16 offset:1024
    ds_read_b128 v[60:63], v26 offset:4096
    s_waitcnt lgkmcnt(3)
    v_mfma_f32_32x32x16_bf16 v[84:99], v[44:47], v[40:43], v[84:99]
    ds_read_b128 v[56:59], v17 offset:1024
    ds_read_b128 v[64:67], v26 offset:5120
    s_waitcnt lgkmcnt(4)
    v_mfma_f32_32x32x16_bf16 v[100:115], v[48:51], v[36:39], v[100:115]
    v_mfma_f32_32x32x16_bf16 v[116:131], v[48:51], v[40:43], v[116:131]
    s_waitcnt lgkmcnt(2)
    v_mfma_f32_32x32x16_bf16 v[68:83], v[60:63], v[52:55], v[68:83]
    ds_read_b128 v[36:39], v16 offset:2048
    ds_read_b128 v[44:47], v26 offset:8192
    s_waitcnt lgkmcnt(3)
    v_mfma_f32_32x32x16_bf16 v[84:99], v[60:63], v[56:59], v[84:99]
    ds_read_b128 v[40:43], v17 offset:2048
    ds_read_b128 v[48:51], v26 offset:9216
    s_waitcnt lgkmcnt(4)
    v_mfma_f32_32x32x16_bf16 v[100:115], v[64:67], v[52:55], v[100:115]
    v_mfma_f32_32x32x16_bf16 v[116:131], v[64:67], v[56:59], v[116:131]
    s_waitcnt lgkmcnt(2)
    v_mfma_f32_32x32x16_bf16 v[68:83], v[44:47], v[36:39], v[68:83]
    ds_read_b128 v[52:55], v16 offset:3072
    ds_read_b128 v[60:63], v26 offset:12288
    s_waitcnt lgkmcnt(3)
    v_mfma_f32_32x32x16_bf16 v[84:99], v[44:47], v[40:43], v[84:99]
    ds_read_b128 v[56:59], v17 offset:3072
    ds_read_b128 v[64:67], v26 offset:13312
    s_waitcnt lgkmcnt(4)
    v_mfma_f32_32x32x16_bf16 v[100:115], v[48:51], v[36:39], v[100:115]
    v_mfma_f32_32x32x16_bf16 v[116:131], v[48:51], v[40:43], v[116:131]
    s_waitcnt lgkmcnt(2)
    v_mfma_f32_32x32x16_bf16 v[68:83], v[60:63], v[52:55], v[68:83]
    s_waitcnt lgkmcnt(1)
    v_mfma_f32_32x32x16_bf16 v[84:99], v[60:63], v[56:59], v[84:99]
    s_waitcnt lgkmcnt(0)
    v_mfma_f32_32x32x16_bf16 v[100:115], v[64:67], v[52:55], v[100:115]
    v_mfma_f32_32x32x16_bf16 v[116:131], v[64:67], v[56:59], v[116:131]
    s_waitcnt vmcnt(0)
    s_add_u32 s44, s36, 180355072
    s_addc_u32 s45, s37, 0
    s_mov_b32 s46, 8388608
    s_mov_b32 s47, 0x20000
    s_add_u32 s52, s36, 49283072
    s_addc_u32 s53, s37, 0
    s_mov_b32 s54, 1048576
    s_mov_b32 s55, 0x20000
    s_lshl_b32 s4, s8, 3
    s_add_u32 s4, s4, s9
    s_lshl_b32 s4, s4, 1
    s_add_u32 s4, s4, s3
    s_lshl_b32 s4, s4, 2
    s_add_u32 s4, s4, s10
    s_xor_b32 s5, s4, 4
    s_lshl_b32 s6, s5, 12
    v_cvt_pk_bf16_f32 v36, v84, v85
    v_cvt_pk_bf16_f32 v37, v86, v87
    v_cvt_pk_bf16_f32 v38, v88, v89
    v_cvt_pk_bf16_f32 v39, v90, v91
    v_cvt_pk_bf16_f32 v40, v92, v93
    v_cvt_pk_bf16_f32 v41, v94, v95
    v_cvt_pk_bf16_f32 v42, v96, v97
    v_cvt_pk_bf16_f32 v43, v98, v99
    buffer_store_dwordx4 v[36:39], v165, s[44:47], s6 offen offset:0 sc1
    buffer_store_dwordx4 v[40:43], v165, s[44:47], s6 offen offset:1024 sc1
    v_cvt_pk_bf16_f32 v44, v116, v117
    v_cvt_pk_bf16_f32 v45, v118, v119
    v_cvt_pk_bf16_f32 v46, v120, v121
    v_cvt_pk_bf16_f32 v47, v122, v123
    v_cvt_pk_bf16_f32 v48, v124, v125
    v_cvt_pk_bf16_f32 v49, v126, v127
    v_cvt_pk_bf16_f32 v50, v128, v129
    v_cvt_pk_bf16_f32 v51, v130, v131
    buffer_store_dwordx4 v[44:47], v165, s[44:47], s6 offen offset:2048 sc1
    buffer_store_dwordx4 v[48:51], v165, s[44:47], s6 offen offset:3072 sc1
    s_lshl_b32 s5, s5, 7
    s_add_u32 s5, s5, 0
    v_mov_b32 v4, 0
    v_mov_b32 v5, 1
    s_lshl_b32 s6, s4, 12
    s_lshl_b32 s4, s4, 7
    s_add_u32 s4, s4, 0
    v_lshlrev_b32 v6, 16, v132
    v_and_b32 v7, 0xffff0000, v132
    v_pk_add_f32 v[68:69], v[68:69], v[6:7]
    v_lshlrev_b32 v6, 16, v148
    v_and_b32 v7, 0xffff0000, v148
    v_pk_add_f32 v[68:69], v[68:69], v[6:7]
    v_lshlrev_b32 v6, 16, v133
    v_and_b32 v7, 0xffff0000, v133
    v_pk_add_f32 v[70:71], v[70:71], v[6:7]
    v_lshlrev_b32 v6, 16, v149
    v_and_b32 v7, 0xffff0000, v149
    v_pk_add_f32 v[70:71], v[70:71], v[6:7]
    v_lshlrev_b32 v6, 16, v134
    v_and_b32 v7, 0xffff0000, v134
    v_pk_add_f32 v[72:73], v[72:73], v[6:7]
    v_lshlrev_b32 v6, 16, v150
    v_and_b32 v7, 0xffff0000, v150
    v_pk_add_f32 v[72:73], v[72:73], v[6:7]
    v_lshlrev_b32 v6, 16, v135
    v_and_b32 v7, 0xffff0000, v135
    v_pk_add_f32 v[74:75], v[74:75], v[6:7]
    v_lshlrev_b32 v6, 16, v151
    v_and_b32 v7, 0xffff0000, v151
    v_pk_add_f32 v[74:75], v[74:75], v[6:7]
    v_lshlrev_b32 v6, 16, v136
    v_and_b32 v7, 0xffff0000, v136
    v_pk_add_f32 v[76:77], v[76:77], v[6:7]
    v_lshlrev_b32 v6, 16, v152
    v_and_b32 v7, 0xffff0000, v152
    v_pk_add_f32 v[76:77], v[76:77], v[6:7]
    v_lshlrev_b32 v6, 16, v137
    v_and_b32 v7, 0xffff0000, v137
    v_pk_add_f32 v[78:79], v[78:79], v[6:7]
    v_lshlrev_b32 v6, 16, v153
    v_and_b32 v7, 0xffff0000, v153
    v_pk_add_f32 v[78:79], v[78:79], v[6:7]
    v_lshlrev_b32 v6, 16, v138
    v_and_b32 v7, 0xffff0000, v138
    v_pk_add_f32 v[80:81], v[80:81], v[6:7]
    v_lshlrev_b32 v6, 16, v154
    v_and_b32 v7, 0xffff0000, v154
    v_pk_add_f32 v[80:81], v[80:81], v[6:7]
    v_lshlrev_b32 v6, 16, v139
    v_and_b32 v7, 0xffff0000, v139
    v_pk_add_f32 v[82:83], v[82:83], v[6:7]
    v_lshlrev_b32 v6, 16, v155
    v_and_b32 v7, 0xffff0000, v155
    v_pk_add_f32 v[82:83], v[82:83], v[6:7]
    v_lshlrev_b32 v6, 16, v140
    v_and_b32 v7, 0xffff0000, v140
    v_pk_add_f32 v[100:101], v[100:101], v[6:7]
    v_lshlrev_b32 v6, 16, v156
    v_and_b32 v7, 0xffff0000, v156
    v_pk_add_f32 v[100:101], v[100:101], v[6:7]
    v_lshlrev_b32 v6, 16, v141
    v_and_b32 v7, 0xffff0000, v141
    v_pk_add_f32 v[102:103], v[102:103], v[6:7]
    v_lshlrev_b32 v6, 16, v157
    v_and_b32 v7, 0xffff0000, v157
    v_pk_add_f32 v[102:103], v[102:103], v[6:7]
    v_lshlrev_b32 v6, 16, v142
    v_and_b32 v7, 0xffff0000, v142
    v_pk_add_f32 v[104:105], v[104:105], v[6:7]
    v_lshlrev_b32 v6, 16, v158
    v_and_b32 v7, 0xffff0000, v158
    v_pk_add_f32 v[104:105], v[104:105], v[6:7]
    v_lshlrev_b32 v6, 16, v143
    v_and_b32 v7, 0xffff0000, v143
    v_pk_add_f32 v[106:107], v[106:107], v[6:7]
    v_lshlrev_b32 v6, 16, v159
    v_and_b32 v7, 0xffff0000, v159
    v_pk_add_f32 v[106:107], v[106:107], v[6:7]
    v_lshlrev_b32 v6, 16, v144
    v_and_b32 v7, 0xffff0000, v144
    v_pk_add_f32 v[108:109], v[108:109], v[6:7]
    v_lshlrev_b32 v6, 16, v160
    v_and_b32 v7, 0xffff0000, v160
    v_pk_add_f32 v[108:109], v[108:109], v[6:7]
    v_lshlrev_b32 v6, 16, v145
    v_and_b32 v7, 0xffff0000, v145
    v_pk_add_f32 v[110:111], v[110:111], v[6:7]
    v_lshlrev_b32 v6, 16, v161
    v_and_b32 v7, 0xffff0000, v161
    v_pk_add_f32 v[110:111], v[110:111], v[6:7]
    v_lshlrev_b32 v6, 16, v146
    v_and_b32 v7, 0xffff0000, v146
    v_pk_add_f32 v[112:113], v[112:113], v[6:7]
    v_lshlrev_b32 v6, 16, v162
    v_and_b32 v7, 0xffff0000, v162
    v_pk_add_f32 v[112:113], v[112:113], v[6:7]
    v_lshlrev_b32 v6, 16, v147
    v_and_b32 v7, 0xffff0000, v147
    v_pk_add_f32 v[114:115], v[114:115], v[6:7]
    v_lshlrev_b32 v6, 16, v163
    v_and_b32 v7, 0xffff0000, v163
    v_pk_add_f32 v[114:115], v[114:115], v[6:7]
    s_waitcnt vmcnt(0)
    buffer_store_dword v5, v4, s[52:55], s5 offen sc1
    s_mov_b32 s60, 0x40000
L_w2b_poll:
    buffer_load_dword v5, v4, s[52:55], s4 offen sc1
    s_waitcnt vmcnt(0)
    v_readfirstlane_b32 s5, v5
    s_nop 0
    s_cmp_eq_u32 s5, 1
    s_cbranch_scc1 L_w2b_got
    s_sleep 1
    s_sub_u32 s60, s60, 1
    s_cmp_lg_u32 s60, 0
    s_cbranch_scc1 L_w2b_poll
L_w2b_got:
    buffer_load_dwordx4 v[36:39], v165, s[44:47], s6 offen offset:0 sc1
    buffer_load_dwordx4 v[40:43], v165, s[44:47], s6 offen offset:1024 sc1
    buffer_load_dwordx4 v[44:47], v165, s[44:47], s6 offen offset:2048 sc1
    buffer_load_dwordx4 v[48:51], v165, s[44:47], s6 offen offset:3072 sc1
    s_waitcnt vmcnt(3)
    v_lshlrev_b32 v6, 16, v36
    v_and_b32 v7, 0xffff0000, v36
    v_pk_add_f32 v[68:69], v[68:69], v[6:7]
    v_lshlrev_b32 v6, 16, v37
    v_and_b32 v7, 0xffff0000, v37
    v_pk_add_f32 v[70:71], v[70:71], v[6:7]
    v_lshlrev_b32 v6, 16, v38
    v_and_b32 v7, 0xffff0000, v38
    v_pk_add_f32 v[72:73], v[72:73], v[6:7]
    v_lshlrev_b32 v6, 16, v39
    v_and_b32 v7, 0xffff0000, v39
    v_pk_add_f32 v[74:75], v[74:75], v[6:7]
    s_waitcnt vmcnt(2)
    v_lshlrev_b32 v6, 16, v40
    v_and_b32 v7, 0xffff0000, v40
    v_pk_add_f32 v[76:77], v[76:77], v[6:7]
    v_lshlrev_b32 v6, 16, v41
    v_and_b32 v7, 0xffff0000, v41
    v_pk_add_f32 v[78:79], v[78:79], v[6:7]
    v_lshlrev_b32 v6, 16, v42
    v_and_b32 v7, 0xffff0000, v42
    v_pk_add_f32 v[80:81], v[80:81], v[6:7]
    v_lshlrev_b32 v6, 16, v43
    v_and_b32 v7, 0xffff0000, v43
    v_pk_add_f32 v[82:83], v[82:83], v[6:7]
    s_waitcnt vmcnt(1)
    v_lshlrev_b32 v6, 16, v44
    v_and_b32 v7, 0xffff0000, v44
    v_pk_add_f32 v[100:101], v[100:101], v[6:7]
    v_lshlrev_b32 v6, 16, v45
    v_and_b32 v7, 0xffff0000, v45
    v_pk_add_f32 v[102:103], v[102:103], v[6:7]
    v_lshlrev_b32 v6, 16, v46
    v_and_b32 v7, 0xffff0000, v46
    v_pk_add_f32 v[104:105], v[104:105], v[6:7]
    v_lshlrev_b32 v6, 16, v47
    v_and_b32 v7, 0xffff0000, v47
    v_pk_add_f32 v[106:107], v[106:107], v[6:7]
    s_waitcnt vmcnt(0)
    v_lshlrev_b32 v6, 16, v48
    v_and_b32 v7, 0xffff0000, v48
    v_pk_add_f32 v[108:109], v[108:109], v[6:7]
    v_lshlrev_b32 v6, 16, v49
    v_and_b32 v7, 0xffff0000, v49
    v_pk_add_f32 v[110:111], v[110:111], v[6:7]
    v_lshlrev_b32 v6, 16, v50
    v_and_b32 v7, 0xffff0000, v50
    v_pk_add_f32 v[112:113], v[112:113], v[6:7]
    v_lshlrev_b32 v6, 16, v51
    v_and_b32 v7, 0xffff0000, v51
    v_pk_add_f32 v[114:115], v[114:115], v[6:7]
    s_mov_b32 s48, s32
    s_mov_b32 s49, s33
    s_mov_b32 s50, 4194304
    s_mov_b32 s51, 0x20000
    v_lshl_add_u32 v164, v3, 3, v164
    v_cvt_pk_bf16_f32 v36, v68, v69
    v_cvt_pk_bf16_f32 v37, v70, v71
    v_cvt_pk_bf16_f32 v38, v72, v73
    v_cvt_pk_bf16_f32 v39, v74, v75
    v_cvt_pk_bf16_f32 v40, v76, v77
    v_cvt_pk_bf16_f32 v41, v78, v79
    v_cvt_pk_bf16_f32 v42, v80, v81
    v_cvt_pk_bf16_f32 v43, v82, v83
    v_permlane32_swap_b32 v36, v38
    v_permlane32_swap_b32 v37, v39
    buffer_store_dwordx4 v[36:39], v164, s[48:51], s56 offen offset:0
    v_permlane32_swap_b32 v40, v42
    v_permlane32_swap_b32 v41, v43
    buffer_store_dwordx4 v[40:43], v164, s[48:51], s56 offen offset:32
    v_cvt_pk_bf16_f32 v44, v100, v101
    v_cvt_pk_bf16_f32 v45, v102, v103
    v_cvt_pk_bf16_f32 v46, v104, v105
    v_cvt_pk_bf16_f32 v47, v106, v107
    v_cvt_pk_bf16_f32 v48, v108, v109
    v_cvt_pk_bf16_f32 v49, v110, v111
    v_cvt_pk_bf16_f32 v50, v112, v113
    v_cvt_pk_bf16_f32 v51, v114, v115
    v_permlane32_swap_b32 v44, v46
    v_permlane32_swap_b32 v45, v47
    buffer_store_dwordx4 v[44:47], v164, s[48:51], s56 offen offset:64
    v_permlane32_swap_b32 v48, v50
    v_permlane32_swap_b32 v49, v51
    buffer_store_dwordx4 v[48:51], v164, s[48:51], s56 offen offset:96
L_w2b_dend:
L_rest_kernel_j3:
L_rest_kernel_end:
    s_endpgm
L_text_end:
.section .rodata,"a"
.p2align 6
.amdhsa_kernel g0_kernel
  .amdhsa_next_free_vgpr 256
  .amdhsa_next_free_sgpr 63
  .amdhsa_accum_offset 256
  .amdhsa_group_segment_fixed_size 0
  .amdhsa_kernarg_size 88
  .amdhsa_user_sgpr_count 2
  .amdhsa_user_sgpr_kernarg_segment_ptr 1
  .amdhsa_system_sgpr_workgroup_id_x 1
.end_amdhsa_kernel
.p2align 6
.amdhsa_kernel rest_kernel
  .amdhsa_next_free_vgpr 232
  .amdhsa_next_free_sgpr 102
  .amdhsa_accum_offset 232
  .amdhsa_group_segment_fixed_size 0
  .amdhsa_kernarg_size 88
  .amdhsa_user_sgpr_count 2
  .amdhsa_user_sgpr_kernarg_segment_ptr 1
  .amdhsa_system_sgpr_workgroup_id_x 1
.end_amdhsa_kernel
```
